```python
import torch

def _softmax(x, axis=-1):
    return torch.softmax(x, dim=axis)
def _gelu(x):
    return torch.nn.functional.gelu(x, approximate="tanh")
def _silu(x):
    return torch.nn.functional.silu(x)
def _sigmoid(x):
    return torch.sigmoid(x)
def _layernorm(x, axis=-1, eps=1e-5):
    m = x.mean(dim=axis, keepdim=True)
    v = x.var(dim=axis, keepdim=True, unbiased=False)
    return (x - m) / torch.sqrt(v + eps)
def _scatter_add(tgt, idx, src, axis=0):
    return tgt.clone().index_add_(axis, idx, src)
def _segment_sum(src, seg, n):
    out = torch.zeros((n,) + src.shape[1:], dtype=src.dtype)
    return out.index_add_(0, seg, src)
def _pad(x, pw):
    flat = tuple(v for pair in reversed(pw) for v in pair)
    return torch.nn.functional.pad(x, flat)

kernel_name = 'sequential_preLN__ssm_conv_h3__dense_activation_mish__prompt'

def setup_inputs():

    _w = (lambda a: (lambda t: t.to(torch.bfloat16) if t.is_floating_point() else t)(torch.as_tensor(a)))
    def _A_setup():
        B, S, D = 1, 2048, 576
        ks = 4
        return {
            "q": _w((lambda *s: torch.randn(*s, dtype=torch.bfloat16) * 0.05)(B, S, D)),
            "k": _w((lambda *s: torch.randn(*s, dtype=torch.bfloat16) * 0.2)(B, S, D)),
            "v": _w((lambda *s: torch.randn(*s, dtype=torch.bfloat16) * 0.2)(B, S, D)),
            "shift_k": _w((lambda *s: torch.randn(*s, dtype=torch.bfloat16) * 0.2)(D, ks) * 0.5),
            "ssm_k": _w((lambda *s: torch.randn(*s, dtype=torch.bfloat16) * 0.8)(D, S) * (1.0 / S ** 0.5)),
            "ssm_D": _w((lambda *s: torch.randn(*s, dtype=torch.bfloat16) * 0.2)(D)),
        }
    _A_in = _A_setup()

    def _B_setup():
        B, S, D, F = 1, 2048, 576, 4608
        return {
            "x": _w((lambda *s: torch.randn(*s, dtype=torch.bfloat16) * 0.05)(B, S, D)),
            "w1": _w((lambda *s: torch.randn(*s, dtype=torch.bfloat16) * 0.8)(D, F) * (D ** -0.5)),
            "b1": _w((lambda *s: torch.randn(*s, dtype=torch.bfloat16) * 0.2)(F)),
            "w2": _w((lambda *s: torch.randn(*s, dtype=torch.bfloat16) * 0.1)(F, D) * (F ** -0.5)),
        }
    _B_in = _B_setup()

    return {
        "A_q": _A_in["q"],
        "A_k": _A_in["k"],
        "A_v": _A_in["v"],
        "A_shift_k": _A_in["shift_k"],
        "A_ssm_k": _A_in["ssm_k"],
        "A_ssm_D": _A_in["ssm_D"],
        "B_x": _B_in["x"],
        "B_w1": _B_in["w1"],
        "B_b1": _B_in["b1"],
        "B_w2": _B_in["w2"],
    }

def reference(A_q, A_k, A_v, A_shift_k, A_ssm_k, A_ssm_D, B_x, B_w1, B_b1, B_w2):
    def _A_ref(q, k, v, shift_k, ssm_k, ssm_D):
        B, S, D = q.shape
        ks = shift_k.shape[-1]
        k_pad = _pad(k, ((0, 0), (ks - 1, 0), (0, 0)))
        k_shift = torch.zeros_like(k)
        for t in range(ks):
            k_shift = k_shift + k_pad[:, t:t + S, :] * shift_k[:, ks - 1 - t][None, None, :]
        kv = k_shift * v
        L = 2 * S
        kv_pad = _pad(kv, ((0, 0), (0, S), (0, 0)))
        kf_pad = _pad(ssm_k, ((0, 0), (0, S)))
        kv_f = (lambda x, axes=(-2,-1): torch.fft.rfft2(x.float(), dim=axes))(kv_pad[:, None, :, :], axes=(1, 2))
        kf_f = (lambda x, axes=(-2,-1): torch.fft.rfft2(x.float(), dim=axes))(kf_pad[:, None, :], axes=(1, 2))
        kf_f = (lambda x, *d: x.permute(*d))(kf_f, 1, 2, 0)
        y_f = kv_f * kf_f[None, :, :, :]
        y = (lambda x, s, axes=(-2,-1): torch.fft.irfft2(x, s=s, dim=axes).to(torch.bfloat16))(y_f, (1, L), axes=(1, 2))[:, 0, :S, :]
        y = y + kv * ssm_D[None, None, :]
        return q * y

    def _B_ref(x, w1, b1, w2):
        h = torch.einsum("bsd,df->bsf", x, w1) + b1
        sp = torch.log1p(torch.exp(-torch.abs(h))) + torch.where(h > 0, h, torch.zeros_like(h))
        act = h * torch.tanh(sp)
        return torch.einsum("bsf,fd->bsd", act, w2)

    x = A_q
    h = x + _A_ref(_layernorm(x, axis=-1), A_k, A_v, A_shift_k, A_ssm_k, A_ssm_D)
    h2 = h + _B_ref(_layernorm(h, axis=-1), B_w1, B_b1, B_w2)
    return h2
```

```asm
; @launch kernel=fused_kernel grid=(256,1,1) block=(256,1,1) lds=157696
.amdgcn_target "amdgcn-amd-amdhsa--gfx950"
.text
.globl fused_kernel
.p2align 8
.type fused_kernel,@function
fused_kernel:
s_cmp_ge_u32 s2, 256
s_cbranch_scc1 fused_kernel_done
s_load_dwordx2 s[16:17], s[0:1], 96
s_load_dwordx2 s[18:19], s[0:1], 80
v_lshrrev_b32 v1, 6, v0
v_and_b32 v2, 63, v0
v_readfirstlane_b32 s20, v1
s_cmp_ge_u32 s2, 144
s_cbranch_scc1 fused_kernel_aux
s_load_dwordx4 s[4:7], s[0:1], 0
s_load_dwordx4 s[8:11], s[0:1], 16
s_load_dwordx4 s[12:15], s[0:1], 32
s_and_b32 s21, s20, 1
s_lshl_b32 s21, s21, 6
s_lshr_b32 s23, s2, 4
s_and_b32 s22, s2, 15
v_lshrrev_b32 v5, 3, v2
v_bfe_u32 v6, v2, 4, 1
v_lshlrev_b32 v6, 1, v6
v_and_b32 v4, 7, v2
v_xor_b32 v4, v4, v6
v_lshlrev_b32 v4, 4, v4
v_xor_b32 v4, s21, v4
v_mul_u32_u24 v5, 1152, v5
v_add_u32 v4, v4, v5
s_lshl_b32 s37, s22, 7
s_lshl_b32 s38, s20, 3
s_add_u32 s37, s37, s38
s_mul_i32 s37, s37, 1152
s_lshl_b32 s38, s23, 7
s_add_u32 s37, s37, s38
s_sub_u32 s38, s37, 4608
v_add_u32 v5, s38, v4
v_add_u32 v6, 36864, v5
s_lshl_b32 s36, s20, 10
s_add_u32 s36, s36, 101376
s_lshl_b32 s42, s2, 2
s_add_u32 s42, s42, s20
s_lshl_b32 s41, s42, 12
s_mul_i32 s51, s42, 4096
v_lshlrev_b32 v3, 4, v2
s_lshl_b32 s38, s23, 6
s_lshl_b32 s40, s20, 4
s_add_u32 s38, s38, s40
v_and_b32 v7, 15, v2
v_add_u32 v7, s38, v7
v_lshlrev_b32 v8, 3, v7
s_waitcnt lgkmcnt(0)
s_mov_b32 s24, s6
s_and_b32 s25, s7, 0xffff
s_mov_b32 s26, 2359296
s_mov_b32 s27, 0x20000
s_mov_b32 s28, s8
s_and_b32 s29, s9, 0xffff
s_mov_b32 s30, 2359296
s_mov_b32 s31, 0x20000
s_add_u32 s40, s36, 0
s_mov_b32 m0, s40
s_nop 0
buffer_load_dwordx4 v5, s[24:27], 0 offen lds
s_add_u32 s40, s36, 17408
s_mov_b32 m0, s40
s_add_u32 s39, s37, 0
buffer_load_dwordx4 v4, s[28:31], s39 offen lds
s_add_u32 s40, s36, 4096
s_mov_b32 m0, s40
s_mov_b32 s39, 0
buffer_load_dwordx4 v6, s[24:27], s39 offen lds
s_add_u32 s40, s36, 21504
s_mov_b32 m0, s40
s_add_u32 s39, s37, 36864
buffer_load_dwordx4 v4, s[28:31], s39 offen lds
s_add_u32 s40, s36, 8192
s_mov_b32 m0, s40
s_mov_b32 s39, 36864
buffer_load_dwordx4 v6, s[24:27], s39 offen lds
s_add_u32 s40, s36, 25600
s_mov_b32 m0, s40
s_add_u32 s39, s37, 73728
buffer_load_dwordx4 v4, s[28:31], s39 offen lds
s_add_u32 s40, s36, 12288
s_mov_b32 m0, s40
s_mov_b32 s39, 73728
buffer_load_dwordx4 v6, s[24:27], s39 offen lds
s_add_u32 s40, s36, 29696
s_mov_b32 m0, s40
s_add_u32 s39, s37, 110592
buffer_load_dwordx4 v4, s[28:31], s39 offen lds
s_mov_b32 s44, s10
s_and_b32 s45, s11, 0xffff
s_mov_b32 s46, 4608
s_mov_b32 s47, 0x20000
buffer_load_dwordx2 v[10:11], v8, s[44:47], 0 offen
s_cmp_lg_u32 s20, 0
s_cbranch_scc1 fused_kernel_nok16
s_mov_b32 m0, 117760
s_mov_b32 s39, 110592
buffer_load_dwordx4 v6, s[24:27], s39 offen lds
fused_kernel_nok16:
s_mov_b32 s44, s12
s_and_b32 s45, s13, 0xffff
s_mov_b32 s46, 2359296
s_mov_b32 s47, 0x20000
buffer_load_dwordx4 v[104:107], v3, s[44:47], s41 offen offset:0
buffer_load_dwordx4 v[108:111], v3, s[44:47], s41 offen offset:1024
buffer_load_dwordx4 v[112:115], v3, s[44:47], s41 offen offset:2048
buffer_load_dwordx4 v[116:119], v3, s[44:47], s41 offen offset:3072
s_mov_b32 s79, 7241728
s_load_dword s76, s[16:17], s79
s_lshr_b32 s43, s42, 1
s_lshl_b32 s43, s43, 2
s_load_dword s43, s[14:15], s43
s_mov_b32 s32, s4
s_and_b32 s33, s5, 0xffff
s_mov_b32 s34, 2359296
s_mov_b32 s35, 0x20000
s_add_u32 s40, s36, 33792
s_mov_b32 m0, s40
s_add_u32 s38, s37, 0
buffer_load_dwordx4 v4, s[32:35], s38 offen lds
s_add_u32 s40, s36, 37888
s_mov_b32 m0, s40
s_add_u32 s38, s37, 36864
buffer_load_dwordx4 v4, s[32:35], s38 offen lds
s_add_u32 s40, s36, 41984
s_mov_b32 m0, s40
s_add_u32 s38, s37, 73728
buffer_load_dwordx4 v4, s[32:35], s38 offen lds
s_add_u32 s40, s36, 46080
s_mov_b32 m0, s40
s_add_u32 s38, s37, 110592
buffer_load_dwordx4 v4, s[32:35], s38 offen lds
s_mul_i32 s22, s20, 21248
v_bfe_u32 v14, v2, 2, 2
v_lshrrev_b32 v15, 4, v2
v_lshl_add_u32 v13, v15, 3, v14
v_lshlrev_b32 v13, 7, v13
v_lshrrev_b32 v14, 1, v14
v_and_b32 v15, 1, v15
v_lshl_or_b32 v14, v15, 1, v14
v_xor_b32 v14, s20, v14
v_and_b32 v12, 3, v2
v_lshlrev_b32 v12, 3, v12
v_lshl_add_u32 v14, v14, 5, v12
v_add_u32 v13, v13, v14
v_add_u32 v13, 101376, v13
v_xor_b32 v14, 64, v13
v_lshrrev_b32 v5, 4, v2
s_and_b32 s40, s2, 15
s_lshl_b32 s40, s40, 7
v_lshl_add_u32 v6, v5, 3, s40
v_lshlrev_b32 v6, 1, v6
v_mul_u32_u24 v15, 4096, v7
v_add_u32 v15, v15, v6
v_mov_b32 v16, 0
v_mov_b32 v17, 0
v_mov_b32 v18, 0
v_mov_b32 v19, 0
v_subrev_u32 v20, 32, v2
v_lshrrev_b32 v21, 1, v20
v_mul_u32_u24 v21, 4160, v21
v_and_b32 v22, 1, v2
v_lshl_add_u32 v21, v22, 4, v21
v_add_u32 v21, 4096, v21
v_add_u32 v22, 16640, v3
v_mov_b32 v23, 16640
v_cmp_gt_u32 vcc, 8, v20
s_nop 1
v_cndmask_b32 v23, v23, v21, vcc
v_cmp_gt_u32 vcc, 30, v2
s_nop 1
v_cndmask_b32 v23, v23, v22, vcc
v_add_u32 v23, s22, v23
ds_write_b128 v23, v[16:19]
s_add_u32 s40, s22, 1008
v_sub_u32 v12, s40, v3
s_add_u32 s24, s16, 0
s_addc_u32 s25, s17, 0
s_and_b32 s25, s25, 0xffff
s_mov_b32 s26, 2359296
s_mov_b32 s27, 0x20000
s_add_u32 s28, s16, 2424832
s_addc_u32 s29, s17, 0
s_and_b32 s29, s29, 0xffff
s_mov_b32 s30, 2359296
s_mov_b32 s31, 0x20000
s_waitcnt vmcnt(8) lgkmcnt(0)
s_mul_i32 s76, s76, 1664525
s_add_u32 s76, s76, 1013904223
s_barrier
ds_read_b64_tr_b16 v[16:17], v13 offset:0
ds_read_b64_tr_b16 v[18:19], v13 offset:512
ds_read_b64_tr_b16 v[20:21], v14 offset:1024
ds_read_b64_tr_b16 v[40:41], v13 offset:17408
ds_read_b64_tr_b16 v[42:43], v13 offset:17920
ds_read_b64_tr_b16 v[22:23], v13 offset:4096
ds_read_b64_tr_b16 v[24:25], v13 offset:4608
ds_read_b64_tr_b16 v[26:27], v14 offset:5120
ds_read_b64_tr_b16 v[44:45], v13 offset:21504
ds_read_b64_tr_b16 v[46:47], v13 offset:22016
ds_read_b64_tr_b16 v[28:29], v13 offset:8192
ds_read_b64_tr_b16 v[30:31], v13 offset:8704
ds_read_b64_tr_b16 v[32:33], v14 offset:9216
ds_read_b64_tr_b16 v[48:49], v13 offset:25600
ds_read_b64_tr_b16 v[50:51], v13 offset:26112
ds_read_b64_tr_b16 v[34:35], v13 offset:12288
ds_read_b64_tr_b16 v[36:37], v13 offset:12800
ds_read_b64_tr_b16 v[38:39], v14 offset:13312
ds_read_b64_tr_b16 v[52:53], v13 offset:29696
ds_read_b64_tr_b16 v[54:55], v13 offset:30208
v_alignbit_b32 v10, v10, v10, 16
v_alignbit_b32 v11, v11, v11, 16
s_waitcnt lgkmcnt(15)
v_alignbit_b32 v72, v17, v16, 16
v_alignbit_b32 v73, v18, v17, 16
v_alignbit_b32 v74, v19, v18, 16
v_alignbit_b32 v75, v20, v19, 16
v_alignbit_b32 v76, v21, v20, 16
v_dot2_f32_bf16 v78, v72, v11, 0
v_dot2_f32_bf16 v79, v17, v11, 0
v_dot2_f32_bf16 v80, v73, v11, 0
v_dot2_f32_bf16 v81, v18, v11, 0
v_dot2_f32_bf16 v82, v74, v11, 0
v_dot2_f32_bf16 v83, v19, v11, 0
v_dot2_f32_bf16 v84, v75, v11, 0
v_dot2_f32_bf16 v85, v20, v11, 0
v_dot2_f32_bf16 v78, v73, v10, v78
v_dot2_f32_bf16 v79, v18, v10, v79
v_dot2_f32_bf16 v80, v74, v10, v80
v_dot2_f32_bf16 v81, v19, v10, v81
v_dot2_f32_bf16 v82, v75, v10, v82
v_dot2_f32_bf16 v83, v20, v10, v83
v_dot2_f32_bf16 v84, v76, v10, v84
v_dot2_f32_bf16 v85, v21, v10, v85
v_lshlrev_b32 v72, 16, v40
v_and_b32 v73, 0xffff0000, v40
v_lshlrev_b32 v74, 16, v41
v_and_b32 v75, 0xffff0000, v41
v_mul_f32 v78, v78, v72
v_mul_f32 v79, v79, v73
v_mul_f32 v80, v80, v74
v_mul_f32 v81, v81, v75
v_lshlrev_b32 v72, 16, v42
v_and_b32 v73, 0xffff0000, v42
v_lshlrev_b32 v74, 16, v43
v_and_b32 v75, 0xffff0000, v43
v_mul_f32 v82, v82, v72
v_mul_f32 v83, v83, v73
v_mul_f32 v84, v84, v74
v_mul_f32 v85, v85, v75
v_cvt_pk_bf16_f32 v88, v78, v79
v_cvt_pk_bf16_f32 v89, v80, v81
v_cvt_pk_bf16_f32 v90, v82, v83
v_cvt_pk_bf16_f32 v91, v84, v85
buffer_store_dwordx4 v[88:91], v15, s[24:27], 0 offen offset:0 sc1
s_waitcnt lgkmcnt(10)
v_alignbit_b32 v72, v23, v22, 16
v_alignbit_b32 v73, v24, v23, 16
v_alignbit_b32 v74, v25, v24, 16
v_alignbit_b32 v75, v26, v25, 16
v_alignbit_b32 v76, v27, v26, 16
v_dot2_f32_bf16 v78, v72, v11, 0
v_dot2_f32_bf16 v79, v23, v11, 0
v_dot2_f32_bf16 v80, v73, v11, 0
v_dot2_f32_bf16 v81, v24, v11, 0
v_dot2_f32_bf16 v82, v74, v11, 0
v_dot2_f32_bf16 v83, v25, v11, 0
v_dot2_f32_bf16 v84, v75, v11, 0
v_dot2_f32_bf16 v85, v26, v11, 0
v_dot2_f32_bf16 v78, v73, v10, v78
v_dot2_f32_bf16 v79, v24, v10, v79
v_dot2_f32_bf16 v80, v74, v10, v80
v_dot2_f32_bf16 v81, v25, v10, v81
v_dot2_f32_bf16 v82, v75, v10, v82
v_dot2_f32_bf16 v83, v26, v10, v83
v_dot2_f32_bf16 v84, v76, v10, v84
v_dot2_f32_bf16 v85, v27, v10, v85
v_lshlrev_b32 v72, 16, v44
v_and_b32 v73, 0xffff0000, v44
v_lshlrev_b32 v74, 16, v45
v_and_b32 v75, 0xffff0000, v45
v_mul_f32 v78, v78, v72
v_mul_f32 v79, v79, v73
v_mul_f32 v80, v80, v74
v_mul_f32 v81, v81, v75
v_lshlrev_b32 v72, 16, v46
v_and_b32 v73, 0xffff0000, v46
v_lshlrev_b32 v74, 16, v47
v_and_b32 v75, 0xffff0000, v47
v_mul_f32 v82, v82, v72
v_mul_f32 v83, v83, v73
v_mul_f32 v84, v84, v74
v_mul_f32 v85, v85, v75
v_cvt_pk_bf16_f32 v92, v78, v79
v_cvt_pk_bf16_f32 v93, v80, v81
v_cvt_pk_bf16_f32 v94, v82, v83
v_cvt_pk_bf16_f32 v95, v84, v85
buffer_store_dwordx4 v[92:95], v15, s[24:27], 0 offen offset:64 sc1
s_waitcnt lgkmcnt(5)
v_alignbit_b32 v72, v29, v28, 16
v_alignbit_b32 v73, v30, v29, 16
v_alignbit_b32 v74, v31, v30, 16
v_alignbit_b32 v75, v32, v31, 16
v_alignbit_b32 v76, v33, v32, 16
v_dot2_f32_bf16 v78, v72, v11, 0
v_dot2_f32_bf16 v79, v29, v11, 0
v_dot2_f32_bf16 v80, v73, v11, 0
v_dot2_f32_bf16 v81, v30, v11, 0
v_dot2_f32_bf16 v82, v74, v11, 0
v_dot2_f32_bf16 v83, v31, v11, 0
v_dot2_f32_bf16 v84, v75, v11, 0
v_dot2_f32_bf16 v85, v32, v11, 0
v_dot2_f32_bf16 v78, v73, v10, v78
v_dot2_f32_bf16 v79, v30, v10, v79
v_dot2_f32_bf16 v80, v74, v10, v80
v_dot2_f32_bf16 v81, v31, v10, v81
v_dot2_f32_bf16 v82, v75, v10, v82
v_dot2_f32_bf16 v83, v32, v10, v83
v_dot2_f32_bf16 v84, v76, v10, v84
v_dot2_f32_bf16 v85, v33, v10, v85
v_lshlrev_b32 v72, 16, v48
v_and_b32 v73, 0xffff0000, v48
v_lshlrev_b32 v74, 16, v49
v_and_b32 v75, 0xffff0000, v49
v_mul_f32 v78, v78, v72
v_mul_f32 v79, v79, v73
v_mul_f32 v80, v80, v74
v_mul_f32 v81, v81, v75
v_lshlrev_b32 v72, 16, v50
v_and_b32 v73, 0xffff0000, v50
v_lshlrev_b32 v74, 16, v51
v_and_b32 v75, 0xffff0000, v51
v_mul_f32 v82, v82, v72
v_mul_f32 v83, v83, v73
v_mul_f32 v84, v84, v74
v_mul_f32 v85, v85, v75
v_cvt_pk_bf16_f32 v96, v78, v79
v_cvt_pk_bf16_f32 v97, v80, v81
v_cvt_pk_bf16_f32 v98, v82, v83
v_cvt_pk_bf16_f32 v99, v84, v85
buffer_store_dwordx4 v[96:99], v15, s[24:27], 0 offen offset:128 sc1
s_waitcnt lgkmcnt(0)
v_alignbit_b32 v72, v35, v34, 16
v_alignbit_b32 v73, v36, v35, 16
v_alignbit_b32 v74, v37, v36, 16
v_alignbit_b32 v75, v38, v37, 16
v_alignbit_b32 v76, v39, v38, 16
v_dot2_f32_bf16 v78, v72, v11, 0
v_dot2_f32_bf16 v79, v35, v11, 0
v_dot2_f32_bf16 v80, v73, v11, 0
v_dot2_f32_bf16 v81, v36, v11, 0
v_dot2_f32_bf16 v82, v74, v11, 0
v_dot2_f32_bf16 v83, v37, v11, 0
v_dot2_f32_bf16 v84, v75, v11, 0
v_dot2_f32_bf16 v85, v38, v11, 0
v_dot2_f32_bf16 v78, v73, v10, v78
v_dot2_f32_bf16 v79, v36, v10, v79
v_dot2_f32_bf16 v80, v74, v10, v80
v_dot2_f32_bf16 v81, v37, v10, v81
v_dot2_f32_bf16 v82, v75, v10, v82
v_dot2_f32_bf16 v83, v38, v10, v83
v_dot2_f32_bf16 v84, v76, v10, v84
v_dot2_f32_bf16 v85, v39, v10, v85
v_lshlrev_b32 v72, 16, v52
v_and_b32 v73, 0xffff0000, v52
v_lshlrev_b32 v74, 16, v53
v_and_b32 v75, 0xffff0000, v53
v_mul_f32 v78, v78, v72
v_mul_f32 v79, v79, v73
v_mul_f32 v80, v80, v74
v_mul_f32 v81, v81, v75
v_lshlrev_b32 v72, 16, v54
v_and_b32 v73, 0xffff0000, v54
v_lshlrev_b32 v74, 16, v55
v_and_b32 v75, 0xffff0000, v55
v_mul_f32 v82, v82, v72
v_mul_f32 v83, v83, v73
v_mul_f32 v84, v84, v74
v_mul_f32 v85, v85, v75
v_cvt_pk_bf16_f32 v100, v78, v79
v_cvt_pk_bf16_f32 v101, v80, v81
v_cvt_pk_bf16_f32 v102, v82, v83
v_cvt_pk_bf16_f32 v103, v84, v85
buffer_store_dwordx4 v[100:103], v15, s[24:27], 0 offen offset:192 sc1
s_mov_b32 s38, 0xffff
s_waitcnt vmcnt(8)
v_mov_b32_dpp v120, v106 wave_shr:1 row_mask:0xf bank_mask:0xf bound_ctrl:1
v_mov_b32_dpp v121, v107 wave_shr:1 row_mask:0xf bank_mask:0xf bound_ctrl:1
v_alignbit_b32 v28, v107, v107, 16
v_alignbit_b32 v29, v106, v106, 16
v_alignbit_b32 v30, v105, v105, 16
v_alignbit_b32 v31, v104, v104, 16
ds_write_b128 v12, v[28:31] offset:15552
v_bfi_b32 v24, s38, v107, v106
v_bfi_b32 v25, s38, v106, v105
v_bfi_b32 v26, s38, v105, v104
v_bfi_b32 v27, s38, v104, v121
ds_write_b128 v12, v[24:27] offset:11392
v_alignbit_b32 v20, v106, v106, 16
v_alignbit_b32 v21, v105, v105, 16
v_alignbit_b32 v22, v104, v104, 16
v_alignbit_b32 v23, v121, v121, 16
ds_write_b128 v12, v[20:23] offset:7232
v_bfi_b32 v16, s38, v106, v105
v_bfi_b32 v17, s38, v105, v104
v_bfi_b32 v18, s38, v104, v121
v_bfi_b32 v19, s38, v121, v120
ds_write_b128 v12, v[16:19] offset:3072
v_mov_b32_dpp v122, v106 wave_ror:1 row_mask:0xf bank_mask:0xf
v_mov_b32_dpp v122, v110 wave_shr:1 row_mask:0xf bank_mask:0xf
v_mov_b32_dpp v123, v107 wave_ror:1 row_mask:0xf bank_mask:0xf
v_mov_b32_dpp v123, v111 wave_shr:1 row_mask:0xf bank_mask:0xf
v_alignbit_b32 v44, v111, v111, 16
v_alignbit_b32 v45, v110, v110, 16
v_alignbit_b32 v46, v109, v109, 16
v_alignbit_b32 v47, v108, v108, 16
ds_write_b128 v12, v[44:47] offset:14528
v_bfi_b32 v40, s38, v111, v110
v_bfi_b32 v41, s38, v110, v109
v_bfi_b32 v42, s38, v109, v108
v_bfi_b32 v43, s38, v108, v123
ds_write_b128 v12, v[40:43] offset:10368
v_alignbit_b32 v36, v110, v110, 16
v_alignbit_b32 v37, v109, v109, 16
v_alignbit_b32 v38, v108, v108, 16
v_alignbit_b32 v39, v123, v123, 16
ds_write_b128 v12, v[36:39] offset:6208
v_bfi_b32 v32, s38, v110, v109
v_bfi_b32 v33, s38, v109, v108
v_bfi_b32 v34, s38, v108, v123
v_bfi_b32 v35, s38, v123, v122
ds_write_b128 v12, v[32:35] offset:2048
v_mov_b32_dpp v124, v110 wave_ror:1 row_mask:0xf bank_mask:0xf
v_mov_b32_dpp v124, v114 wave_shr:1 row_mask:0xf bank_mask:0xf
v_mov_b32_dpp v125, v111 wave_ror:1 row_mask:0xf bank_mask:0xf
v_mov_b32_dpp v125, v115 wave_shr:1 row_mask:0xf bank_mask:0xf
v_alignbit_b32 v28, v115, v115, 16
v_alignbit_b32 v29, v114, v114, 16
v_alignbit_b32 v30, v113, v113, 16
v_alignbit_b32 v31, v112, v112, 16
ds_write_b128 v12, v[28:31] offset:13504
v_bfi_b32 v24, s38, v115, v114
v_bfi_b32 v25, s38, v114, v113
v_bfi_b32 v26, s38, v113, v112
v_bfi_b32 v27, s38, v112, v125
ds_write_b128 v12, v[24:27] offset:9344
v_alignbit_b32 v20, v114, v114, 16
v_alignbit_b32 v21, v113, v113, 16
v_alignbit_b32 v22, v112, v112, 16
v_alignbit_b32 v23, v125, v125, 16
ds_write_b128 v12, v[20:23] offset:5184
v_bfi_b32 v16, s38, v114, v113
v_bfi_b32 v17, s38, v113, v112
v_bfi_b32 v18, s38, v112, v125
v_bfi_b32 v19, s38, v125, v124
ds_write_b128 v12, v[16:19] offset:1024
v_mov_b32_dpp v126, v114 wave_ror:1 row_mask:0xf bank_mask:0xf
v_mov_b32_dpp v126, v118 wave_shr:1 row_mask:0xf bank_mask:0xf
v_mov_b32_dpp v127, v115 wave_ror:1 row_mask:0xf bank_mask:0xf
v_mov_b32_dpp v127, v119 wave_shr:1 row_mask:0xf bank_mask:0xf
v_alignbit_b32 v44, v119, v119, 16
v_alignbit_b32 v45, v118, v118, 16
v_alignbit_b32 v46, v117, v117, 16
v_alignbit_b32 v47, v116, v116, 16
ds_write_b128 v12, v[44:47] offset:12480
v_bfi_b32 v40, s38, v119, v118
v_bfi_b32 v41, s38, v118, v117
v_bfi_b32 v42, s38, v117, v116
v_bfi_b32 v43, s38, v116, v127
ds_write_b128 v12, v[40:43] offset:8320
v_alignbit_b32 v36, v118, v118, 16
v_alignbit_b32 v37, v117, v117, 16
v_alignbit_b32 v38, v116, v116, 16
v_alignbit_b32 v39, v127, v127, 16
ds_write_b128 v12, v[36:39] offset:4160
v_bfi_b32 v32, s38, v118, v117
v_bfi_b32 v33, s38, v117, v116
v_bfi_b32 v34, s38, v116, v127
v_bfi_b32 v35, s38, v127, v126
ds_write_b128 v12, v[32:35] offset:0
v_and_b32 v4, 15, v2
v_lshlrev_b32 v6, 5, v4
v_lshl_add_u32 v6, v5, 3, v6
v_and_b32 v7, 3, v4
v_mul_u32_u24 v7, 4160, v7
v_lshrrev_b32 v8, 2, v4
v_lshlrev_b32 v8, 3, v8
v_lshlrev_b32 v9, 4, v5
v_sub_u32 v9, v9, v8
v_add3_u32 v7, v7, v9, s22
v_add_u32 v7, 24, v7
v_lshlrev_b32 v8, 5, v4
v_lshl_add_u32 v8, v5, 4, v8
s_add_u32 s40, s22, 16640
v_add_u32 v8, s40, v8
s_add_u32 s40, s22, 17120
v_add_u32 v9, s40, v6
v_lshlrev_b32 v10, 1, v6
v_add_u32 v10, 84992, v10
s_lshl_b32 s40, s23, 4
v_min_u32 v11, 15, v2
v_add_u32 v11, s40, v11
v_lshlrev_b32 v11, 6, v11
v_add_u32 v11, 38862848, v11
s_waitcnt vmcnt(0)
s_barrier
s_cmp_lg_u32 s20, 0
s_cbranch_scc1 fused_kernel_nof1
s_lshl_b32 s78, s2, 6
s_add_u32 s78, s78, 38862848
v_mov_b32 v60, s78
v_mov_b32 v61, s76
s_mov_b64 exec, 1
global_store_dword v60, v61, s[16:17] sc1
s_mov_b64 exec, -1
fused_kernel_nof1:
ds_read_b64_tr_b16 v[56:57], v13 offset:33792
ds_read_b64_tr_b16 v[58:59], v13 offset:34304
ds_read_b64_tr_b16 v[60:61], v13 offset:37888
ds_read_b64_tr_b16 v[62:63], v13 offset:38400
ds_read_b64_tr_b16 v[64:65], v13 offset:41984
ds_read_b64_tr_b16 v[66:67], v13 offset:42496
ds_read_b64_tr_b16 v[68:69], v13 offset:46080
ds_read_b64_tr_b16 v[70:71], v13 offset:46592
s_waitcnt lgkmcnt(0)
buffer_store_dwordx4 v[56:59], v15, s[28:31], 0 offen offset:0 sc1
buffer_store_dwordx4 v[60:63], v15, s[28:31], 0 offen offset:64 sc1
buffer_store_dwordx4 v[64:67], v15, s[28:31], 0 offen offset:128 sc1
buffer_store_dwordx4 v[68:71], v15, s[28:31], 0 offen offset:192 sc1
s_add_u32 s32, s16, 7143424
s_addc_u32 s33, s17, 0
s_and_b32 s33, s33, 0xffff
s_mov_b32 s34, 16384
s_mov_b32 s35, 0x20000
s_lshl_b32 s74, s2, 2
s_add_u32 s74, s74, s20
s_mov_b32 s77, 400000
fused_kernel_pm1:
global_load_dword v13, v11, s[16:17] sc1
s_waitcnt vmcnt(0)
v_cmp_ne_u32 vcc, s76, v13
s_sub_u32 s77, s77, 1
s_cselect_b64 vcc, 0, vcc
s_cmp_eq_u64 vcc, 0
s_cbranch_scc1 fused_kernel_pmd1
s_mov_b64 exec, vcc
s_branch fused_kernel_pm1
fused_kernel_pmd1:
s_mov_b64 exec, -1
s_lshl_b32 s78, s74, 6
s_add_u32 s78, s78, 39124992
v_mov_b32 v13, s78
v_mov_b32 v14, s76
s_mov_b64 exec, 1
global_store_dword v13, v14, s[16:17] sc1
s_mov_b64 exec, -1
s_add_u32 s40, s22, 17120
s_mov_b32 m0, s40
s_nop 0
buffer_load_dwordx4 v3, s[24:27], s51 offen sc1 lds
buffer_load_dwordx4 v3, s[24:27], s51 offen offset:1024 sc1 lds
buffer_load_dwordx4 v3, s[24:27], s51 offen offset:2048 sc1 lds
buffer_load_dwordx4 v3, s[24:27], s51 offen offset:3072 sc1 lds
s_waitcnt lgkmcnt(0)
ds_read_b64 a[0:1], v7 offset:4032
ds_read_b64 a[2:3], v7 offset:4040
ds_read_b64 a[4:5], v7 offset:3520
ds_read_b64 a[6:7], v7 offset:3528
ds_read_b64 a[8:9], v7 offset:3008
ds_read_b64 a[10:11], v7 offset:3016
ds_read_b64 a[12:13], v7 offset:2496
ds_read_b64 a[14:15], v7 offset:2504
ds_read_b64 a[16:17], v7 offset:1984
ds_read_b64 a[18:19], v7 offset:1992
ds_read_b64 a[20:21], v7 offset:1472
ds_read_b64 a[22:23], v7 offset:1480
ds_read_b64 a[24:25], v7 offset:960
ds_read_b64 a[26:27], v7 offset:968
ds_read_b64 a[28:29], v7 offset:448
ds_read_b64 a[30:31], v7 offset:456
s_and_b32 s38, s20, 1
s_lshl_b32 s38, s38, 5
v_min_u32 v11, 31, v2
v_add_u32 v11, s38, v11
v_lshlrev_b32 v11, 6, v11
v_add_u32 v11, 38928384, v11
v_subrev_u32 v12, 32, v2
v_min_u32 v12, 15, v12
s_lshl_b32 s38, s23, 4
v_add_u32 v12, s38, v12
v_lshlrev_b32 v12, 2, v12
s_bfe_u32 s38, s2, 0x20002
v_add_u32 v12, s38, v12
v_lshlrev_b32 v12, 6, v12
v_add_u32 v12, 39124992, v12
v_cmp_gt_u32 vcc, 32, v2
s_nop 1
v_cndmask_b32 v11, v12, v11, vcc
s_and_b32 s38, s42, 1
s_lshl_b32 s38, s38, 4
s_lshr_b32 s43, s43, s38
s_lshl_b32 s43, s43, 16
s_waitcnt vmcnt(0) lgkmcnt(0)
ds_read_b128 a[64:67], v8 offset:448
ds_read_b128 a[68:71], v8 offset:960
ds_read_b128 a[72:75], v8 offset:1472
ds_read_b128 a[76:79], v8 offset:1984
ds_read_b128 a[80:83], v8 offset:2496
ds_read_b128 a[84:87], v8 offset:3008
ds_read_b128 a[88:91], v8 offset:3520
ds_read_b128 a[92:95], v8 offset:4032
s_waitcnt lgkmcnt(0)
v_mfma_f32_16x16x32_bf16 v[144:147], a[0:3], a[64:67], 0
ds_read_b64 a[32:33], v7 offset:3968
v_mfma_f32_16x16x32_bf16 v[148:151], a[4:7], a[64:67], 0
ds_read_b64 a[34:35], v7 offset:3976
v_mfma_f32_16x16x32_bf16 v[152:155], a[8:11], a[64:67], 0
ds_read_b128 a[96:99], v8 offset:384
v_mfma_f32_16x16x32_bf16 v[156:159], a[12:15], a[64:67], 0
ds_read_b64 a[36:37], v7 offset:3456
v_mfma_f32_16x16x32_bf16 v[160:163], a[16:19], a[64:67], 0
ds_read_b64 a[38:39], v7 offset:3464
v_mfma_f32_16x16x32_bf16 v[164:167], a[20:23], a[64:67], 0
ds_read_b128 a[100:103], v8 offset:896
v_mfma_f32_16x16x32_bf16 v[168:171], a[24:27], a[64:67], 0
ds_read_b64 a[40:41], v7 offset:2944
v_mfma_f32_16x16x32_bf16 v[172:175], a[28:31], a[64:67], 0
ds_read_b64 a[42:43], v7 offset:2952
v_mfma_f32_16x16x32_bf16 v[148:151], a[0:3], a[68:71], v[148:151]
ds_read_b128 a[104:107], v8 offset:1408
v_mfma_f32_16x16x32_bf16 v[152:155], a[4:7], a[68:71], v[152:155]
ds_read_b64 a[44:45], v7 offset:2432
v_mfma_f32_16x16x32_bf16 v[156:159], a[8:11], a[68:71], v[156:159]
ds_read_b64 a[46:47], v7 offset:2440
v_mfma_f32_16x16x32_bf16 v[160:163], a[12:15], a[68:71], v[160:163]
ds_read_b128 a[108:111], v8 offset:1920
v_mfma_f32_16x16x32_bf16 v[164:167], a[16:19], a[68:71], v[164:167]
ds_read_b64 a[48:49], v7 offset:1920
v_mfma_f32_16x16x32_bf16 v[168:171], a[20:23], a[68:71], v[168:171]
ds_read_b64 a[50:51], v7 offset:1928
v_mfma_f32_16x16x32_bf16 v[172:175], a[24:27], a[68:71], v[172:175]
ds_read_b128 a[112:115], v8 offset:2432
v_mfma_f32_16x16x32_bf16 v[152:155], a[0:3], a[72:75], v[152:155]
ds_read_b64 a[52:53], v7 offset:1408
v_mfma_f32_16x16x32_bf16 v[156:159], a[4:7], a[72:75], v[156:159]
ds_read_b64 a[54:55], v7 offset:1416
v_mfma_f32_16x16x32_bf16 v[160:163], a[8:11], a[72:75], v[160:163]
ds_read_b128 a[116:119], v8 offset:2944
v_mfma_f32_16x16x32_bf16 v[164:167], a[12:15], a[72:75], v[164:167]
ds_read_b64 a[56:57], v7 offset:896
v_mfma_f32_16x16x32_bf16 v[168:171], a[16:19], a[72:75], v[168:171]
ds_read_b64 a[58:59], v7 offset:904
v_mfma_f32_16x16x32_bf16 v[172:175], a[20:23], a[72:75], v[172:175]
ds_read_b128 a[120:123], v8 offset:3456
v_mfma_f32_16x16x32_bf16 v[156:159], a[0:3], a[76:79], v[156:159]
ds_read_b64 a[60:61], v7 offset:384
v_mfma_f32_16x16x32_bf16 v[160:163], a[4:7], a[76:79], v[160:163]
ds_read_b64 a[62:63], v7 offset:392
v_mfma_f32_16x16x32_bf16 v[164:167], a[8:11], a[76:79], v[164:167]
ds_read_b128 a[124:127], v8 offset:3968
v_mfma_f32_16x16x32_bf16 v[168:171], a[12:15], a[76:79], v[168:171]
v_mfma_f32_16x16x32_bf16 v[172:175], a[16:19], a[76:79], v[172:175]
v_mfma_f32_16x16x32_bf16 v[160:163], a[0:3], a[80:83], v[160:163]
v_mfma_f32_16x16x32_bf16 v[164:167], a[4:7], a[80:83], v[164:167]
v_mfma_f32_16x16x32_bf16 v[168:171], a[8:11], a[80:83], v[168:171]
v_mfma_f32_16x16x32_bf16 v[172:175], a[12:15], a[80:83], v[172:175]
v_mfma_f32_16x16x32_bf16 v[164:167], a[0:3], a[84:87], v[164:167]
v_mfma_f32_16x16x32_bf16 v[168:171], a[4:7], a[84:87], v[168:171]
v_mfma_f32_16x16x32_bf16 v[172:175], a[8:11], a[84:87], v[172:175]
v_mfma_f32_16x16x32_bf16 v[168:171], a[0:3], a[88:91], v[168:171]
v_mfma_f32_16x16x32_bf16 v[172:175], a[4:7], a[88:91], v[172:175]
v_mfma_f32_16x16x32_bf16 v[172:175], a[0:3], a[92:95], v[172:175]
s_waitcnt lgkmcnt(0)
v_mfma_f32_16x16x32_bf16 v[144:147], a[32:35], a[96:99], v[144:147]
ds_read_b64 a[0:1], v7 offset:3904
v_mfma_f32_16x16x32_bf16 v[148:151], a[36:39], a[96:99], v[148:151]
ds_read_b64 a[2:3], v7 offset:3912
v_mfma_f32_16x16x32_bf16 v[152:155], a[40:43], a[96:99], v[152:155]
ds_read_b128 a[64:67], v8 offset:320
v_mfma_f32_16x16x32_bf16 v[156:159], a[44:47], a[96:99], v[156:159]
ds_read_b64 a[4:5], v7 offset:3392
v_mfma_f32_16x16x32_bf16 v[160:163], a[48:51], a[96:99], v[160:163]
ds_read_b64 a[6:7], v7 offset:3400
v_mfma_f32_16x16x32_bf16 v[164:167], a[52:55], a[96:99], v[164:167]
ds_read_b128 a[68:71], v8 offset:832
v_mfma_f32_16x16x32_bf16 v[168:171], a[56:59], a[96:99], v[168:171]
ds_read_b64 a[8:9], v7 offset:2880
v_mfma_f32_16x16x32_bf16 v[172:175], a[60:63], a[96:99], v[172:175]
ds_read_b64 a[10:11], v7 offset:2888
v_mfma_f32_16x16x32_bf16 v[148:151], a[32:35], a[100:103], v[148:151]
ds_read_b128 a[72:75], v8 offset:1344
v_mfma_f32_16x16x32_bf16 v[152:155], a[36:39], a[100:103], v[152:155]
ds_read_b64 a[12:13], v7 offset:2368
v_mfma_f32_16x16x32_bf16 v[156:159], a[40:43], a[100:103], v[156:159]
ds_read_b64 a[14:15], v7 offset:2376
v_mfma_f32_16x16x32_bf16 v[160:163], a[44:47], a[100:103], v[160:163]
ds_read_b128 a[76:79], v8 offset:1856
v_mfma_f32_16x16x32_bf16 v[164:167], a[48:51], a[100:103], v[164:167]
ds_read_b64 a[16:17], v7 offset:1856
v_mfma_f32_16x16x32_bf16 v[168:171], a[52:55], a[100:103], v[168:171]
ds_read_b64 a[18:19], v7 offset:1864
v_mfma_f32_16x16x32_bf16 v[172:175], a[56:59], a[100:103], v[172:175]
ds_read_b128 a[80:83], v8 offset:2368
v_mfma_f32_16x16x32_bf16 v[152:155], a[32:35], a[104:107], v[152:155]
ds_read_b64 a[20:21], v7 offset:1344
v_mfma_f32_16x16x32_bf16 v[156:159], a[36:39], a[104:107], v[156:159]
ds_read_b64 a[22:23], v7 offset:1352
v_mfma_f32_16x16x32_bf16 v[160:163], a[40:43], a[104:107], v[160:163]
ds_read_b128 a[84:87], v8 offset:2880
v_mfma_f32_16x16x32_bf16 v[164:167], a[44:47], a[104:107], v[164:167]
ds_read_b64 a[24:25], v7 offset:832
v_mfma_f32_16x16x32_bf16 v[168:171], a[48:51], a[104:107], v[168:171]
ds_read_b64 a[26:27], v7 offset:840
v_mfma_f32_16x16x32_bf16 v[172:175], a[52:55], a[104:107], v[172:175]
ds_read_b128 a[88:91], v8 offset:3392
v_mfma_f32_16x16x32_bf16 v[156:159], a[32:35], a[108:111], v[156:159]
ds_read_b64 a[28:29], v7 offset:320
v_mfma_f32_16x16x32_bf16 v[160:163], a[36:39], a[108:111], v[160:163]
ds_read_b64 a[30:31], v7 offset:328
v_mfma_f32_16x16x32_bf16 v[164:167], a[40:43], a[108:111], v[164:167]
ds_read_b128 a[92:95], v8 offset:3904
v_mfma_f32_16x16x32_bf16 v[168:171], a[44:47], a[108:111], v[168:171]
v_mfma_f32_16x16x32_bf16 v[172:175], a[48:51], a[108:111], v[172:175]
v_mfma_f32_16x16x32_bf16 v[160:163], a[32:35], a[112:115], v[160:163]
v_mfma_f32_16x16x32_bf16 v[164:167], a[36:39], a[112:115], v[164:167]
v_mfma_f32_16x16x32_bf16 v[168:171], a[40:43], a[112:115], v[168:171]
v_mfma_f32_16x16x32_bf16 v[172:175], a[44:47], a[112:115], v[172:175]
v_mfma_f32_16x16x32_bf16 v[164:167], a[32:35], a[116:119], v[164:167]
v_mfma_f32_16x16x32_bf16 v[168:171], a[36:39], a[116:119], v[168:171]
v_mfma_f32_16x16x32_bf16 v[172:175], a[40:43], a[116:119], v[172:175]
v_mfma_f32_16x16x32_bf16 v[168:171], a[32:35], a[120:123], v[168:171]
v_mfma_f32_16x16x32_bf16 v[172:175], a[36:39], a[120:123], v[172:175]
v_mfma_f32_16x16x32_bf16 v[172:175], a[32:35], a[124:127], v[172:175]
global_load_dword v13, v11, s[16:17] sc1
s_waitcnt lgkmcnt(0)
v_mfma_f32_16x16x32_bf16 v[144:147], a[0:3], a[64:67], v[144:147]
ds_read_b64 a[32:33], v7 offset:3840
v_mfma_f32_16x16x32_bf16 v[148:151], a[4:7], a[64:67], v[148:151]
ds_read_b64 a[34:35], v7 offset:3848
v_mfma_f32_16x16x32_bf16 v[152:155], a[8:11], a[64:67], v[152:155]
ds_read_b128 a[96:99], v8 offset:256
v_mfma_f32_16x16x32_bf16 v[156:159], a[12:15], a[64:67], v[156:159]
ds_read_b64 a[36:37], v7 offset:3328
v_mfma_f32_16x16x32_bf16 v[160:163], a[16:19], a[64:67], v[160:163]
ds_read_b64 a[38:39], v7 offset:3336
v_mfma_f32_16x16x32_bf16 v[164:167], a[20:23], a[64:67], v[164:167]
ds_read_b128 a[100:103], v8 offset:768
v_mfma_f32_16x16x32_bf16 v[168:171], a[24:27], a[64:67], v[168:171]
ds_read_b64 a[40:41], v7 offset:2816
v_mfma_f32_16x16x32_bf16 v[172:175], a[28:31], a[64:67], v[172:175]
ds_read_b64 a[42:43], v7 offset:2824
v_mfma_f32_16x16x32_bf16 v[148:151], a[0:3], a[68:71], v[148:151]
ds_read_b128 a[104:107], v8 offset:1280
v_mfma_f32_16x16x32_bf16 v[152:155], a[4:7], a[68:71], v[152:155]
ds_read_b64 a[44:45], v7 offset:2304
v_mfma_f32_16x16x32_bf16 v[156:159], a[8:11], a[68:71], v[156:159]
ds_read_b64 a[46:47], v7 offset:2312
v_mfma_f32_16x16x32_bf16 v[160:163], a[12:15], a[68:71], v[160:163]
ds_read_b128 a[108:111], v8 offset:1792
v_mfma_f32_16x16x32_bf16 v[164:167], a[16:19], a[68:71], v[164:167]
ds_read_b64 a[48:49], v7 offset:1792
v_mfma_f32_16x16x32_bf16 v[168:171], a[20:23], a[68:71], v[168:171]
ds_read_b64 a[50:51], v7 offset:1800
v_mfma_f32_16x16x32_bf16 v[172:175], a[24:27], a[68:71], v[172:175]
ds_read_b128 a[112:115], v8 offset:2304
v_mfma_f32_16x16x32_bf16 v[152:155], a[0:3], a[72:75], v[152:155]
ds_read_b64 a[52:53], v7 offset:1280
v_mfma_f32_16x16x32_bf16 v[156:159], a[4:7], a[72:75], v[156:159]
ds_read_b64 a[54:55], v7 offset:1288
v_mfma_f32_16x16x32_bf16 v[160:163], a[8:11], a[72:75], v[160:163]
ds_read_b128 a[116:119], v8 offset:2816
v_mfma_f32_16x16x32_bf16 v[164:167], a[12:15], a[72:75], v[164:167]
ds_read_b64 a[56:57], v7 offset:768
v_mfma_f32_16x16x32_bf16 v[168:171], a[16:19], a[72:75], v[168:171]
ds_read_b64 a[58:59], v7 offset:776
v_mfma_f32_16x16x32_bf16 v[172:175], a[20:23], a[72:75], v[172:175]
ds_read_b128 a[120:123], v8 offset:3328
v_mfma_f32_16x16x32_bf16 v[156:159], a[0:3], a[76:79], v[156:159]
ds_read_b64 a[60:61], v7 offset:256
v_mfma_f32_16x16x32_bf16 v[160:163], a[4:7], a[76:79], v[160:163]
ds_read_b64 a[62:63], v7 offset:264
v_mfma_f32_16x16x32_bf16 v[164:167], a[8:11], a[76:79], v[164:167]
ds_read_b128 a[124:127], v8 offset:3840
v_mfma_f32_16x16x32_bf16 v[168:171], a[12:15], a[76:79], v[168:171]
v_mfma_f32_16x16x32_bf16 v[172:175], a[16:19], a[76:79], v[172:175]
v_mfma_f32_16x16x32_bf16 v[160:163], a[0:3], a[80:83], v[160:163]
v_mfma_f32_16x16x32_bf16 v[164:167], a[4:7], a[80:83], v[164:167]
v_mfma_f32_16x16x32_bf16 v[168:171], a[8:11], a[80:83], v[168:171]
v_mfma_f32_16x16x32_bf16 v[172:175], a[12:15], a[80:83], v[172:175]
v_mfma_f32_16x16x32_bf16 v[164:167], a[0:3], a[84:87], v[164:167]
v_mfma_f32_16x16x32_bf16 v[168:171], a[4:7], a[84:87], v[168:171]
v_mfma_f32_16x16x32_bf16 v[172:175], a[8:11], a[84:87], v[172:175]
v_mfma_f32_16x16x32_bf16 v[168:171], a[0:3], a[88:91], v[168:171]
v_mfma_f32_16x16x32_bf16 v[172:175], a[4:7], a[88:91], v[172:175]
v_mfma_f32_16x16x32_bf16 v[172:175], a[0:3], a[92:95], v[172:175]
s_waitcnt vmcnt(0)
s_mov_b32 s77, 400000
s_branch fused_kernel_pollc2
fused_kernel_poll2:
global_load_dword v13, v11, s[16:17] sc1
s_waitcnt vmcnt(0)
fused_kernel_pollc2:
v_xor_b32 v13, s76, v13
v_cmp_ne_u32 vcc, 0, v13
s_sub_u32 s77, s77, 1
s_cselect_b64 vcc, 0, vcc
s_cmp_lg_u64 vcc, 0
s_cbranch_scc1 fused_kernel_poll2
buffer_load_dwordx2 v[80:81], v6, s[28:31], s51 offen offset:0 sc1
buffer_load_dwordx2 v[82:83], v6, s[28:31], s51 offen offset:512 sc1
buffer_load_dwordx2 v[84:85], v6, s[28:31], s51 offen offset:1024 sc1
buffer_load_dwordx2 v[86:87], v6, s[28:31], s51 offen offset:1536 sc1
buffer_load_dwordx2 v[88:89], v6, s[28:31], s51 offen offset:2048 sc1
buffer_load_dwordx2 v[90:91], v6, s[28:31], s51 offen offset:2560 sc1
buffer_load_dwordx2 v[92:93], v6, s[28:31], s51 offen offset:3072 sc1
buffer_load_dwordx2 v[94:95], v6, s[28:31], s51 offen offset:3584 sc1
s_lshl_b32 s39, s20, 12
s_add_u32 s40, s39, 84992
s_mov_b32 m0, s40
s_nop 0
buffer_load_dwordx4 v3, s[32:35], s39 offen sc1 lds
buffer_load_dwordx4 v3, s[32:35], s39 offen offset:1024 sc1 lds
buffer_load_dwordx4 v3, s[32:35], s39 offen offset:2048 sc1 lds
buffer_load_dwordx4 v3, s[32:35], s39 offen offset:3072 sc1 lds
s_waitcnt lgkmcnt(0)
v_mfma_f32_16x16x32_bf16 v[144:147], a[32:35], a[96:99], v[144:147]
ds_read_b64 a[0:1], v7 offset:3776
v_mfma_f32_16x16x32_bf16 v[148:151], a[36:39], a[96:99], v[148:151]
ds_read_b64 a[2:3], v7 offset:3784
v_mfma_f32_16x16x32_bf16 v[152:155], a[40:43], a[96:99], v[152:155]
ds_read_b128 a[64:67], v8 offset:192
v_mfma_f32_16x16x32_bf16 v[156:159], a[44:47], a[96:99], v[156:159]
ds_read_b64 a[4:5], v7 offset:3264
v_mfma_f32_16x16x32_bf16 v[160:163], a[48:51], a[96:99], v[160:163]
ds_read_b64 a[6:7], v7 offset:3272
v_mfma_f32_16x16x32_bf16 v[164:167], a[52:55], a[96:99], v[164:167]
ds_read_b128 a[68:71], v8 offset:704
v_mfma_f32_16x16x32_bf16 v[168:171], a[56:59], a[96:99], v[168:171]
ds_read_b64 a[8:9], v7 offset:2752
v_mfma_f32_16x16x32_bf16 v[172:175], a[60:63], a[96:99], v[172:175]
ds_read_b64 a[10:11], v7 offset:2760
v_mfma_f32_16x16x32_bf16 v[148:151], a[32:35], a[100:103], v[148:151]
ds_read_b128 a[72:75], v8 offset:1216
v_mfma_f32_16x16x32_bf16 v[152:155], a[36:39], a[100:103], v[152:155]
ds_read_b64 a[12:13], v7 offset:2240
v_mfma_f32_16x16x32_bf16 v[156:159], a[40:43], a[100:103], v[156:159]
ds_read_b64 a[14:15], v7 offset:2248
v_mfma_f32_16x16x32_bf16 v[160:163], a[44:47], a[100:103], v[160:163]
ds_read_b128 a[76:79], v8 offset:1728
v_mfma_f32_16x16x32_bf16 v[164:167], a[48:51], a[100:103], v[164:167]
ds_read_b64 a[16:17], v7 offset:1728
v_mfma_f32_16x16x32_bf16 v[168:171], a[52:55], a[100:103], v[168:171]
ds_read_b64 a[18:19], v7 offset:1736
v_mfma_f32_16x16x32_bf16 v[172:175], a[56:59], a[100:103], v[172:175]
ds_read_b128 a[80:83], v8 offset:2240
v_mfma_f32_16x16x32_bf16 v[152:155], a[32:35], a[104:107], v[152:155]
ds_read_b64 a[20:21], v7 offset:1216
v_mfma_f32_16x16x32_bf16 v[156:159], a[36:39], a[104:107], v[156:159]
ds_read_b64 a[22:23], v7 offset:1224
v_mfma_f32_16x16x32_bf16 v[160:163], a[40:43], a[104:107], v[160:163]
ds_read_b128 a[84:87], v8 offset:2752
v_mfma_f32_16x16x32_bf16 v[164:167], a[44:47], a[104:107], v[164:167]
ds_read_b64 a[24:25], v7 offset:704
v_mfma_f32_16x16x32_bf16 v[168:171], a[48:51], a[104:107], v[168:171]
ds_read_b64 a[26:27], v7 offset:712
v_mfma_f32_16x16x32_bf16 v[172:175], a[52:55], a[104:107], v[172:175]
ds_read_b128 a[88:91], v8 offset:3264
v_mfma_f32_16x16x32_bf16 v[156:159], a[32:35], a[108:111], v[156:159]
ds_read_b64 a[28:29], v7 offset:192
v_mfma_f32_16x16x32_bf16 v[160:163], a[36:39], a[108:111], v[160:163]
ds_read_b64 a[30:31], v7 offset:200
v_mfma_f32_16x16x32_bf16 v[164:167], a[40:43], a[108:111], v[164:167]
ds_read_b128 a[92:95], v8 offset:3776
v_mfma_f32_16x16x32_bf16 v[168:171], a[44:47], a[108:111], v[168:171]
v_mfma_f32_16x16x32_bf16 v[172:175], a[48:51], a[108:111], v[172:175]
v_mfma_f32_16x16x32_bf16 v[160:163], a[32:35], a[112:115], v[160:163]
v_mfma_f32_16x16x32_bf16 v[164:167], a[36:39], a[112:115], v[164:167]
v_mfma_f32_16x16x32_bf16 v[168:171], a[40:43], a[112:115], v[168:171]
v_mfma_f32_16x16x32_bf16 v[172:175], a[44:47], a[112:115], v[172:175]
v_mfma_f32_16x16x32_bf16 v[164:167], a[32:35], a[116:119], v[164:167]
v_mfma_f32_16x16x32_bf16 v[168:171], a[36:39], a[116:119], v[168:171]
v_mfma_f32_16x16x32_bf16 v[172:175], a[40:43], a[116:119], v[172:175]
v_mfma_f32_16x16x32_bf16 v[168:171], a[32:35], a[120:123], v[168:171]
v_mfma_f32_16x16x32_bf16 v[172:175], a[36:39], a[120:123], v[172:175]
v_mfma_f32_16x16x32_bf16 v[172:175], a[32:35], a[124:127], v[172:175]
s_waitcnt lgkmcnt(0)
v_mfma_f32_16x16x32_bf16 v[144:147], a[0:3], a[64:67], v[144:147]
ds_read_b64 a[32:33], v7 offset:3712
v_mfma_f32_16x16x32_bf16 v[148:151], a[4:7], a[64:67], v[148:151]
ds_read_b64 a[34:35], v7 offset:3720
v_mfma_f32_16x16x32_bf16 v[152:155], a[8:11], a[64:67], v[152:155]
ds_read_b128 a[96:99], v8 offset:128
v_mfma_f32_16x16x32_bf16 v[156:159], a[12:15], a[64:67], v[156:159]
ds_read_b64 a[36:37], v7 offset:3200
v_mfma_f32_16x16x32_bf16 v[160:163], a[16:19], a[64:67], v[160:163]
ds_read_b64 a[38:39], v7 offset:3208
v_mfma_f32_16x16x32_bf16 v[164:167], a[20:23], a[64:67], v[164:167]
ds_read_b128 a[100:103], v8 offset:640
v_mfma_f32_16x16x32_bf16 v[168:171], a[24:27], a[64:67], v[168:171]
ds_read_b64 a[40:41], v7 offset:2688
v_mfma_f32_16x16x32_bf16 v[172:175], a[28:31], a[64:67], v[172:175]
ds_read_b64 a[42:43], v7 offset:2696
v_mfma_f32_16x16x32_bf16 v[148:151], a[0:3], a[68:71], v[148:151]
ds_read_b128 a[104:107], v8 offset:1152
v_mfma_f32_16x16x32_bf16 v[152:155], a[4:7], a[68:71], v[152:155]
ds_read_b64 a[44:45], v7 offset:2176
v_mfma_f32_16x16x32_bf16 v[156:159], a[8:11], a[68:71], v[156:159]
ds_read_b64 a[46:47], v7 offset:2184
v_mfma_f32_16x16x32_bf16 v[160:163], a[12:15], a[68:71], v[160:163]
ds_read_b128 a[108:111], v8 offset:1664
v_mfma_f32_16x16x32_bf16 v[164:167], a[16:19], a[68:71], v[164:167]
ds_read_b64 a[48:49], v7 offset:1664
v_mfma_f32_16x16x32_bf16 v[168:171], a[20:23], a[68:71], v[168:171]
ds_read_b64 a[50:51], v7 offset:1672
v_mfma_f32_16x16x32_bf16 v[172:175], a[24:27], a[68:71], v[172:175]
ds_read_b128 a[112:115], v8 offset:2176
v_mfma_f32_16x16x32_bf16 v[152:155], a[0:3], a[72:75], v[152:155]
ds_read_b64 a[52:53], v7 offset:1152
v_mfma_f32_16x16x32_bf16 v[156:159], a[4:7], a[72:75], v[156:159]
ds_read_b64 a[54:55], v7 offset:1160
v_mfma_f32_16x16x32_bf16 v[160:163], a[8:11], a[72:75], v[160:163]
ds_read_b128 a[116:119], v8 offset:2688
v_mfma_f32_16x16x32_bf16 v[164:167], a[12:15], a[72:75], v[164:167]
ds_read_b64 a[56:57], v7 offset:640
v_mfma_f32_16x16x32_bf16 v[168:171], a[16:19], a[72:75], v[168:171]
ds_read_b64 a[58:59], v7 offset:648
v_mfma_f32_16x16x32_bf16 v[172:175], a[20:23], a[72:75], v[172:175]
ds_read_b128 a[120:123], v8 offset:3200
v_mfma_f32_16x16x32_bf16 v[156:159], a[0:3], a[76:79], v[156:159]
ds_read_b64 a[60:61], v7 offset:128
v_mfma_f32_16x16x32_bf16 v[160:163], a[4:7], a[76:79], v[160:163]
ds_read_b64 a[62:63], v7 offset:136
v_mfma_f32_16x16x32_bf16 v[164:167], a[8:11], a[76:79], v[164:167]
ds_read_b128 a[124:127], v8 offset:3712
v_mfma_f32_16x16x32_bf16 v[168:171], a[12:15], a[76:79], v[168:171]
v_mfma_f32_16x16x32_bf16 v[172:175], a[16:19], a[76:79], v[172:175]
v_mfma_f32_16x16x32_bf16 v[160:163], a[0:3], a[80:83], v[160:163]
v_mfma_f32_16x16x32_bf16 v[164:167], a[4:7], a[80:83], v[164:167]
v_mfma_f32_16x16x32_bf16 v[168:171], a[8:11], a[80:83], v[168:171]
v_mfma_f32_16x16x32_bf16 v[172:175], a[12:15], a[80:83], v[172:175]
v_mfma_f32_16x16x32_bf16 v[164:167], a[0:3], a[84:87], v[164:167]
v_mfma_f32_16x16x32_bf16 v[168:171], a[4:7], a[84:87], v[168:171]
v_mfma_f32_16x16x32_bf16 v[172:175], a[8:11], a[84:87], v[172:175]
v_mfma_f32_16x16x32_bf16 v[168:171], a[0:3], a[88:91], v[168:171]
v_mfma_f32_16x16x32_bf16 v[172:175], a[4:7], a[88:91], v[172:175]
v_mfma_f32_16x16x32_bf16 v[172:175], a[0:3], a[92:95], v[172:175]
s_waitcnt lgkmcnt(0)
s_waitcnt vmcnt(0)
s_barrier
v_mfma_f32_16x16x32_bf16 v[144:147], a[32:35], a[96:99], v[144:147]
ds_read_b64 a[0:1], v7 offset:3648
ds_read_b64 v[96:97], v9 offset:0
ds_read_b128 v[16:19], v10 offset:0
v_mfma_f32_16x16x32_bf16 v[148:151], a[36:39], a[96:99], v[148:151]
ds_read_b64 a[2:3], v7 offset:3656
ds_read_b128 v[48:51], v10 offset:8192
v_mfma_f32_16x16x32_bf16 v[152:155], a[40:43], a[96:99], v[152:155]
ds_read_b128 a[64:67], v8 offset:64
ds_read_b64 v[98:99], v9 offset:512
ds_read_b128 v[20:23], v10 offset:1024
v_mfma_f32_16x16x32_bf16 v[156:159], a[44:47], a[96:99], v[156:159]
ds_read_b64 a[4:5], v7 offset:3136
ds_read_b128 v[52:55], v10 offset:9216
s_waitcnt lgkmcnt(5)
v_lshlrev_b32 v112, 16, v80
v_mfma_f32_16x16x32_bf16 v[160:163], a[48:51], a[96:99], v[160:163]
ds_read_b64 a[6:7], v7 offset:3144
v_and_b32 v113, 0xffff0000, v80
v_mfma_f32_16x16x32_bf16 v[164:167], a[52:55], a[96:99], v[164:167]
ds_read_b128 a[68:71], v8 offset:576
v_lshlrev_b32 v116, 16, v96
v_and_b32 v117, 0xffff0000, v96
v_mfma_f32_16x16x32_bf16 v[168:171], a[56:59], a[96:99], v[168:171]
ds_read_b64 a[8:9], v7 offset:2624
v_lshlrev_b32 v114, 16, v81
v_and_b32 v115, 0xffff0000, v81
v_mfma_f32_16x16x32_bf16 v[172:175], a[60:63], a[96:99], v[172:175]
ds_read_b64 a[10:11], v7 offset:2632
v_lshlrev_b32 v118, 16, v97
v_mfma_f32_16x16x32_bf16 v[148:151], a[32:35], a[100:103], v[148:151]
ds_read_b128 a[72:75], v8 offset:1088
v_and_b32 v119, 0xffff0000, v97
v_fma_f32 v16, v112, v16, v48
v_mfma_f32_16x16x32_bf16 v[152:155], a[36:39], a[100:103], v[152:155]
ds_read_b64 a[12:13], v7 offset:2112
v_fma_f32 v17, v113, v17, v49
v_fma_f32 v18, v114, v18, v50
v_mfma_f32_16x16x32_bf16 v[156:159], a[40:43], a[100:103], v[156:159]
ds_read_b64 a[14:15], v7 offset:2120
v_fma_f32 v19, v115, v19, v51
v_mfma_f32_16x16x32_bf16 v[160:163], a[44:47], a[100:103], v[160:163]
ds_read_b128 a[76:79], v8 offset:1600
v_mul_f32 v116, s43, v116
v_mul_f32 v117, s43, v117
v_mfma_f32_16x16x32_bf16 v[164:167], a[48:51], a[100:103], v[164:167]
ds_read_b64 a[16:17], v7 offset:1600
v_mul_f32 v118, s43, v118
v_mul_f32 v119, s43, v119
v_mfma_f32_16x16x32_bf16 v[168:171], a[52:55], a[100:103], v[168:171]
ds_read_b64 a[18:19], v7 offset:1608
v_fma_f32 v48, v16, v116, v112
v_mfma_f32_16x16x32_bf16 v[172:175], a[56:59], a[100:103], v[172:175]
ds_read_b128 a[80:83], v8 offset:2112
v_fma_f32 v49, v17, v117, v113
v_fma_f32 v50, v18, v118, v114
v_mfma_f32_16x16x32_bf16 v[152:155], a[32:35], a[104:107], v[152:155]
ds_read_b64 a[20:21], v7 offset:1088
v_fma_f32 v51, v19, v119, v115
ds_read_b64 v[100:101], v9 offset:1024
v_mfma_f32_16x16x32_bf16 v[156:159], a[36:39], a[104:107], v[156:159]
ds_read_b64 a[22:23], v7 offset:1096
ds_read_b128 v[24:27], v10 offset:2048
v_mfma_f32_16x16x32_bf16 v[160:163], a[40:43], a[104:107], v[160:163]
ds_read_b128 a[84:87], v8 offset:2624
ds_read_b128 v[56:59], v10 offset:10240
s_waitcnt lgkmcnt(15)
v_lshlrev_b32 v120, 16, v82
v_mfma_f32_16x16x32_bf16 v[164:167], a[44:47], a[104:107], v[164:167]
ds_read_b64 a[24:25], v7 offset:576
v_and_b32 v121, 0xffff0000, v82
v_lshlrev_b32 v124, 16, v98
v_mfma_f32_16x16x32_bf16 v[168:171], a[48:51], a[104:107], v[168:171]
ds_read_b64 a[26:27], v7 offset:584
v_and_b32 v125, 0xffff0000, v98
v_mfma_f32_16x16x32_bf16 v[172:175], a[52:55], a[104:107], v[172:175]
ds_read_b128 a[88:91], v8 offset:3136
v_lshlrev_b32 v122, 16, v83
v_and_b32 v123, 0xffff0000, v83
v_mfma_f32_16x16x32_bf16 v[156:159], a[32:35], a[108:111], v[156:159]
ds_read_b64 a[28:29], v7 offset:64
v_lshlrev_b32 v126, 16, v99
v_mfma_f32_16x16x32_bf16 v[160:163], a[36:39], a[108:111], v[160:163]
ds_read_b64 a[30:31], v7 offset:72
v_and_b32 v127, 0xffff0000, v99
v_mfma_f32_16x16x32_bf16 v[164:167], a[40:43], a[108:111], v[164:167]
ds_read_b128 a[92:95], v8 offset:3648
v_fma_f32 v20, v120, v20, v52
v_mfma_f32_16x16x32_bf16 v[168:171], a[44:47], a[108:111], v[168:171]
v_fma_f32 v21, v121, v21, v53
v_fma_f32 v22, v122, v22, v54
v_mfma_f32_16x16x32_bf16 v[172:175], a[48:51], a[108:111], v[172:175]
v_fma_f32 v23, v123, v23, v55
v_mul_f32 v124, s43, v124
v_mfma_f32_16x16x32_bf16 v[160:163], a[32:35], a[112:115], v[160:163]
v_mul_f32 v125, s43, v125
v_mul_f32 v126, s43, v126
v_mfma_f32_16x16x32_bf16 v[164:167], a[36:39], a[112:115], v[164:167]
v_mul_f32 v127, s43, v127
v_fma_f32 v52, v20, v124, v120
v_mfma_f32_16x16x32_bf16 v[168:171], a[40:43], a[112:115], v[168:171]
v_fma_f32 v53, v21, v125, v121
v_fma_f32 v54, v22, v126, v122
v_mfma_f32_16x16x32_bf16 v[172:175], a[44:47], a[112:115], v[172:175]
v_fma_f32 v55, v23, v127, v123
ds_read_b64 v[102:103], v9 offset:1536
v_mfma_f32_16x16x32_bf16 v[164:167], a[32:35], a[116:119], v[164:167]
ds_read_b128 v[28:31], v10 offset:3072
ds_read_b128 v[60:63], v10 offset:11264
v_mfma_f32_16x16x32_bf16 v[168:171], a[36:39], a[116:119], v[168:171]
s_waitcnt lgkmcnt(9)
v_lshlrev_b32 v112, 16, v84
v_and_b32 v113, 0xffff0000, v84
v_mfma_f32_16x16x32_bf16 v[172:175], a[40:43], a[116:119], v[172:175]
v_lshlrev_b32 v116, 16, v100
v_and_b32 v117, 0xffff0000, v100
v_mfma_f32_16x16x32_bf16 v[168:171], a[32:35], a[120:123], v[168:171]
v_lshlrev_b32 v114, 16, v85
v_and_b32 v115, 0xffff0000, v85
v_mfma_f32_16x16x32_bf16 v[172:175], a[36:39], a[120:123], v[172:175]
v_lshlrev_b32 v118, 16, v101
v_and_b32 v119, 0xffff0000, v101
v_mfma_f32_16x16x32_bf16 v[172:175], a[32:35], a[124:127], v[172:175]
v_fma_f32 v24, v112, v24, v56
v_fma_f32 v25, v113, v25, v57
s_waitcnt lgkmcnt(3)
v_mfma_f32_16x16x32_bf16 v[144:147], a[0:3], a[64:67], v[144:147]
ds_read_b64 a[32:33], v7 offset:3584
v_fma_f32 v26, v114, v26, v58
v_fma_f32 v27, v115, v27, v59
v_mfma_f32_16x16x32_bf16 v[148:151], a[4:7], a[64:67], v[148:151]
ds_read_b64 a[34:35], v7 offset:3592
v_mul_f32 v116, s43, v116
v_mfma_f32_16x16x32_bf16 v[152:155], a[8:11], a[64:67], v[152:155]
ds_read_b128 a[96:99], v8 offset:0
v_mul_f32 v117, s43, v117
v_mul_f32 v118, s43, v118
v_mfma_f32_16x16x32_bf16 v[156:159], a[12:15], a[64:67], v[156:159]
ds_read_b64 a[36:37], v7 offset:3072
v_mul_f32 v119, s43, v119
v_fma_f32 v56, v24, v116, v112
v_mfma_f32_16x16x32_bf16 v[160:163], a[16:19], a[64:67], v[160:163]
ds_read_b64 a[38:39], v7 offset:3080
v_fma_f32 v57, v25, v117, v113
v_mfma_f32_16x16x32_bf16 v[164:167], a[20:23], a[64:67], v[164:167]
ds_read_b128 a[100:103], v8 offset:512
v_fma_f32 v58, v26, v118, v114
v_fma_f32 v59, v27, v119, v115
v_mfma_f32_16x16x32_bf16 v[168:171], a[24:27], a[64:67], v[168:171]
ds_read_b64 a[40:41], v7 offset:2560
ds_read_b64 v[104:105], v9 offset:2048
ds_read_b128 v[32:35], v10 offset:4096
v_mfma_f32_16x16x32_bf16 v[172:175], a[28:31], a[64:67], v[172:175]
ds_read_b64 a[42:43], v7 offset:2568
ds_read_b128 v[64:67], v10 offset:12288
v_mfma_f32_16x16x32_bf16 v[148:151], a[0:3], a[68:71], v[148:151]
ds_read_b128 a[104:107], v8 offset:1024
s_waitcnt lgkmcnt(12)
v_lshlrev_b32 v120, 16, v86
v_and_b32 v121, 0xffff0000, v86
v_mfma_f32_16x16x32_bf16 v[152:155], a[4:7], a[68:71], v[152:155]
ds_read_b64 a[44:45], v7 offset:2048
v_lshlrev_b32 v124, 16, v102
v_and_b32 v125, 0xffff0000, v102
v_mfma_f32_16x16x32_bf16 v[156:159], a[8:11], a[68:71], v[156:159]
ds_read_b64 a[46:47], v7 offset:2056
v_lshlrev_b32 v122, 16, v87
v_mfma_f32_16x16x32_bf16 v[160:163], a[12:15], a[68:71], v[160:163]
ds_read_b128 a[108:111], v8 offset:1536
v_and_b32 v123, 0xffff0000, v87
v_lshlrev_b32 v126, 16, v103
v_mfma_f32_16x16x32_bf16 v[164:167], a[16:19], a[68:71], v[164:167]
ds_read_b64 a[48:49], v7 offset:1536
v_and_b32 v127, 0xffff0000, v103
v_fma_f32 v28, v120, v28, v60
v_mfma_f32_16x16x32_bf16 v[168:171], a[20:23], a[68:71], v[168:171]
ds_read_b64 a[50:51], v7 offset:1544
v_fma_f32 v29, v121, v29, v61
v_mfma_f32_16x16x32_bf16 v[172:175], a[24:27], a[68:71], v[172:175]
ds_read_b128 a[112:115], v8 offset:2048
v_fma_f32 v30, v122, v30, v62
v_fma_f32 v31, v123, v31, v63
v_mfma_f32_16x16x32_bf16 v[152:155], a[0:3], a[72:75], v[152:155]
ds_read_b64 a[52:53], v7 offset:1024
v_mul_f32 v124, s43, v124
v_mul_f32 v125, s43, v125
v_mfma_f32_16x16x32_bf16 v[156:159], a[4:7], a[72:75], v[156:159]
ds_read_b64 a[54:55], v7 offset:1032
v_mul_f32 v126, s43, v126
v_mfma_f32_16x16x32_bf16 v[160:163], a[8:11], a[72:75], v[160:163]
ds_read_b128 a[116:119], v8 offset:2560
v_mul_f32 v127, s43, v127
v_fma_f32 v60, v28, v124, v120
v_mfma_f32_16x16x32_bf16 v[164:167], a[12:15], a[72:75], v[164:167]
ds_read_b64 a[56:57], v7 offset:512
v_fma_f32 v61, v29, v125, v121
v_mfma_f32_16x16x32_bf16 v[168:171], a[16:19], a[72:75], v[168:171]
ds_read_b64 a[58:59], v7 offset:520
v_fma_f32 v62, v30, v126, v122
v_mfma_f32_16x16x32_bf16 v[172:175], a[20:23], a[72:75], v[172:175]
ds_read_b128 a[120:123], v8 offset:3072
v_fma_f32 v63, v31, v127, v123
v_mfma_f32_16x16x32_bf16 v[156:159], a[0:3], a[76:79], v[156:159]
ds_read_b64 a[60:61], v7 offset:0
ds_read_b64 v[106:107], v9 offset:2560
v_mfma_f32_16x16x32_bf16 v[160:163], a[4:7], a[76:79], v[160:163]
ds_read_b64 a[62:63], v7 offset:8
ds_read_b128 v[36:39], v10 offset:5120
v_mfma_f32_16x16x32_bf16 v[164:167], a[8:11], a[76:79], v[164:167]
ds_read_b128 a[124:127], v8 offset:3584
ds_read_b128 v[68:71], v10 offset:13312
v_mfma_f32_16x16x32_bf16 v[168:171], a[12:15], a[76:79], v[168:171]
s_waitcnt lgkmcnt(15)
v_lshlrev_b32 v112, 16, v88
v_and_b32 v113, 0xffff0000, v88
v_mfma_f32_16x16x32_bf16 v[172:175], a[16:19], a[76:79], v[172:175]
v_lshlrev_b32 v116, 16, v104
v_and_b32 v117, 0xffff0000, v104
v_mfma_f32_16x16x32_bf16 v[160:163], a[0:3], a[80:83], v[160:163]
v_lshlrev_b32 v114, 16, v89
v_and_b32 v115, 0xffff0000, v89
v_mfma_f32_16x16x32_bf16 v[164:167], a[4:7], a[80:83], v[164:167]
v_lshlrev_b32 v118, 16, v105
v_and_b32 v119, 0xffff0000, v105
v_mfma_f32_16x16x32_bf16 v[168:171], a[8:11], a[80:83], v[168:171]
v_fma_f32 v32, v112, v32, v64
v_fma_f32 v33, v113, v33, v65
v_mfma_f32_16x16x32_bf16 v[172:175], a[12:15], a[80:83], v[172:175]
v_fma_f32 v34, v114, v34, v66
v_fma_f32 v35, v115, v35, v67
v_mfma_f32_16x16x32_bf16 v[164:167], a[0:3], a[84:87], v[164:167]
v_mul_f32 v116, s43, v116
v_mul_f32 v117, s43, v117
v_mfma_f32_16x16x32_bf16 v[168:171], a[4:7], a[84:87], v[168:171]
v_mul_f32 v118, s43, v118
v_mul_f32 v119, s43, v119
v_mfma_f32_16x16x32_bf16 v[172:175], a[8:11], a[84:87], v[172:175]
v_fma_f32 v64, v32, v116, v112
v_fma_f32 v65, v33, v117, v113
v_mfma_f32_16x16x32_bf16 v[168:171], a[0:3], a[88:91], v[168:171]
v_fma_f32 v66, v34, v118, v114
v_fma_f32 v67, v35, v119, v115
v_mfma_f32_16x16x32_bf16 v[172:175], a[4:7], a[88:91], v[172:175]
ds_read_b64 v[108:109], v9 offset:3072
ds_read_b128 v[40:43], v10 offset:6144
v_mfma_f32_16x16x32_bf16 v[172:175], a[0:3], a[92:95], v[172:175]
ds_read_b128 v[72:75], v10 offset:14336
s_waitcnt lgkmcnt(3)
v_lshlrev_b32 v120, 16, v90
s_waitcnt lgkmcnt(4)
v_mfma_f32_16x16x32_bf16 v[144:147], a[32:35], a[96:99], v[144:147]
v_and_b32 v121, 0xffff0000, v90
v_lshlrev_b32 v124, 16, v106
v_mfma_f32_16x16x32_bf16 v[148:151], a[36:39], a[96:99], v[148:151]
v_and_b32 v125, 0xffff0000, v106
v_mfma_f32_16x16x32_bf16 v[152:155], a[40:43], a[96:99], v[152:155]
v_lshlrev_b32 v122, 16, v91
v_and_b32 v123, 0xffff0000, v91
v_mfma_f32_16x16x32_bf16 v[156:159], a[44:47], a[96:99], v[156:159]
v_lshlrev_b32 v126, 16, v107
v_and_b32 v127, 0xffff0000, v107
v_mfma_f32_16x16x32_bf16 v[160:163], a[48:51], a[96:99], v[160:163]
v_fma_f32 v36, v120, v36, v68
v_fma_f32 v37, v121, v37, v69
v_mfma_f32_16x16x32_bf16 v[164:167], a[52:55], a[96:99], v[164:167]
v_fma_f32 v38, v122, v38, v70
v_mfma_f32_16x16x32_bf16 v[168:171], a[56:59], a[96:99], v[168:171]
v_fma_f32 v39, v123, v39, v71
v_mul_f32 v124, s43, v124
v_mfma_f32_16x16x32_bf16 v[172:175], a[60:63], a[96:99], v[172:175]
v_mul_f32 v125, s43, v125
v_mul_f32 v126, s43, v126
v_mfma_f32_16x16x32_bf16 v[148:151], a[32:35], a[100:103], v[148:151]
v_mul_f32 v127, s43, v127
v_mfma_f32_16x16x32_bf16 v[152:155], a[36:39], a[100:103], v[152:155]
v_fma_f32 v68, v36, v124, v120
v_fma_f32 v69, v37, v125, v121
v_mfma_f32_16x16x32_bf16 v[156:159], a[40:43], a[100:103], v[156:159]
v_fma_f32 v70, v38, v126, v122
v_fma_f32 v71, v39, v127, v123
v_mfma_f32_16x16x32_bf16 v[160:163], a[44:47], a[100:103], v[160:163]
ds_read_b64 v[110:111], v9 offset:3584
ds_read_b128 v[44:47], v10 offset:7168
v_mfma_f32_16x16x32_bf16 v[164:167], a[48:51], a[100:103], v[164:167]
ds_read_b128 v[76:79], v10 offset:15360
v_mfma_f32_16x16x32_bf16 v[168:171], a[52:55], a[100:103], v[168:171]
s_waitcnt lgkmcnt(3)
v_lshlrev_b32 v112, 16, v92
v_and_b32 v113, 0xffff0000, v92
v_mfma_f32_16x16x32_bf16 v[172:175], a[56:59], a[100:103], v[172:175]
v_lshlrev_b32 v116, 16, v108
v_and_b32 v117, 0xffff0000, v108
v_mfma_f32_16x16x32_bf16 v[152:155], a[32:35], a[104:107], v[152:155]
v_lshlrev_b32 v114, 16, v93
v_and_b32 v115, 0xffff0000, v93
v_mfma_f32_16x16x32_bf16 v[156:159], a[36:39], a[104:107], v[156:159]
v_lshlrev_b32 v118, 16, v109
v_mfma_f32_16x16x32_bf16 v[160:163], a[40:43], a[104:107], v[160:163]
v_and_b32 v119, 0xffff0000, v109
v_fma_f32 v40, v112, v40, v72
v_mfma_f32_16x16x32_bf16 v[164:167], a[44:47], a[104:107], v[164:167]
v_fma_f32 v41, v113, v41, v73
v_fma_f32 v42, v114, v42, v74
v_mfma_f32_16x16x32_bf16 v[168:171], a[48:51], a[104:107], v[168:171]
v_fma_f32 v43, v115, v43, v75
v_mfma_f32_16x16x32_bf16 v[172:175], a[52:55], a[104:107], v[172:175]
v_mul_f32 v116, s43, v116
v_mul_f32 v117, s43, v117
v_mfma_f32_16x16x32_bf16 v[156:159], a[32:35], a[108:111], v[156:159]
v_mul_f32 v118, s43, v118
v_mul_f32 v119, s43, v119
v_mfma_f32_16x16x32_bf16 v[160:163], a[36:39], a[108:111], v[160:163]
v_fma_f32 v72, v40, v116, v112
v_fma_f32 v73, v41, v117, v113
v_mfma_f32_16x16x32_bf16 v[164:167], a[40:43], a[108:111], v[164:167]
v_fma_f32 v74, v42, v118, v114
v_mfma_f32_16x16x32_bf16 v[168:171], a[44:47], a[108:111], v[168:171]
v_fma_f32 v75, v43, v119, v115
s_waitcnt lgkmcnt(0)
v_lshlrev_b32 v120, 16, v94
v_mfma_f32_16x16x32_bf16 v[172:175], a[48:51], a[108:111], v[172:175]
v_and_b32 v121, 0xffff0000, v94
v_lshlrev_b32 v124, 16, v110
v_mfma_f32_16x16x32_bf16 v[160:163], a[32:35], a[112:115], v[160:163]
v_and_b32 v125, 0xffff0000, v110
v_mfma_f32_16x16x32_bf16 v[164:167], a[36:39], a[112:115], v[164:167]
v_lshlrev_b32 v122, 16, v95
v_and_b32 v123, 0xffff0000, v95
v_mfma_f32_16x16x32_bf16 v[168:171], a[40:43], a[112:115], v[168:171]
v_lshlrev_b32 v126, 16, v111
v_and_b32 v127, 0xffff0000, v111
v_mfma_f32_16x16x32_bf16 v[172:175], a[44:47], a[112:115], v[172:175]
v_fma_f32 v44, v120, v44, v76
v_fma_f32 v45, v121, v45, v77
v_mfma_f32_16x16x32_bf16 v[164:167], a[32:35], a[116:119], v[164:167]
v_fma_f32 v46, v122, v46, v78
v_mfma_f32_16x16x32_bf16 v[168:171], a[36:39], a[116:119], v[168:171]
v_fma_f32 v47, v123, v47, v79
v_mul_f32 v124, s43, v124
v_mfma_f32_16x16x32_bf16 v[172:175], a[40:43], a[116:119], v[172:175]
v_mul_f32 v125, s43, v125
v_mul_f32 v126, s43, v126
v_mfma_f32_16x16x32_bf16 v[168:171], a[32:35], a[120:123], v[168:171]
v_mul_f32 v127, s43, v127
v_fma_f32 v76, v44, v124, v120
v_mfma_f32_16x16x32_bf16 v[172:175], a[36:39], a[120:123], v[172:175]
v_fma_f32 v77, v45, v125, v121
v_mfma_f32_16x16x32_bf16 v[172:175], a[32:35], a[124:127], v[172:175]
v_fma_f32 v78, v46, v126, v122
v_fma_f32 v79, v47, v127, v123
s_add_u32 s24, s16, 4784128
s_addc_u32 s25, s17, 0
s_and_b32 s25, s25, 0xffff
s_mov_b32 s26, 2359296
s_mov_b32 s27, 0x20000
v_and_b32 v11, 1, v5
v_mul_u32_u24 v11, 504, v11
v_add_u32 v11, v11, v6
v_fma_f32 v144, v16, v144, v48
v_fma_f32 v145, v17, v145, v49
v_fma_f32 v146, v18, v146, v50
v_fma_f32 v147, v19, v147, v51
v_cvt_pk_bf16_f32 v232, v144, v145
v_cvt_pk_bf16_f32 v233, v146, v147
v_fma_f32 v148, v20, v148, v52
v_fma_f32 v149, v21, v149, v53
v_fma_f32 v150, v22, v150, v54
v_fma_f32 v151, v23, v151, v55
v_cvt_pk_bf16_f32 v234, v148, v149
v_cvt_pk_bf16_f32 v235, v150, v151
s_nop 1
v_permlane16_swap_b32 v232, v234
v_permlane16_swap_b32 v233, v235
buffer_store_dwordx4 v[232:235], v11, s[24:27], s51 offen offset:0 sc1
v_fma_f32 v152, v24, v152, v56
v_fma_f32 v153, v25, v153, v57
v_fma_f32 v154, v26, v154, v58
v_fma_f32 v155, v27, v155, v59
v_cvt_pk_bf16_f32 v236, v152, v153
v_cvt_pk_bf16_f32 v237, v154, v155
v_fma_f32 v156, v28, v156, v60
v_fma_f32 v157, v29, v157, v61
v_fma_f32 v158, v30, v158, v62
v_fma_f32 v159, v31, v159, v63
v_cvt_pk_bf16_f32 v238, v156, v157
v_cvt_pk_bf16_f32 v239, v158, v159
s_nop 1
v_permlane16_swap_b32 v236, v238
v_permlane16_swap_b32 v237, v239
buffer_store_dwordx4 v[236:239], v11, s[24:27], s51 offen offset:1024 sc1
v_fma_f32 v160, v32, v160, v64
v_fma_f32 v161, v33, v161, v65
v_fma_f32 v162, v34, v162, v66
v_fma_f32 v163, v35, v163, v67
v_cvt_pk_bf16_f32 v240, v160, v161
v_cvt_pk_bf16_f32 v241, v162, v163
v_fma_f32 v164, v36, v164, v68
v_fma_f32 v165, v37, v165, v69
v_fma_f32 v166, v38, v166, v70
v_fma_f32 v167, v39, v167, v71
v_cvt_pk_bf16_f32 v242, v164, v165
v_cvt_pk_bf16_f32 v243, v166, v167
s_nop 1
v_permlane16_swap_b32 v240, v242
v_permlane16_swap_b32 v241, v243
buffer_store_dwordx4 v[240:243], v11, s[24:27], s51 offen offset:2048 sc1
v_fma_f32 v168, v40, v168, v72
v_fma_f32 v169, v41, v169, v73
v_fma_f32 v170, v42, v170, v74
v_fma_f32 v171, v43, v171, v75
v_cvt_pk_bf16_f32 v244, v168, v169
v_cvt_pk_bf16_f32 v245, v170, v171
v_fma_f32 v172, v44, v172, v76
v_fma_f32 v173, v45, v173, v77
v_fma_f32 v174, v46, v174, v78
v_fma_f32 v175, v47, v175, v79
v_cvt_pk_bf16_f32 v246, v172, v173
v_cvt_pk_bf16_f32 v247, v174, v175
s_nop 1
v_permlane16_swap_b32 v244, v246
v_permlane16_swap_b32 v245, v247
buffer_store_dwordx4 v[244:247], v11, s[24:27], s51 offen offset:3072 sc1
s_mov_b32 s75, 1
s_branch fused_kernel_p3
fused_kernel_aux:
s_getpc_b64 s[72:73]
fused_kernel_pc:
s_sub_u32 s72, s72, fused_kernel_pc-fused_kernel
s_subb_u32 s73, s73, 0
v_lshlrev_b32 v28, 7, v0
v_add_u32 v29, 32768, v28
s_mov_b32 s36, fused_kernel_end-fused_kernel-4
v_min_u32 v28, s36, v28
v_min_u32 v29, s36, v29
global_load_dword v254, v28, s[72:73]
global_load_dword v254, v29, s[72:73]
s_load_dwordx2 s[4:5], s[0:1], 56
s_load_dwordx2 s[6:7], s[0:1], 64
s_load_dwordx2 s[10:11], s[0:1], 0
s_load_dwordx2 s[8:9], s[0:1], 72
s_and_b32 s21, s20, 1
s_lshl_b32 s21, s21, 6
s_sub_u32 s42, s2, 144
v_lshrrev_b32 v5, 3, v2
v_bfe_u32 v6, v2, 4, 1
v_lshlrev_b32 v6, 1, v6
v_and_b32 v4, 7, v2
v_xor_b32 v4, v4, v6
v_lshlrev_b32 v4, 4, v4
v_xor_b32 v4, s21, v4
v_mul_u32_u24 v5, 9216, v5
v_add_u32 v4, v4, v5
v_bfe_u32 v5, v2, 2, 2
v_lshrrev_b32 v6, 4, v2
v_lshl_add_u32 v3, v6, 3, v5
v_lshlrev_b32 v3, 7, v3
v_lshrrev_b32 v5, 1, v5
v_and_b32 v6, 1, v6
v_lshl_or_b32 v5, v6, 1, v5
v_xor_b32 v5, s20, v5
v_and_b32 v7, 3, v2
v_lshlrev_b32 v7, 3, v7
v_lshl_add_u32 v5, v5, 5, v7
v_add_u32 v3, v3, v5
v_lshlrev_b32 v14, 4, v2
v_mov_b32 v15, 0x3f803f80
s_waitcnt lgkmcnt(0)
s_mov_b32 s79, 7241728
s_load_dword s76, s[16:17], s79
s_mov_b32 s24, s4
s_and_b32 s25, s5, 0xffff
s_mov_b32 s26, 5308416
s_mov_b32 s27, 0x20000
s_mov_b32 s44, s6
s_and_b32 s45, s7, 0xffff
s_mov_b32 s46, 9216
s_mov_b32 s47, 0x20000
s_mov_b32 s48, s8
s_and_b32 s49, s9, 0xffff
s_mov_b32 s50, 5308416
s_mov_b32 s51, 0x20000
v_bfe_u32 v5, v2, 2, 2
v_lshrrev_b32 v6, 4, v2
v_lshl_add_u32 v5, v6, 2, v5
v_mul_u32_u24 v5, 288, v5
s_mul_i32 s36, s20, 9216
v_add_u32 v5, s36, v5
v_and_b32 v6, 3, v2
v_lshl_add_u32 v12, v6, 4, v5
v_lshl_add_u32 v13, v6, 3, v5
s_add_u32 s28, s16, 7340032
s_addc_u32 s29, s17, 0
s_and_b32 s29, s29, 0xffff
s_mov_b32 s30, 10616832
s_mov_b32 s31, 0x20000
s_add_u32 s32, s16, 7159808
s_addc_u32 s33, s17, 0
s_and_b32 s33, s33, 0xffff
s_mov_b32 s34, 55296
s_mov_b32 s35, 0x20000
s_waitcnt lgkmcnt(0)
s_mul_i32 s76, s76, 1664525
s_add_u32 s76, s76, 1013904223
s_cmp_lt_u32 s42, 32
s_cbranch_scc1 fused_kernel_two1
s_cmp_ge_u32 s42, 96
s_cbranch_scc1 fused_kernel_two
s_add_u32 s52, s42, 0
s_lshr_b32 s36, s52, 1
s_and_b32 s37, s52, 1
s_mul_i32 s38, s37, 288
s_lshl_b32 s39, s20, 3
s_add_u32 s38, s38, s39
s_mul_i32 s38, s38, 9216
s_lshl_b32 s39, s36, 7
s_add_u32 s38, s38, s39
s_lshl_b32 s39, s20, 10
s_add_u32 s39, s39, 0
s_mov_b32 m0, s39
s_add_u32 s39, s39, 4096
buffer_load_dwordx4 v4, s[24:27], s38 offen lds
s_add_u32 s38, s38, 294912
s_mov_b32 m0, s39
s_add_u32 s39, s39, 4096
buffer_load_dwordx4 v4, s[24:27], s38 offen lds
s_add_u32 s38, s38, 294912
s_mov_b32 m0, s39
s_add_u32 s39, s39, 4096
buffer_load_dwordx4 v4, s[24:27], s38 offen lds
s_add_u32 s38, s38, 294912
s_mov_b32 m0, s39
s_add_u32 s39, s39, 4096
buffer_load_dwordx4 v4, s[24:27], s38 offen lds
s_add_u32 s38, s38, 294912
s_mov_b32 m0, s39
s_add_u32 s39, s39, 4096
buffer_load_dwordx4 v4, s[24:27], s38 offen lds
s_add_u32 s38, s38, 294912
s_mov_b32 m0, s39
s_add_u32 s39, s39, 4096
buffer_load_dwordx4 v4, s[24:27], s38 offen lds
s_add_u32 s38, s38, 294912
s_mov_b32 m0, s39
s_add_u32 s39, s39, 4096
buffer_load_dwordx4 v4, s[24:27], s38 offen lds
s_add_u32 s38, s38, 294912
s_mov_b32 m0, s39
s_add_u32 s39, s39, 4096
buffer_load_dwordx4 v4, s[24:27], s38 offen lds
s_add_u32 s38, s38, 294912
s_mov_b32 m0, s39
s_add_u32 s39, s39, 4096
buffer_load_dwordx4 v4, s[24:27], s38 offen lds
s_add_u32 s38, s38, 294912
s_lshl_b32 s36, s36, 2
s_add_u32 s36, s36, s20
v_and_b32 v8, 15, v2
s_lshl_b32 s38, s36, 4
v_add_u32 v36, s38, v8
v_lshlrev_b32 v8, 1, v36
buffer_load_ushort v40, v8, s[44:47], 0 offen
s_mul_hi_u32 s38, s36, 477218589
s_mul_i32 s40, s38, 9
s_sub_u32 s39, s36, s40
s_mul_hi_u32 s41, s39, 1431655766
s_mul_i32 s40, s41, 3
s_sub_u32 s43, s39, s40
s_mul_i32 s38, s38, 331776
s_mul_i32 s41, s41, 55296
s_add_u32 s38, s38, s41
s_lshl_b32 s43, s43, 10
s_add_u32 s38, s38, s43
s_mul_i32 s37, s37, 27648
s_add_u32 s55, s38, s37
s_add_u32 s53, s42, 112
s_cmp_ge_u32 s53, 144
s_cbranch_scc1 fused_kernel_iw2_1
s_lshr_b32 s36, s53, 1
s_and_b32 s37, s53, 1
s_mul_i32 s38, s37, 288
s_lshl_b32 s39, s20, 3
s_add_u32 s38, s38, s39
s_mul_i32 s38, s38, 9216
s_lshl_b32 s39, s36, 7
s_add_u32 s38, s38, s39
s_lshl_b32 s39, s20, 10
s_add_u32 s39, s39, 36864
s_mov_b32 m0, s39
s_add_u32 s39, s39, 4096
buffer_load_dwordx4 v4, s[24:27], s38 offen lds
s_add_u32 s38, s38, 294912
s_mov_b32 m0, s39
s_add_u32 s39, s39, 4096
buffer_load_dwordx4 v4, s[24:27], s38 offen lds
s_add_u32 s38, s38, 294912
s_mov_b32 m0, s39
s_add_u32 s39, s39, 4096
buffer_load_dwordx4 v4, s[24:27], s38 offen lds
s_add_u32 s38, s38, 294912
s_mov_b32 m0, s39
s_add_u32 s39, s39, 4096
buffer_load_dwordx4 v4, s[24:27], s38 offen lds
s_add_u32 s38, s38, 294912
s_mov_b32 m0, s39
s_add_u32 s39, s39, 4096
buffer_load_dwordx4 v4, s[24:27], s38 offen lds
s_add_u32 s38, s38, 294912
s_mov_b32 m0, s39
s_add_u32 s39, s39, 4096
buffer_load_dwordx4 v4, s[24:27], s38 offen lds
s_add_u32 s38, s38, 294912
s_mov_b32 m0, s39
s_add_u32 s39, s39, 4096
buffer_load_dwordx4 v4, s[24:27], s38 offen lds
s_add_u32 s38, s38, 294912
s_mov_b32 m0, s39
s_add_u32 s39, s39, 4096
buffer_load_dwordx4 v4, s[24:27], s38 offen lds
s_add_u32 s38, s38, 294912
s_mov_b32 m0, s39
s_add_u32 s39, s39, 4096
buffer_load_dwordx4 v4, s[24:27], s38 offen lds
s_add_u32 s38, s38, 294912
s_lshl_b32 s36, s36, 2
s_add_u32 s36, s36, s20
v_and_b32 v8, 15, v2
s_lshl_b32 s38, s36, 4
v_add_u32 v37, s38, v8
v_lshlrev_b32 v8, 1, v37
buffer_load_ushort v41, v8, s[44:47], 0 offen
s_mul_hi_u32 s38, s36, 477218589
s_mul_i32 s40, s38, 9
s_sub_u32 s39, s36, s40
s_mul_hi_u32 s41, s39, 1431655766
s_mul_i32 s40, s41, 3
s_sub_u32 s43, s39, s40
s_mul_i32 s38, s38, 331776
s_mul_i32 s41, s41, 55296
s_add_u32 s38, s38, s41
s_lshl_b32 s43, s43, 10
s_add_u32 s38, s38, s43
s_mul_i32 s37, s37, 27648
s_add_u32 s56, s38, s37
s_branch fused_kernel_idone_1
fused_kernel_iw2_1:
s_sub_u32 s36, s53, 144
s_mul_hi_u32 s37, s36, 238609295
s_mul_i32 s40, s37, 18
s_sub_u32 s41, s36, s40
s_lshr_b32 s39, s41, 2
s_lshl_b32 s39, s39, 5
s_and_b32 s40, s41, 3
s_mul_i32 s40, s40, 144
s_add_u32 s39, s39, s40
s_sub_u32 s40, s41, 16
s_mul_i32 s40, s40, 288
s_add_u32 s40, s40, 128
s_cmp_ge_u32 s41, 16
s_cselect_b32 s39, s40, s39
s_cselect_b32 s38, 147456, 0
s_mul_i32 s40, s37, 576
s_add_u32 s39, s39, s40
s_mul_i32 s39, s39, 1152
s_mul_i32 s40, s20, 288
s_add_u32 s39, s39, s40
v_add_u32 v25, 0, v2
v_mul_u32_u24 v26, 3641, v25
v_lshrrev_b32 v26, 16, v26
v_mul_u32_u24 v27, 18, v26
v_sub_u32 v25, v25, v27
v_mul_u32_u24 v27, 1152, v26
v_lshl_add_u32 v25, v25, 4, v27
v_lshrrev_b32 v26, 4, v26
v_mad_u32_u24 v16, v26, s38, v25
v_add_u32 v25, 64, v2
v_mul_u32_u24 v26, 3641, v25
v_lshrrev_b32 v26, 16, v26
v_mul_u32_u24 v27, 18, v26
v_sub_u32 v25, v25, v27
v_mul_u32_u24 v27, 1152, v26
v_lshl_add_u32 v25, v25, 4, v27
v_lshrrev_b32 v26, 4, v26
v_mad_u32_u24 v17, v26, s38, v25
v_add_u32 v25, 128, v2
v_mul_u32_u24 v26, 3641, v25
v_lshrrev_b32 v26, 16, v26
v_mul_u32_u24 v27, 18, v26
v_sub_u32 v25, v25, v27
v_mul_u32_u24 v27, 1152, v26
v_lshl_add_u32 v25, v25, 4, v27
v_lshrrev_b32 v26, 4, v26
v_mad_u32_u24 v18, v26, s38, v25
v_add_u32 v25, 192, v2
v_mul_u32_u24 v26, 3641, v25
v_lshrrev_b32 v26, 16, v26
v_mul_u32_u24 v27, 18, v26
v_sub_u32 v25, v25, v27
v_mul_u32_u24 v27, 1152, v26
v_lshl_add_u32 v25, v25, 4, v27
v_lshrrev_b32 v26, 4, v26
v_mad_u32_u24 v19, v26, s38, v25
v_add_u32 v25, 256, v2
v_mul_u32_u24 v26, 3641, v25
v_lshrrev_b32 v26, 16, v26
v_mul_u32_u24 v27, 18, v26
v_sub_u32 v25, v25, v27
v_mul_u32_u24 v27, 1152, v26
v_lshl_add_u32 v25, v25, 4, v27
v_lshrrev_b32 v26, 4, v26
v_mad_u32_u24 v20, v26, s38, v25
v_add_u32 v25, 320, v2
v_mul_u32_u24 v26, 3641, v25
v_lshrrev_b32 v26, 16, v26
v_mul_u32_u24 v27, 18, v26
v_sub_u32 v25, v25, v27
v_mul_u32_u24 v27, 1152, v26
v_lshl_add_u32 v25, v25, 4, v27
v_lshrrev_b32 v26, 4, v26
v_mad_u32_u24 v21, v26, s38, v25
v_add_u32 v25, 384, v2
v_mul_u32_u24 v26, 3641, v25
v_lshrrev_b32 v26, 16, v26
v_mul_u32_u24 v27, 18, v26
v_sub_u32 v25, v25, v27
v_mul_u32_u24 v27, 1152, v26
v_lshl_add_u32 v25, v25, 4, v27
v_lshrrev_b32 v26, 4, v26
v_mad_u32_u24 v22, v26, s38, v25
v_add_u32 v25, 448, v2
v_mul_u32_u24 v26, 3641, v25
v_lshrrev_b32 v26, 16, v26
v_mul_u32_u24 v27, 18, v26
v_sub_u32 v25, v25, v27
v_mul_u32_u24 v27, 1152, v26
v_lshl_add_u32 v25, v25, 4, v27
v_lshrrev_b32 v26, 4, v26
v_mad_u32_u24 v23, v26, s38, v25
v_add_u32 v25, 512, v2
v_mul_u32_u24 v26, 3641, v25
v_lshrrev_b32 v26, 16, v26
v_mul_u32_u24 v27, 18, v26
v_sub_u32 v25, v25, v27
v_mul_u32_u24 v27, 1152, v26
v_lshl_add_u32 v25, v25, 4, v27
v_lshrrev_b32 v26, 4, v26
v_mad_u32_u24 v24, v26, s38, v25
s_lshl_b32 s40, s37, 2
s_add_u32 s40, s40, s20
s_mul_i32 s40, s40, 331776
s_mul_i32 s38, s41, 3072
s_add_u32 s40, s40, s38
s_add_u32 s56, s40, 165888
s_cmp_ge_u32 s41, 12
s_cselect_b32 s59, 18432, 0
s_mul_i32 s41, s20, 9216
s_add_u32 s41, s41, 36864
s_mov_b32 m0, s41
s_add_u32 s41, s41, 1024
buffer_load_dwordx4 v16, s[48:51], s39 offen lds
s_mov_b32 m0, s41
s_add_u32 s41, s41, 1024
buffer_load_dwordx4 v17, s[48:51], s39 offen lds
s_mov_b32 m0, s41
s_add_u32 s41, s41, 1024
buffer_load_dwordx4 v18, s[48:51], s39 offen lds
s_mov_b32 m0, s41
s_add_u32 s41, s41, 1024
buffer_load_dwordx4 v19, s[48:51], s39 offen lds
s_mov_b32 m0, s41
s_add_u32 s41, s41, 1024
buffer_load_dwordx4 v20, s[48:51], s39 offen lds
s_mov_b32 m0, s41
s_add_u32 s41, s41, 1024
buffer_load_dwordx4 v21, s[48:51], s39 offen lds
s_mov_b32 m0, s41
s_add_u32 s41, s41, 1024
buffer_load_dwordx4 v22, s[48:51], s39 offen lds
s_mov_b32 m0, s41
s_add_u32 s41, s41, 1024
buffer_load_dwordx4 v23, s[48:51], s39 offen lds
s_mov_b32 m0, s41
s_add_u32 s41, s41, 1024
buffer_load_dwordx4 v24, s[48:51], s39 offen lds
buffer_load_ushort v41, v14, s[44:47], 0 offen
fused_kernel_idone_1:
s_add_u32 s54, s42, 192
s_cmp_ge_u32 s54, 144
s_cbranch_scc1 fused_kernel_iw2_2
s_lshr_b32 s36, s54, 1
s_and_b32 s37, s54, 1
s_mul_i32 s38, s37, 288
s_lshl_b32 s39, s20, 3
s_add_u32 s38, s38, s39
s_mul_i32 s38, s38, 9216
s_lshl_b32 s39, s36, 7
s_add_u32 s38, s38, s39
s_lshl_b32 s39, s20, 10
s_add_u32 s39, s39, 73728
s_mov_b32 m0, s39
s_add_u32 s39, s39, 4096
buffer_load_dwordx4 v4, s[24:27], s38 offen lds
s_add_u32 s38, s38, 294912
s_mov_b32 m0, s39
s_add_u32 s39, s39, 4096
buffer_load_dwordx4 v4, s[24:27], s38 offen lds
s_add_u32 s38, s38, 294912
s_mov_b32 m0, s39
s_add_u32 s39, s39, 4096
buffer_load_dwordx4 v4, s[24:27], s38 offen lds
s_add_u32 s38, s38, 294912
s_mov_b32 m0, s39
s_add_u32 s39, s39, 4096
buffer_load_dwordx4 v4, s[24:27], s38 offen lds
s_add_u32 s38, s38, 294912
s_mov_b32 m0, s39
s_add_u32 s39, s39, 4096
buffer_load_dwordx4 v4, s[24:27], s38 offen lds
s_add_u32 s38, s38, 294912
s_mov_b32 m0, s39
s_add_u32 s39, s39, 4096
buffer_load_dwordx4 v4, s[24:27], s38 offen lds
s_add_u32 s38, s38, 294912
s_mov_b32 m0, s39
s_add_u32 s39, s39, 4096
buffer_load_dwordx4 v4, s[24:27], s38 offen lds
s_add_u32 s38, s38, 294912
s_mov_b32 m0, s39
s_add_u32 s39, s39, 4096
buffer_load_dwordx4 v4, s[24:27], s38 offen lds
s_add_u32 s38, s38, 294912
s_mov_b32 m0, s39
s_add_u32 s39, s39, 4096
buffer_load_dwordx4 v4, s[24:27], s38 offen lds
s_add_u32 s38, s38, 294912
s_lshl_b32 s36, s36, 2
s_add_u32 s36, s36, s20
v_and_b32 v8, 15, v2
s_lshl_b32 s38, s36, 4
v_add_u32 v38, s38, v8
v_lshlrev_b32 v8, 1, v38
buffer_load_ushort v42, v8, s[44:47], 0 offen
s_mul_hi_u32 s38, s36, 477218589
s_mul_i32 s40, s38, 9
s_sub_u32 s39, s36, s40
s_mul_hi_u32 s41, s39, 1431655766
s_mul_i32 s40, s41, 3
s_sub_u32 s43, s39, s40
s_mul_i32 s38, s38, 331776
s_mul_i32 s41, s41, 55296
s_add_u32 s38, s38, s41
s_lshl_b32 s43, s43, 10
s_add_u32 s38, s38, s43
s_mul_i32 s37, s37, 27648
s_add_u32 s57, s38, s37
s_branch fused_kernel_idone_2
fused_kernel_iw2_2:
s_sub_u32 s36, s54, 144
s_mul_hi_u32 s37, s36, 238609295
s_mul_i32 s40, s37, 18
s_sub_u32 s41, s36, s40
s_lshr_b32 s39, s41, 2
s_lshl_b32 s39, s39, 5
s_and_b32 s40, s41, 3
s_mul_i32 s40, s40, 144
s_add_u32 s39, s39, s40
s_sub_u32 s40, s41, 16
s_mul_i32 s40, s40, 288
s_add_u32 s40, s40, 128
s_cmp_ge_u32 s41, 16
s_cselect_b32 s39, s40, s39
s_cselect_b32 s38, 147456, 0
s_mul_i32 s40, s37, 576
s_add_u32 s39, s39, s40
s_mul_i32 s39, s39, 1152
s_mul_i32 s40, s20, 288
s_add_u32 s39, s39, s40
v_add_u32 v25, 0, v2
v_mul_u32_u24 v26, 3641, v25
v_lshrrev_b32 v26, 16, v26
v_mul_u32_u24 v27, 18, v26
v_sub_u32 v25, v25, v27
v_mul_u32_u24 v27, 1152, v26
v_lshl_add_u32 v25, v25, 4, v27
v_lshrrev_b32 v26, 4, v26
v_mad_u32_u24 v16, v26, s38, v25
v_add_u32 v25, 64, v2
v_mul_u32_u24 v26, 3641, v25
v_lshrrev_b32 v26, 16, v26
v_mul_u32_u24 v27, 18, v26
v_sub_u32 v25, v25, v27
v_mul_u32_u24 v27, 1152, v26
v_lshl_add_u32 v25, v25, 4, v27
v_lshrrev_b32 v26, 4, v26
v_mad_u32_u24 v17, v26, s38, v25
v_add_u32 v25, 128, v2
v_mul_u32_u24 v26, 3641, v25
v_lshrrev_b32 v26, 16, v26
v_mul_u32_u24 v27, 18, v26
v_sub_u32 v25, v25, v27
v_mul_u32_u24 v27, 1152, v26
v_lshl_add_u32 v25, v25, 4, v27
v_lshrrev_b32 v26, 4, v26
v_mad_u32_u24 v18, v26, s38, v25
v_add_u32 v25, 192, v2
v_mul_u32_u24 v26, 3641, v25
v_lshrrev_b32 v26, 16, v26
v_mul_u32_u24 v27, 18, v26
v_sub_u32 v25, v25, v27
v_mul_u32_u24 v27, 1152, v26
v_lshl_add_u32 v25, v25, 4, v27
v_lshrrev_b32 v26, 4, v26
v_mad_u32_u24 v19, v26, s38, v25
v_add_u32 v25, 256, v2
v_mul_u32_u24 v26, 3641, v25
v_lshrrev_b32 v26, 16, v26
v_mul_u32_u24 v27, 18, v26
v_sub_u32 v25, v25, v27
v_mul_u32_u24 v27, 1152, v26
v_lshl_add_u32 v25, v25, 4, v27
v_lshrrev_b32 v26, 4, v26
v_mad_u32_u24 v20, v26, s38, v25
v_add_u32 v25, 320, v2
v_mul_u32_u24 v26, 3641, v25
v_lshrrev_b32 v26, 16, v26
v_mul_u32_u24 v27, 18, v26
v_sub_u32 v25, v25, v27
v_mul_u32_u24 v27, 1152, v26
v_lshl_add_u32 v25, v25, 4, v27
v_lshrrev_b32 v26, 4, v26
v_mad_u32_u24 v21, v26, s38, v25
v_add_u32 v25, 384, v2
v_mul_u32_u24 v26, 3641, v25
v_lshrrev_b32 v26, 16, v26
v_mul_u32_u24 v27, 18, v26
v_sub_u32 v25, v25, v27
v_mul_u32_u24 v27, 1152, v26
v_lshl_add_u32 v25, v25, 4, v27
v_lshrrev_b32 v26, 4, v26
v_mad_u32_u24 v22, v26, s38, v25
v_add_u32 v25, 448, v2
v_mul_u32_u24 v26, 3641, v25
v_lshrrev_b32 v26, 16, v26
v_mul_u32_u24 v27, 18, v26
v_sub_u32 v25, v25, v27
v_mul_u32_u24 v27, 1152, v26
v_lshl_add_u32 v25, v25, 4, v27
v_lshrrev_b32 v26, 4, v26
v_mad_u32_u24 v23, v26, s38, v25
v_add_u32 v25, 512, v2
v_mul_u32_u24 v26, 3641, v25
v_lshrrev_b32 v26, 16, v26
v_mul_u32_u24 v27, 18, v26
v_sub_u32 v25, v25, v27
v_mul_u32_u24 v27, 1152, v26
v_lshl_add_u32 v25, v25, 4, v27
v_lshrrev_b32 v26, 4, v26
v_mad_u32_u24 v24, v26, s38, v25
s_lshl_b32 s40, s37, 2
s_add_u32 s40, s40, s20
s_mul_i32 s40, s40, 331776
s_mul_i32 s38, s41, 3072
s_add_u32 s40, s40, s38
s_add_u32 s57, s40, 165888
s_cmp_ge_u32 s41, 12
s_cselect_b32 s60, 18432, 0
s_mul_i32 s41, s20, 9216
s_add_u32 s41, s41, 73728
s_mov_b32 m0, s41
s_add_u32 s41, s41, 1024
buffer_load_dwordx4 v16, s[48:51], s39 offen lds
s_mov_b32 m0, s41
s_add_u32 s41, s41, 1024
buffer_load_dwordx4 v17, s[48:51], s39 offen lds
s_mov_b32 m0, s41
s_add_u32 s41, s41, 1024
buffer_load_dwordx4 v18, s[48:51], s39 offen lds
s_mov_b32 m0, s41
s_add_u32 s41, s41, 1024
buffer_load_dwordx4 v19, s[48:51], s39 offen lds
s_mov_b32 m0, s41
s_add_u32 s41, s41, 1024
buffer_load_dwordx4 v20, s[48:51], s39 offen lds
s_mov_b32 m0, s41
s_add_u32 s41, s41, 1024
buffer_load_dwordx4 v21, s[48:51], s39 offen lds
s_mov_b32 m0, s41
s_add_u32 s41, s41, 1024
buffer_load_dwordx4 v22, s[48:51], s39 offen lds
s_mov_b32 m0, s41
s_add_u32 s41, s41, 1024
buffer_load_dwordx4 v23, s[48:51], s39 offen lds
s_mov_b32 m0, s41
s_add_u32 s41, s41, 1024
buffer_load_dwordx4 v24, s[48:51], s39 offen lds
buffer_load_ushort v42, v14, s[44:47], 0 offen
fused_kernel_idone_2:
s_waitcnt vmcnt(20)
s_barrier
v_add_u32 v8, 0, v3
ds_read_b64_tr_b16 v[48:49], v8 offset:0
ds_read_b64_tr_b16 v[50:51], v8 offset:512
ds_read_b64_tr_b16 v[52:53], v8 offset:4096
ds_read_b64_tr_b16 v[54:55], v8 offset:4608
ds_read_b64_tr_b16 v[56:57], v8 offset:8192
ds_read_b64_tr_b16 v[58:59], v8 offset:8704
ds_read_b64_tr_b16 v[60:61], v8 offset:12288
ds_read_b64_tr_b16 v[62:63], v8 offset:12800
ds_read_b64_tr_b16 v[64:65], v8 offset:16384
ds_read_b64_tr_b16 v[66:67], v8 offset:16896
ds_read_b64_tr_b16 v[68:69], v8 offset:20480
ds_read_b64_tr_b16 v[70:71], v8 offset:20992
ds_read_b64_tr_b16 v[72:73], v8 offset:24576
ds_read_b64_tr_b16 v[74:75], v8 offset:25088
ds_read_b64_tr_b16 v[76:77], v8 offset:28672
ds_read_b64_tr_b16 v[78:79], v8 offset:29184
ds_read_b64_tr_b16 v[80:81], v8 offset:32768
ds_read_b64_tr_b16 v[82:83], v8 offset:33280
s_waitcnt lgkmcnt(15)
buffer_store_dwordx4 v[48:51], v14, s[28:31], s55 offen sc1
s_add_u32 s55, s55, 3072
s_waitcnt lgkmcnt(14)
buffer_store_dwordx4 v[52:55], v14, s[28:31], s55 offen sc1
s_add_u32 s55, s55, 3072
s_waitcnt lgkmcnt(12)
buffer_store_dwordx4 v[56:59], v14, s[28:31], s55 offen sc1
s_add_u32 s55, s55, 3072
s_waitcnt lgkmcnt(10)
buffer_store_dwordx4 v[60:63], v14, s[28:31], s55 offen sc1
s_add_u32 s55, s55, 3072
s_waitcnt lgkmcnt(8)
buffer_store_dwordx4 v[64:67], v14, s[28:31], s55 offen sc1
s_add_u32 s55, s55, 3072
s_waitcnt lgkmcnt(6)
buffer_store_dwordx4 v[68:71], v14, s[28:31], s55 offen sc1
s_add_u32 s55, s55, 3072
s_waitcnt lgkmcnt(4)
buffer_store_dwordx4 v[72:75], v14, s[28:31], s55 offen sc1
s_add_u32 s55, s55, 3072
s_waitcnt lgkmcnt(2)
buffer_store_dwordx4 v[76:79], v14, s[28:31], s55 offen sc1
s_add_u32 s55, s55, 3072
s_waitcnt lgkmcnt(0)
buffer_store_dwordx4 v[80:83], v14, s[28:31], s55 offen sc1
s_add_u32 s55, s55, 3072
v_dot2_f32_bf16 v44, v48, v15, 0
v_dot2_f32_bf16 v45, v49, v15, 0
v_dot2_f32_bf16 v44, v50, v15, v44
v_dot2_f32_bf16 v45, v51, v15, v45
v_dot2_f32_bf16 v44, v52, v15, v44
v_dot2_f32_bf16 v45, v53, v15, v45
v_dot2_f32_bf16 v44, v54, v15, v44
v_dot2_f32_bf16 v45, v55, v15, v45
v_dot2_f32_bf16 v44, v56, v15, v44
v_dot2_f32_bf16 v45, v57, v15, v45
v_dot2_f32_bf16 v44, v58, v15, v44
v_dot2_f32_bf16 v45, v59, v15, v45
v_dot2_f32_bf16 v44, v60, v15, v44
v_dot2_f32_bf16 v45, v61, v15, v45
v_dot2_f32_bf16 v44, v62, v15, v44
v_dot2_f32_bf16 v45, v63, v15, v45
v_dot2_f32_bf16 v44, v64, v15, v44
v_dot2_f32_bf16 v45, v65, v15, v45
v_dot2_f32_bf16 v44, v66, v15, v44
v_dot2_f32_bf16 v45, v67, v15, v45
v_dot2_f32_bf16 v44, v68, v15, v44
v_dot2_f32_bf16 v45, v69, v15, v45
v_dot2_f32_bf16 v44, v70, v15, v44
v_dot2_f32_bf16 v45, v71, v15, v45
v_dot2_f32_bf16 v44, v72, v15, v44
v_dot2_f32_bf16 v45, v73, v15, v45
v_dot2_f32_bf16 v44, v74, v15, v44
v_dot2_f32_bf16 v45, v75, v15, v45
v_dot2_f32_bf16 v44, v76, v15, v44
v_dot2_f32_bf16 v45, v77, v15, v45
v_dot2_f32_bf16 v44, v78, v15, v44
v_dot2_f32_bf16 v45, v79, v15, v45
v_dot2_f32_bf16 v44, v80, v15, v44
v_dot2_f32_bf16 v45, v81, v15, v45
v_dot2_f32_bf16 v44, v82, v15, v44
v_dot2_f32_bf16 v45, v83, v15, v45
s_nop 2
v_add_f32 v44, v44, v45
s_nop 0
v_mov_b32 v45, v44
s_nop 1
v_permlane32_swap_b32 v44, v45
v_add_f32 v44, v44, v45
s_nop 0
v_mov_b32 v45, v44
s_nop 1
v_permlane16_swap_b32 v44, v45
v_add_f32 v44, v44, v45
v_lshlrev_b32 v45, 16, v40
v_mul_f32 v45, 0x3fb8aa3b, v45
v_lshlrev_b32 v8, 2, v36
s_and_b32 s36, s52, 1
s_mul_i32 s36, s36, 18432
s_mov_b32 s37, 36864
v_cmp_gt_u32 vcc, 16, v2
s_and_saveexec_b64 s[38:39], vcc
buffer_store_dword v44, v8, s[32:35], s36 offen sc1
buffer_store_dword v45, v8, s[32:35], s37 offen sc1
s_mov_b64 exec, s[38:39]
s_waitcnt vmcnt(19)
s_cmp_ge_u32 s53, 144
s_cbranch_scc1 fused_kernel_pw2_1
s_barrier
v_add_u32 v8, 36864, v3
ds_read_b64_tr_b16 v[48:49], v8 offset:0
ds_read_b64_tr_b16 v[50:51], v8 offset:512
ds_read_b64_tr_b16 v[52:53], v8 offset:4096
ds_read_b64_tr_b16 v[54:55], v8 offset:4608
ds_read_b64_tr_b16 v[56:57], v8 offset:8192
ds_read_b64_tr_b16 v[58:59], v8 offset:8704
ds_read_b64_tr_b16 v[60:61], v8 offset:12288
ds_read_b64_tr_b16 v[62:63], v8 offset:12800
ds_read_b64_tr_b16 v[64:65], v8 offset:16384
ds_read_b64_tr_b16 v[66:67], v8 offset:16896
ds_read_b64_tr_b16 v[68:69], v8 offset:20480
ds_read_b64_tr_b16 v[70:71], v8 offset:20992
ds_read_b64_tr_b16 v[72:73], v8 offset:24576
ds_read_b64_tr_b16 v[74:75], v8 offset:25088
ds_read_b64_tr_b16 v[76:77], v8 offset:28672
ds_read_b64_tr_b16 v[78:79], v8 offset:29184
ds_read_b64_tr_b16 v[80:81], v8 offset:32768
ds_read_b64_tr_b16 v[82:83], v8 offset:33280
s_waitcnt lgkmcnt(15)
buffer_store_dwordx4 v[48:51], v14, s[28:31], s56 offen sc1
s_add_u32 s56, s56, 3072
s_waitcnt lgkmcnt(14)
buffer_store_dwordx4 v[52:55], v14, s[28:31], s56 offen sc1
s_add_u32 s56, s56, 3072
s_waitcnt lgkmcnt(12)
buffer_store_dwordx4 v[56:59], v14, s[28:31], s56 offen sc1
s_add_u32 s56, s56, 3072
s_waitcnt lgkmcnt(10)
buffer_store_dwordx4 v[60:63], v14, s[28:31], s56 offen sc1
s_add_u32 s56, s56, 3072
s_waitcnt lgkmcnt(8)
buffer_store_dwordx4 v[64:67], v14, s[28:31], s56 offen sc1
s_add_u32 s56, s56, 3072
s_waitcnt lgkmcnt(6)
buffer_store_dwordx4 v[68:71], v14, s[28:31], s56 offen sc1
s_add_u32 s56, s56, 3072
s_waitcnt lgkmcnt(4)
buffer_store_dwordx4 v[72:75], v14, s[28:31], s56 offen sc1
s_add_u32 s56, s56, 3072
s_waitcnt lgkmcnt(2)
buffer_store_dwordx4 v[76:79], v14, s[28:31], s56 offen sc1
s_add_u32 s56, s56, 3072
s_waitcnt lgkmcnt(0)
buffer_store_dwordx4 v[80:83], v14, s[28:31], s56 offen sc1
s_add_u32 s56, s56, 3072
v_dot2_f32_bf16 v44, v48, v15, 0
v_dot2_f32_bf16 v45, v49, v15, 0
v_dot2_f32_bf16 v44, v50, v15, v44
v_dot2_f32_bf16 v45, v51, v15, v45
v_dot2_f32_bf16 v44, v52, v15, v44
v_dot2_f32_bf16 v45, v53, v15, v45
v_dot2_f32_bf16 v44, v54, v15, v44
v_dot2_f32_bf16 v45, v55, v15, v45
v_dot2_f32_bf16 v44, v56, v15, v44
v_dot2_f32_bf16 v45, v57, v15, v45
v_dot2_f32_bf16 v44, v58, v15, v44
v_dot2_f32_bf16 v45, v59, v15, v45
v_dot2_f32_bf16 v44, v60, v15, v44
v_dot2_f32_bf16 v45, v61, v15, v45
v_dot2_f32_bf16 v44, v62, v15, v44
v_dot2_f32_bf16 v45, v63, v15, v45
v_dot2_f32_bf16 v44, v64, v15, v44
v_dot2_f32_bf16 v45, v65, v15, v45
v_dot2_f32_bf16 v44, v66, v15, v44
v_dot2_f32_bf16 v45, v67, v15, v45
v_dot2_f32_bf16 v44, v68, v15, v44
v_dot2_f32_bf16 v45, v69, v15, v45
v_dot2_f32_bf16 v44, v70, v15, v44
v_dot2_f32_bf16 v45, v71, v15, v45
v_dot2_f32_bf16 v44, v72, v15, v44
v_dot2_f32_bf16 v45, v73, v15, v45
v_dot2_f32_bf16 v44, v74, v15, v44
v_dot2_f32_bf16 v45, v75, v15, v45
v_dot2_f32_bf16 v44, v76, v15, v44
v_dot2_f32_bf16 v45, v77, v15, v45
v_dot2_f32_bf16 v44, v78, v15, v44
v_dot2_f32_bf16 v45, v79, v15, v45
v_dot2_f32_bf16 v44, v80, v15, v44
v_dot2_f32_bf16 v45, v81, v15, v45
v_dot2_f32_bf16 v44, v82, v15, v44
v_dot2_f32_bf16 v45, v83, v15, v45
s_nop 2
v_add_f32 v44, v44, v45
s_nop 0
v_mov_b32 v45, v44
s_nop 1
v_permlane32_swap_b32 v44, v45
v_add_f32 v44, v44, v45
s_nop 0
v_mov_b32 v45, v44
s_nop 1
v_permlane16_swap_b32 v44, v45
v_add_f32 v44, v44, v45
v_lshlrev_b32 v45, 16, v41
v_mul_f32 v45, 0x3fb8aa3b, v45
v_lshlrev_b32 v8, 2, v37
s_and_b32 s36, s53, 1
s_mul_i32 s36, s36, 18432
s_mov_b32 s37, 36864
v_cmp_gt_u32 vcc, 16, v2
s_and_saveexec_b64 s[38:39], vcc
buffer_store_dword v44, v8, s[32:35], s36 offen sc1
buffer_store_dword v45, v8, s[32:35], s37 offen sc1
s_mov_b64 exec, s[38:39]
s_branch fused_kernel_pdone_1
fused_kernel_pw2_1:
v_add_u32 v8, 36864, v12
v_add_u32 v9, 36864, v13
ds_read_b64_tr_b16 v[48:49], v8 offset:0
ds_read_b64_tr_b16 v[50:51], v8 offset:4608
ds_read_b64_tr_b16 v[52:53], v8 offset:8
ds_read_b64_tr_b16 v[54:55], v8 offset:4616
ds_read_b64_tr_b16 v[56:57], v8 offset:64
ds_read_b64_tr_b16 v[58:59], v8 offset:4672
ds_read_b64_tr_b16 v[60:61], v8 offset:72
ds_read_b64_tr_b16 v[62:63], v8 offset:4680
ds_read_b64_tr_b16 v[64:65], v8 offset:128
ds_read_b64_tr_b16 v[66:67], v8 offset:4736
ds_read_b64_tr_b16 v[68:69], v8 offset:136
ds_read_b64_tr_b16 v[70:71], v8 offset:4744
ds_read_b64_tr_b16 v[72:73], v8 offset:192
ds_read_b64_tr_b16 v[74:75], v8 offset:4800
ds_read_b64_tr_b16 v[76:77], v8 offset:200
ds_read_b64_tr_b16 v[78:79], v8 offset:4808
ds_read_b64_tr_b16 v[80:81], v9 offset:256
ds_read_b64_tr_b16 v[82:83], v9 offset:4864
s_waitcnt lgkmcnt(15)
s_mul_i32 s36, s59, 2
s_add_u32 s36, s36, s56
s_add_u32 s36, s36, 0
buffer_store_dwordx4 v[48:51], v14, s[28:31], s36 offen sc1
s_waitcnt lgkmcnt(14)
s_mul_i32 s36, s59, 2
s_add_u32 s36, s36, s56
s_add_u32 s36, s36, 1024
buffer_store_dwordx4 v[52:55], v14, s[28:31], s36 offen sc1
s_waitcnt lgkmcnt(12)
s_mul_i32 s36, s59, 2
s_add_u32 s36, s36, s56
s_add_u32 s36, s36, 2048
buffer_store_dwordx4 v[56:59], v14, s[28:31], s36 offen sc1
s_waitcnt lgkmcnt(10)
s_mul_i32 s36, s59, 1
s_add_u32 s36, s36, s56
s_add_u32 s36, s36, 36864
buffer_store_dwordx4 v[60:63], v14, s[28:31], s36 offen sc1
s_waitcnt lgkmcnt(8)
s_mul_i32 s36, s59, 1
s_add_u32 s36, s36, s56
s_add_u32 s36, s36, 37888
buffer_store_dwordx4 v[64:67], v14, s[28:31], s36 offen sc1
s_waitcnt lgkmcnt(6)
s_mul_i32 s36, s59, 1
s_add_u32 s36, s36, s56
s_add_u32 s36, s36, 38912
buffer_store_dwordx4 v[68:71], v14, s[28:31], s36 offen sc1
s_waitcnt lgkmcnt(4)
s_mul_i32 s36, s59, 0
s_add_u32 s36, s36, s56
s_add_u32 s36, s36, 110592
buffer_store_dwordx4 v[72:75], v14, s[28:31], s36 offen sc1
s_waitcnt lgkmcnt(2)
s_mul_i32 s36, s59, 0
s_add_u32 s36, s36, s56
s_add_u32 s36, s36, 111616
buffer_store_dwordx4 v[76:79], v14, s[28:31], s36 offen sc1
s_waitcnt lgkmcnt(0)
s_mul_i32 s36, s59, 0
s_add_u32 s36, s36, s56
s_add_u32 s36, s36, 112640
buffer_store_dwordx4 v[80:83], v14, s[28:31], s36 offen sc1
fused_kernel_pdone_1:
s_waitcnt vmcnt(9)
s_barrier
s_cmp_lg_u32 s20, 0
s_cbranch_scc1 fused_kernel_pw1a
s_lshl_b32 s78, s42, 6
s_add_u32 s78, s78, 38797312
v_mov_b32 v8, s78
v_mov_b32 v9, s76
s_mov_b64 exec, 1
global_store_dword v8, v9, s[16:17] sc1
s_mov_b64 exec, -1
fused_kernel_pw1a:
s_waitcnt vmcnt(18)
s_cmp_ge_u32 s54, 144
s_cbranch_scc1 fused_kernel_pw2_2
s_barrier
v_add_u32 v8, 73728, v3
ds_read_b64_tr_b16 v[48:49], v8 offset:0
ds_read_b64_tr_b16 v[50:51], v8 offset:512
ds_read_b64_tr_b16 v[52:53], v8 offset:4096
ds_read_b64_tr_b16 v[54:55], v8 offset:4608
ds_read_b64_tr_b16 v[56:57], v8 offset:8192
ds_read_b64_tr_b16 v[58:59], v8 offset:8704
ds_read_b64_tr_b16 v[60:61], v8 offset:12288
ds_read_b64_tr_b16 v[62:63], v8 offset:12800
ds_read_b64_tr_b16 v[64:65], v8 offset:16384
ds_read_b64_tr_b16 v[66:67], v8 offset:16896
ds_read_b64_tr_b16 v[68:69], v8 offset:20480
ds_read_b64_tr_b16 v[70:71], v8 offset:20992
ds_read_b64_tr_b16 v[72:73], v8 offset:24576
ds_read_b64_tr_b16 v[74:75], v8 offset:25088
ds_read_b64_tr_b16 v[76:77], v8 offset:28672
ds_read_b64_tr_b16 v[78:79], v8 offset:29184
ds_read_b64_tr_b16 v[80:81], v8 offset:32768
ds_read_b64_tr_b16 v[82:83], v8 offset:33280
s_waitcnt lgkmcnt(15)
buffer_store_dwordx4 v[48:51], v14, s[28:31], s57 offen sc1
s_add_u32 s57, s57, 3072
s_waitcnt lgkmcnt(14)
buffer_store_dwordx4 v[52:55], v14, s[28:31], s57 offen sc1
s_add_u32 s57, s57, 3072
s_waitcnt lgkmcnt(12)
buffer_store_dwordx4 v[56:59], v14, s[28:31], s57 offen sc1
s_add_u32 s57, s57, 3072
s_waitcnt lgkmcnt(10)
buffer_store_dwordx4 v[60:63], v14, s[28:31], s57 offen sc1
s_add_u32 s57, s57, 3072
s_waitcnt lgkmcnt(8)
buffer_store_dwordx4 v[64:67], v14, s[28:31], s57 offen sc1
s_add_u32 s57, s57, 3072
s_waitcnt lgkmcnt(6)
buffer_store_dwordx4 v[68:71], v14, s[28:31], s57 offen sc1
s_add_u32 s57, s57, 3072
s_waitcnt lgkmcnt(4)
buffer_store_dwordx4 v[72:75], v14, s[28:31], s57 offen sc1
s_add_u32 s57, s57, 3072
s_waitcnt lgkmcnt(2)
buffer_store_dwordx4 v[76:79], v14, s[28:31], s57 offen sc1
s_add_u32 s57, s57, 3072
s_waitcnt lgkmcnt(0)
buffer_store_dwordx4 v[80:83], v14, s[28:31], s57 offen sc1
s_add_u32 s57, s57, 3072
v_dot2_f32_bf16 v44, v48, v15, 0
v_dot2_f32_bf16 v45, v49, v15, 0
v_dot2_f32_bf16 v44, v50, v15, v44
v_dot2_f32_bf16 v45, v51, v15, v45
v_dot2_f32_bf16 v44, v52, v15, v44
v_dot2_f32_bf16 v45, v53, v15, v45
v_dot2_f32_bf16 v44, v54, v15, v44
v_dot2_f32_bf16 v45, v55, v15, v45
v_dot2_f32_bf16 v44, v56, v15, v44
v_dot2_f32_bf16 v45, v57, v15, v45
v_dot2_f32_bf16 v44, v58, v15, v44
v_dot2_f32_bf16 v45, v59, v15, v45
v_dot2_f32_bf16 v44, v60, v15, v44
v_dot2_f32_bf16 v45, v61, v15, v45
v_dot2_f32_bf16 v44, v62, v15, v44
v_dot2_f32_bf16 v45, v63, v15, v45
v_dot2_f32_bf16 v44, v64, v15, v44
v_dot2_f32_bf16 v45, v65, v15, v45
v_dot2_f32_bf16 v44, v66, v15, v44
v_dot2_f32_bf16 v45, v67, v15, v45
v_dot2_f32_bf16 v44, v68, v15, v44
v_dot2_f32_bf16 v45, v69, v15, v45
v_dot2_f32_bf16 v44, v70, v15, v44
v_dot2_f32_bf16 v45, v71, v15, v45
v_dot2_f32_bf16 v44, v72, v15, v44
v_dot2_f32_bf16 v45, v73, v15, v45
v_dot2_f32_bf16 v44, v74, v15, v44
v_dot2_f32_bf16 v45, v75, v15, v45
v_dot2_f32_bf16 v44, v76, v15, v44
v_dot2_f32_bf16 v45, v77, v15, v45
v_dot2_f32_bf16 v44, v78, v15, v44
v_dot2_f32_bf16 v45, v79, v15, v45
v_dot2_f32_bf16 v44, v80, v15, v44
v_dot2_f32_bf16 v45, v81, v15, v45
v_dot2_f32_bf16 v44, v82, v15, v44
v_dot2_f32_bf16 v45, v83, v15, v45
s_nop 2
v_add_f32 v44, v44, v45
s_nop 0
v_mov_b32 v45, v44
s_nop 1
v_permlane32_swap_b32 v44, v45
v_add_f32 v44, v44, v45
s_nop 0
v_mov_b32 v45, v44
s_nop 1
v_permlane16_swap_b32 v44, v45
v_add_f32 v44, v44, v45
v_lshlrev_b32 v45, 16, v42
v_mul_f32 v45, 0x3fb8aa3b, v45
v_lshlrev_b32 v8, 2, v38
s_and_b32 s36, s54, 1
s_mul_i32 s36, s36, 18432
s_mov_b32 s37, 36864
v_cmp_gt_u32 vcc, 16, v2
s_and_saveexec_b64 s[38:39], vcc
buffer_store_dword v44, v8, s[32:35], s36 offen sc1
buffer_store_dword v45, v8, s[32:35], s37 offen sc1
s_mov_b64 exec, s[38:39]
s_branch fused_kernel_pdone_2
fused_kernel_pw2_2:
v_add_u32 v8, 73728, v12
v_add_u32 v9, 73728, v13
ds_read_b64_tr_b16 v[48:49], v8 offset:0
ds_read_b64_tr_b16 v[50:51], v8 offset:4608
ds_read_b64_tr_b16 v[52:53], v8 offset:8
ds_read_b64_tr_b16 v[54:55], v8 offset:4616
ds_read_b64_tr_b16 v[56:57], v8 offset:64
ds_read_b64_tr_b16 v[58:59], v8 offset:4672
ds_read_b64_tr_b16 v[60:61], v8 offset:72
ds_read_b64_tr_b16 v[62:63], v8 offset:4680
ds_read_b64_tr_b16 v[64:65], v8 offset:128
ds_read_b64_tr_b16 v[66:67], v8 offset:4736
ds_read_b64_tr_b16 v[68:69], v8 offset:136
ds_read_b64_tr_b16 v[70:71], v8 offset:4744
ds_read_b64_tr_b16 v[72:73], v8 offset:192
ds_read_b64_tr_b16 v[74:75], v8 offset:4800
ds_read_b64_tr_b16 v[76:77], v8 offset:200
ds_read_b64_tr_b16 v[78:79], v8 offset:4808
ds_read_b64_tr_b16 v[80:81], v9 offset:256
ds_read_b64_tr_b16 v[82:83], v9 offset:4864
s_waitcnt lgkmcnt(15)
s_mul_i32 s36, s60, 2
s_add_u32 s36, s36, s57
s_add_u32 s36, s36, 0
buffer_store_dwordx4 v[48:51], v14, s[28:31], s36 offen sc1
s_waitcnt lgkmcnt(14)
s_mul_i32 s36, s60, 2
s_add_u32 s36, s36, s57
s_add_u32 s36, s36, 1024
buffer_store_dwordx4 v[52:55], v14, s[28:31], s36 offen sc1
s_waitcnt lgkmcnt(12)
s_mul_i32 s36, s60, 2
s_add_u32 s36, s36, s57
s_add_u32 s36, s36, 2048
buffer_store_dwordx4 v[56:59], v14, s[28:31], s36 offen sc1
s_waitcnt lgkmcnt(10)
s_mul_i32 s36, s60, 1
s_add_u32 s36, s36, s57
s_add_u32 s36, s36, 36864
buffer_store_dwordx4 v[60:63], v14, s[28:31], s36 offen sc1
s_waitcnt lgkmcnt(8)
s_mul_i32 s36, s60, 1
s_add_u32 s36, s36, s57
s_add_u32 s36, s36, 37888
buffer_store_dwordx4 v[64:67], v14, s[28:31], s36 offen sc1
s_waitcnt lgkmcnt(6)
s_mul_i32 s36, s60, 1
s_add_u32 s36, s36, s57
s_add_u32 s36, s36, 38912
buffer_store_dwordx4 v[68:71], v14, s[28:31], s36 offen sc1
s_waitcnt lgkmcnt(4)
s_mul_i32 s36, s60, 0
s_add_u32 s36, s36, s57
s_add_u32 s36, s36, 110592
buffer_store_dwordx4 v[72:75], v14, s[28:31], s36 offen sc1
s_waitcnt lgkmcnt(2)
s_mul_i32 s36, s60, 0
s_add_u32 s36, s36, s57
s_add_u32 s36, s36, 111616
buffer_store_dwordx4 v[76:79], v14, s[28:31], s36 offen sc1
s_waitcnt lgkmcnt(0)
s_mul_i32 s36, s60, 0
s_add_u32 s36, s36, s57
s_add_u32 s36, s36, 112640
buffer_store_dwordx4 v[80:83], v14, s[28:31], s36 offen sc1
fused_kernel_pdone_2:
s_branch fused_kernel_auxw
fused_kernel_two1:
s_mov_b32 s74, s42
s_lshl_b32 s75, s42, 5
s_mul_i32 s36, s20, 8
s_add_u32 s36, s36, s75
v_lshrrev_b32 v8, 3, v2
v_add_u32 v9, s36, v8
v_mul_u32_u24 v10, 1152, v9
v_and_b32 v11, 7, v2
v_lshl_add_u32 v10, v11, 4, v10
s_mov_b32 s64, s10
s_and_b32 s65, s11, 0xffff
s_mov_b32 s66, 2359296
s_mov_b32 s67, 0x20000
s_mov_b32 s36, 9216
buffer_load_dwordx4 v[104:107], v10, s[64:67], 0 offen offset:0
buffer_load_dwordx4 v[108:111], v10, s[64:67], 0 offen offset:128
buffer_load_dwordx4 v[112:115], v10, s[64:67], 0 offen offset:256
buffer_load_dwordx4 v[116:119], v10, s[64:67], 0 offen offset:384
buffer_load_dwordx4 v[120:123], v10, s[64:67], 0 offen offset:512
buffer_load_dwordx4 v[124:127], v10, s[64:67], 0 offen offset:640
buffer_load_dwordx4 v[128:131], v10, s[64:67], 0 offen offset:768
buffer_load_dwordx4 v[132:135], v10, s[64:67], 0 offen offset:896
buffer_load_dwordx4 v[136:139], v10, s[64:67], 0 offen offset:1024
s_add_u32 s64, s16, 7143424
s_addc_u32 s65, s17, 0
s_and_b32 s65, s65, 0xffff
s_mov_b32 s66, 16384
s_mov_b32 s67, 0x20000
v_lshlrev_b32 v9, 2, v9
v_add_u32 v10, 8192, v9
v_cmp_eq_u32 s[68:69], 0, v11
s_waitcnt vmcnt(0)
v_dot2_f32_bf16 v88, v104, v15, 0
v_dot2_f32_bf16 v90, v104, v104, 0
v_dot2_f32_bf16 v89, v105, v15, 0
v_dot2_f32_bf16 v91, v105, v105, 0
v_dot2_f32_bf16 v88, v106, v15, v88
v_dot2_f32_bf16 v90, v106, v106, v90
v_dot2_f32_bf16 v89, v107, v15, v89
v_dot2_f32_bf16 v91, v107, v107, v91
v_dot2_f32_bf16 v88, v108, v15, v88
v_dot2_f32_bf16 v90, v108, v108, v90
v_dot2_f32_bf16 v89, v109, v15, v89
v_dot2_f32_bf16 v91, v109, v109, v91
v_dot2_f32_bf16 v88, v110, v15, v88
v_dot2_f32_bf16 v90, v110, v110, v90
v_dot2_f32_bf16 v89, v111, v15, v89
v_dot2_f32_bf16 v91, v111, v111, v91
v_dot2_f32_bf16 v88, v112, v15, v88
v_dot2_f32_bf16 v90, v112, v112, v90
v_dot2_f32_bf16 v89, v113, v15, v89
v_dot2_f32_bf16 v91, v113, v113, v91
v_dot2_f32_bf16 v88, v114, v15, v88
v_dot2_f32_bf16 v90, v114, v114, v90
v_dot2_f32_bf16 v89, v115, v15, v89
v_dot2_f32_bf16 v91, v115, v115, v91
v_dot2_f32_bf16 v88, v116, v15, v88
v_dot2_f32_bf16 v90, v116, v116, v90
v_dot2_f32_bf16 v89, v117, v15, v89
v_dot2_f32_bf16 v91, v117, v117, v91
v_dot2_f32_bf16 v88, v118, v15, v88
v_dot2_f32_bf16 v90, v118, v118, v90
v_dot2_f32_bf16 v89, v119, v15, v89
v_dot2_f32_bf16 v91, v119, v119, v91
v_dot2_f32_bf16 v88, v120, v15, v88
v_dot2_f32_bf16 v90, v120, v120, v90
v_dot2_f32_bf16 v89, v121, v15, v89
v_dot2_f32_bf16 v91, v121, v121, v91
v_dot2_f32_bf16 v88, v122, v15, v88
v_dot2_f32_bf16 v90, v122, v122, v90
v_dot2_f32_bf16 v89, v123, v15, v89
v_dot2_f32_bf16 v91, v123, v123, v91
v_dot2_f32_bf16 v88, v124, v15, v88
v_dot2_f32_bf16 v90, v124, v124, v90
v_dot2_f32_bf16 v89, v125, v15, v89
v_dot2_f32_bf16 v91, v125, v125, v91
v_dot2_f32_bf16 v88, v126, v15, v88
v_dot2_f32_bf16 v90, v126, v126, v90
v_dot2_f32_bf16 v89, v127, v15, v89
v_dot2_f32_bf16 v91, v127, v127, v91
v_dot2_f32_bf16 v88, v128, v15, v88
v_dot2_f32_bf16 v90, v128, v128, v90
v_dot2_f32_bf16 v89, v129, v15, v89
v_dot2_f32_bf16 v91, v129, v129, v91
v_dot2_f32_bf16 v88, v130, v15, v88
v_dot2_f32_bf16 v90, v130, v130, v90
v_dot2_f32_bf16 v89, v131, v15, v89
v_dot2_f32_bf16 v91, v131, v131, v91
v_dot2_f32_bf16 v88, v132, v15, v88
v_dot2_f32_bf16 v90, v132, v132, v90
v_dot2_f32_bf16 v89, v133, v15, v89
v_dot2_f32_bf16 v91, v133, v133, v91
v_dot2_f32_bf16 v88, v134, v15, v88
v_dot2_f32_bf16 v90, v134, v134, v90
v_dot2_f32_bf16 v89, v135, v15, v89
v_dot2_f32_bf16 v91, v135, v135, v91
v_dot2_f32_bf16 v88, v136, v15, v88
v_dot2_f32_bf16 v90, v136, v136, v90
v_dot2_f32_bf16 v89, v137, v15, v89
v_dot2_f32_bf16 v91, v137, v137, v91
v_dot2_f32_bf16 v88, v138, v15, v88
v_dot2_f32_bf16 v90, v138, v138, v90
v_dot2_f32_bf16 v89, v139, v15, v89
v_dot2_f32_bf16 v91, v139, v139, v91
s_nop 2
v_add_f32 v88, v88, v89
v_add_f32 v90, v90, v91
s_nop 1
v_add_f32_dpp v88, v88, v88 quad_perm:[1,0,3,2] row_mask:0xf bank_mask:0xf
v_add_f32_dpp v90, v90, v90 quad_perm:[1,0,3,2] row_mask:0xf bank_mask:0xf
s_nop 1
v_add_f32_dpp v88, v88, v88 quad_perm:[2,3,0,1] row_mask:0xf bank_mask:0xf
v_add_f32_dpp v90, v90, v90 quad_perm:[2,3,0,1] row_mask:0xf bank_mask:0xf
s_nop 1
v_add_f32_dpp v88, v88, v88 row_half_mirror row_mask:0xf bank_mask:0xf
v_add_f32_dpp v90, v90, v90 row_half_mirror row_mask:0xf bank_mask:0xf
v_mul_f32 v88, 0x3ae38e39, v88
v_mul_f32 v90, 0x3ae38e39, v90
v_fma_f32 v90, -v88, v88, v90
v_max_f32 v90, 0, v90
v_cvt_pk_bf16_f32 v88, v88, v88
v_and_b32 v88, 0xffff0000, v88
v_cvt_pk_bf16_f32 v90, v90, v90
v_and_b32 v90, 0xffff0000, v90
v_add_f32 v90, 0x3727c5ac, v90
v_cvt_pk_bf16_f32 v90, v90, v90
v_and_b32 v90, 0xffff0000, v90
v_sqrt_f32 v90, v90
s_nop 0
v_cvt_pk_bf16_f32 v90, v90, v90
v_and_b32 v90, 0xffff0000, v90
v_rcp_f32 v92, v90
s_nop 0
v_mul_f32 v90, v88, v92
v_sub_f32 v90, 0, v90
v_mov_b32 v88, v92
s_mov_b64 exec, s[68:69]
buffer_store_dword v88, v9, s[64:67], 0 offen offset:0 sc1
buffer_store_dword v90, v10, s[64:67], 0 offen offset:0 sc1
s_mov_b64 exec, -1
s_waitcnt vmcnt(0)
s_barrier
s_cmp_lg_u32 s20, 0
s_cbranch_scc1 fused_kernel_psa
s_lshl_b32 s78, s74, 6
s_add_u32 s78, s78, 38928384
v_mov_b32 v8, s78
v_mov_b32 v9, s76
s_mov_b64 exec, 1
global_store_dword v8, v9, s[16:17] sc1
s_mov_b64 exec, -1
fused_kernel_psa:
s_add_u32 s52, s42, 0
s_lshr_b32 s36, s52, 1
s_and_b32 s37, s52, 1
s_mul_i32 s38, s37, 288
s_lshl_b32 s39, s20, 3
s_add_u32 s38, s38, s39
s_mul_i32 s38, s38, 9216
s_lshl_b32 s39, s36, 7
s_add_u32 s38, s38, s39
s_lshl_b32 s39, s20, 10
s_add_u32 s39, s39, 0
s_mov_b32 m0, s39
s_add_u32 s39, s39, 4096
buffer_load_dwordx4 v4, s[24:27], s38 offen lds
s_add_u32 s38, s38, 294912
s_mov_b32 m0, s39
s_add_u32 s39, s39, 4096
buffer_load_dwordx4 v4, s[24:27], s38 offen lds
s_add_u32 s38, s38, 294912
s_mov_b32 m0, s39
s_add_u32 s39, s39, 4096
buffer_load_dwordx4 v4, s[24:27], s38 offen lds
s_add_u32 s38, s38, 294912
s_mov_b32 m0, s39
s_add_u32 s39, s39, 4096
buffer_load_dwordx4 v4, s[24:27], s38 offen lds
s_add_u32 s38, s38, 294912
s_mov_b32 m0, s39
s_add_u32 s39, s39, 4096
buffer_load_dwordx4 v4, s[24:27], s38 offen lds
s_add_u32 s38, s38, 294912
s_mov_b32 m0, s39
s_add_u32 s39, s39, 4096
buffer_load_dwordx4 v4, s[24:27], s38 offen lds
s_add_u32 s38, s38, 294912
s_mov_b32 m0, s39
s_add_u32 s39, s39, 4096
buffer_load_dwordx4 v4, s[24:27], s38 offen lds
s_add_u32 s38, s38, 294912
s_mov_b32 m0, s39
s_add_u32 s39, s39, 4096
buffer_load_dwordx4 v4, s[24:27], s38 offen lds
s_add_u32 s38, s38, 294912
s_mov_b32 m0, s39
s_add_u32 s39, s39, 4096
buffer_load_dwordx4 v4, s[24:27], s38 offen lds
s_add_u32 s38, s38, 294912
s_lshl_b32 s36, s36, 2
s_add_u32 s36, s36, s20
v_and_b32 v8, 15, v2
s_lshl_b32 s38, s36, 4
v_add_u32 v36, s38, v8
v_lshlrev_b32 v8, 1, v36
buffer_load_ushort v40, v8, s[44:47], 0 offen
s_mul_hi_u32 s38, s36, 477218589
s_mul_i32 s40, s38, 9
s_sub_u32 s39, s36, s40
s_mul_hi_u32 s41, s39, 1431655766
s_mul_i32 s40, s41, 3
s_sub_u32 s43, s39, s40
s_mul_i32 s38, s38, 331776
s_mul_i32 s41, s41, 55296
s_add_u32 s38, s38, s41
s_lshl_b32 s43, s43, 10
s_add_u32 s38, s38, s43
s_mul_i32 s37, s37, 27648
s_add_u32 s55, s38, s37
s_add_u32 s53, s42, 112
s_cmp_ge_u32 s53, 144
s_cbranch_scc1 fused_kernel_iw2_1c
s_lshr_b32 s36, s53, 1
s_and_b32 s37, s53, 1
s_mul_i32 s38, s37, 288
s_lshl_b32 s39, s20, 3
s_add_u32 s38, s38, s39
s_mul_i32 s38, s38, 9216
s_lshl_b32 s39, s36, 7
s_add_u32 s38, s38, s39
s_lshl_b32 s39, s20, 10
s_add_u32 s39, s39, 36864
s_mov_b32 m0, s39
s_add_u32 s39, s39, 4096
buffer_load_dwordx4 v4, s[24:27], s38 offen lds
s_add_u32 s38, s38, 294912
s_mov_b32 m0, s39
s_add_u32 s39, s39, 4096
buffer_load_dwordx4 v4, s[24:27], s38 offen lds
s_add_u32 s38, s38, 294912
s_mov_b32 m0, s39
s_add_u32 s39, s39, 4096
buffer_load_dwordx4 v4, s[24:27], s38 offen lds
s_add_u32 s38, s38, 294912
s_mov_b32 m0, s39
s_add_u32 s39, s39, 4096
buffer_load_dwordx4 v4, s[24:27], s38 offen lds
s_add_u32 s38, s38, 294912
s_mov_b32 m0, s39
s_add_u32 s39, s39, 4096
buffer_load_dwordx4 v4, s[24:27], s38 offen lds
s_add_u32 s38, s38, 294912
s_mov_b32 m0, s39
s_add_u32 s39, s39, 4096
buffer_load_dwordx4 v4, s[24:27], s38 offen lds
s_add_u32 s38, s38, 294912
s_mov_b32 m0, s39
s_add_u32 s39, s39, 4096
buffer_load_dwordx4 v4, s[24:27], s38 offen lds
s_add_u32 s38, s38, 294912
s_mov_b32 m0, s39
s_add_u32 s39, s39, 4096
buffer_load_dwordx4 v4, s[24:27], s38 offen lds
s_add_u32 s38, s38, 294912
s_mov_b32 m0, s39
s_add_u32 s39, s39, 4096
buffer_load_dwordx4 v4, s[24:27], s38 offen lds
s_add_u32 s38, s38, 294912
s_lshl_b32 s36, s36, 2
s_add_u32 s36, s36, s20
v_and_b32 v8, 15, v2
s_lshl_b32 s38, s36, 4
v_add_u32 v37, s38, v8
v_lshlrev_b32 v8, 1, v37
buffer_load_ushort v41, v8, s[44:47], 0 offen
s_mul_hi_u32 s38, s36, 477218589
s_mul_i32 s40, s38, 9
s_sub_u32 s39, s36, s40
s_mul_hi_u32 s41, s39, 1431655766
s_mul_i32 s40, s41, 3
s_sub_u32 s43, s39, s40
s_mul_i32 s38, s38, 331776
s_mul_i32 s41, s41, 55296
s_add_u32 s38, s38, s41
s_lshl_b32 s43, s43, 10
s_add_u32 s38, s38, s43
s_mul_i32 s37, s37, 27648
s_add_u32 s56, s38, s37
s_branch fused_kernel_idone_1c
fused_kernel_iw2_1c:
s_sub_u32 s36, s53, 144
s_mul_hi_u32 s37, s36, 238609295
s_mul_i32 s40, s37, 18
s_sub_u32 s41, s36, s40
s_lshr_b32 s39, s41, 2
s_lshl_b32 s39, s39, 5
s_and_b32 s40, s41, 3
s_mul_i32 s40, s40, 144
s_add_u32 s39, s39, s40
s_sub_u32 s40, s41, 16
s_mul_i32 s40, s40, 288
s_add_u32 s40, s40, 128
s_cmp_ge_u32 s41, 16
s_cselect_b32 s39, s40, s39
s_cselect_b32 s38, 147456, 0
s_mul_i32 s40, s37, 576
s_add_u32 s39, s39, s40
s_mul_i32 s39, s39, 1152
s_mul_i32 s40, s20, 288
s_add_u32 s39, s39, s40
v_add_u32 v25, 0, v2
v_mul_u32_u24 v26, 3641, v25
v_lshrrev_b32 v26, 16, v26
v_mul_u32_u24 v27, 18, v26
v_sub_u32 v25, v25, v27
v_mul_u32_u24 v27, 1152, v26
v_lshl_add_u32 v25, v25, 4, v27
v_lshrrev_b32 v26, 4, v26
v_mad_u32_u24 v16, v26, s38, v25
v_add_u32 v25, 64, v2
v_mul_u32_u24 v26, 3641, v25
v_lshrrev_b32 v26, 16, v26
v_mul_u32_u24 v27, 18, v26
v_sub_u32 v25, v25, v27
v_mul_u32_u24 v27, 1152, v26
v_lshl_add_u32 v25, v25, 4, v27
v_lshrrev_b32 v26, 4, v26
v_mad_u32_u24 v17, v26, s38, v25
v_add_u32 v25, 128, v2
v_mul_u32_u24 v26, 3641, v25
v_lshrrev_b32 v26, 16, v26
v_mul_u32_u24 v27, 18, v26
v_sub_u32 v25, v25, v27
v_mul_u32_u24 v27, 1152, v26
v_lshl_add_u32 v25, v25, 4, v27
v_lshrrev_b32 v26, 4, v26
v_mad_u32_u24 v18, v26, s38, v25
v_add_u32 v25, 192, v2
v_mul_u32_u24 v26, 3641, v25
v_lshrrev_b32 v26, 16, v26
v_mul_u32_u24 v27, 18, v26
v_sub_u32 v25, v25, v27
v_mul_u32_u24 v27, 1152, v26
v_lshl_add_u32 v25, v25, 4, v27
v_lshrrev_b32 v26, 4, v26
v_mad_u32_u24 v19, v26, s38, v25
v_add_u32 v25, 256, v2
v_mul_u32_u24 v26, 3641, v25
v_lshrrev_b32 v26, 16, v26
v_mul_u32_u24 v27, 18, v26
v_sub_u32 v25, v25, v27
v_mul_u32_u24 v27, 1152, v26
v_lshl_add_u32 v25, v25, 4, v27
v_lshrrev_b32 v26, 4, v26
v_mad_u32_u24 v20, v26, s38, v25
v_add_u32 v25, 320, v2
v_mul_u32_u24 v26, 3641, v25
v_lshrrev_b32 v26, 16, v26
v_mul_u32_u24 v27, 18, v26
v_sub_u32 v25, v25, v27
v_mul_u32_u24 v27, 1152, v26
v_lshl_add_u32 v25, v25, 4, v27
v_lshrrev_b32 v26, 4, v26
v_mad_u32_u24 v21, v26, s38, v25
v_add_u32 v25, 384, v2
v_mul_u32_u24 v26, 3641, v25
v_lshrrev_b32 v26, 16, v26
v_mul_u32_u24 v27, 18, v26
v_sub_u32 v25, v25, v27
v_mul_u32_u24 v27, 1152, v26
v_lshl_add_u32 v25, v25, 4, v27
v_lshrrev_b32 v26, 4, v26
v_mad_u32_u24 v22, v26, s38, v25
v_add_u32 v25, 448, v2
v_mul_u32_u24 v26, 3641, v25
v_lshrrev_b32 v26, 16, v26
v_mul_u32_u24 v27, 18, v26
v_sub_u32 v25, v25, v27
v_mul_u32_u24 v27, 1152, v26
v_lshl_add_u32 v25, v25, 4, v27
v_lshrrev_b32 v26, 4, v26
v_mad_u32_u24 v23, v26, s38, v25
v_add_u32 v25, 512, v2
v_mul_u32_u24 v26, 3641, v25
v_lshrrev_b32 v26, 16, v26
v_mul_u32_u24 v27, 18, v26
v_sub_u32 v25, v25, v27
v_mul_u32_u24 v27, 1152, v26
v_lshl_add_u32 v25, v25, 4, v27
v_lshrrev_b32 v26, 4, v26
v_mad_u32_u24 v24, v26, s38, v25
s_lshl_b32 s40, s37, 2
s_add_u32 s40, s40, s20
s_mul_i32 s40, s40, 331776
s_mul_i32 s38, s41, 3072
s_add_u32 s40, s40, s38
s_add_u32 s56, s40, 165888
s_cmp_ge_u32 s41, 12
s_cselect_b32 s59, 18432, 0
s_mul_i32 s41, s20, 9216
s_add_u32 s41, s41, 36864
s_mov_b32 m0, s41
s_add_u32 s41, s41, 1024
buffer_load_dwordx4 v16, s[48:51], s39 offen lds
s_mov_b32 m0, s41
s_add_u32 s41, s41, 1024
buffer_load_dwordx4 v17, s[48:51], s39 offen lds
s_mov_b32 m0, s41
s_add_u32 s41, s41, 1024
buffer_load_dwordx4 v18, s[48:51], s39 offen lds
s_mov_b32 m0, s41
s_add_u32 s41, s41, 1024
buffer_load_dwordx4 v19, s[48:51], s39 offen lds
s_mov_b32 m0, s41
s_add_u32 s41, s41, 1024
buffer_load_dwordx4 v20, s[48:51], s39 offen lds
s_mov_b32 m0, s41
s_add_u32 s41, s41, 1024
buffer_load_dwordx4 v21, s[48:51], s39 offen lds
s_mov_b32 m0, s41
s_add_u32 s41, s41, 1024
buffer_load_dwordx4 v22, s[48:51], s39 offen lds
s_mov_b32 m0, s41
s_add_u32 s41, s41, 1024
buffer_load_dwordx4 v23, s[48:51], s39 offen lds
s_mov_b32 m0, s41
s_add_u32 s41, s41, 1024
buffer_load_dwordx4 v24, s[48:51], s39 offen lds
buffer_load_ushort v41, v14, s[44:47], 0 offen
fused_kernel_idone_1c:
s_waitcnt vmcnt(10)
s_barrier
v_add_u32 v8, 0, v3
ds_read_b64_tr_b16 v[48:49], v8 offset:0
ds_read_b64_tr_b16 v[50:51], v8 offset:512
ds_read_b64_tr_b16 v[52:53], v8 offset:4096
ds_read_b64_tr_b16 v[54:55], v8 offset:4608
ds_read_b64_tr_b16 v[56:57], v8 offset:8192
ds_read_b64_tr_b16 v[58:59], v8 offset:8704
ds_read_b64_tr_b16 v[60:61], v8 offset:12288
ds_read_b64_tr_b16 v[62:63], v8 offset:12800
ds_read_b64_tr_b16 v[64:65], v8 offset:16384
ds_read_b64_tr_b16 v[66:67], v8 offset:16896
ds_read_b64_tr_b16 v[68:69], v8 offset:20480
ds_read_b64_tr_b16 v[70:71], v8 offset:20992
ds_read_b64_tr_b16 v[72:73], v8 offset:24576
ds_read_b64_tr_b16 v[74:75], v8 offset:25088
ds_read_b64_tr_b16 v[76:77], v8 offset:28672
ds_read_b64_tr_b16 v[78:79], v8 offset:29184
ds_read_b64_tr_b16 v[80:81], v8 offset:32768
ds_read_b64_tr_b16 v[82:83], v8 offset:33280
s_waitcnt lgkmcnt(15)
buffer_store_dwordx4 v[48:51], v14, s[28:31], s55 offen sc1
s_add_u32 s55, s55, 3072
s_waitcnt lgkmcnt(14)
buffer_store_dwordx4 v[52:55], v14, s[28:31], s55 offen sc1
s_add_u32 s55, s55, 3072
s_waitcnt lgkmcnt(12)
buffer_store_dwordx4 v[56:59], v14, s[28:31], s55 offen sc1
s_add_u32 s55, s55, 3072
s_waitcnt lgkmcnt(10)
buffer_store_dwordx4 v[60:63], v14, s[28:31], s55 offen sc1
s_add_u32 s55, s55, 3072
s_waitcnt lgkmcnt(8)
buffer_store_dwordx4 v[64:67], v14, s[28:31], s55 offen sc1
s_add_u32 s55, s55, 3072
s_waitcnt lgkmcnt(6)
buffer_store_dwordx4 v[68:71], v14, s[28:31], s55 offen sc1
s_add_u32 s55, s55, 3072
s_waitcnt lgkmcnt(4)
buffer_store_dwordx4 v[72:75], v14, s[28:31], s55 offen sc1
s_add_u32 s55, s55, 3072
s_waitcnt lgkmcnt(2)
buffer_store_dwordx4 v[76:79], v14, s[28:31], s55 offen sc1
s_add_u32 s55, s55, 3072
s_waitcnt lgkmcnt(0)
buffer_store_dwordx4 v[80:83], v14, s[28:31], s55 offen sc1
s_add_u32 s55, s55, 3072
v_dot2_f32_bf16 v44, v48, v15, 0
v_dot2_f32_bf16 v45, v49, v15, 0
v_dot2_f32_bf16 v44, v50, v15, v44
v_dot2_f32_bf16 v45, v51, v15, v45
v_dot2_f32_bf16 v44, v52, v15, v44
v_dot2_f32_bf16 v45, v53, v15, v45
v_dot2_f32_bf16 v44, v54, v15, v44
v_dot2_f32_bf16 v45, v55, v15, v45
v_dot2_f32_bf16 v44, v56, v15, v44
v_dot2_f32_bf16 v45, v57, v15, v45
v_dot2_f32_bf16 v44, v58, v15, v44
v_dot2_f32_bf16 v45, v59, v15, v45
v_dot2_f32_bf16 v44, v60, v15, v44
v_dot2_f32_bf16 v45, v61, v15, v45
v_dot2_f32_bf16 v44, v62, v15, v44
v_dot2_f32_bf16 v45, v63, v15, v45
v_dot2_f32_bf16 v44, v64, v15, v44
v_dot2_f32_bf16 v45, v65, v15, v45
v_dot2_f32_bf16 v44, v66, v15, v44
v_dot2_f32_bf16 v45, v67, v15, v45
v_dot2_f32_bf16 v44, v68, v15, v44
v_dot2_f32_bf16 v45, v69, v15, v45
v_dot2_f32_bf16 v44, v70, v15, v44
v_dot2_f32_bf16 v45, v71, v15, v45
v_dot2_f32_bf16 v44, v72, v15, v44
v_dot2_f32_bf16 v45, v73, v15, v45
v_dot2_f32_bf16 v44, v74, v15, v44
v_dot2_f32_bf16 v45, v75, v15, v45
v_dot2_f32_bf16 v44, v76, v15, v44
v_dot2_f32_bf16 v45, v77, v15, v45
v_dot2_f32_bf16 v44, v78, v15, v44
v_dot2_f32_bf16 v45, v79, v15, v45
v_dot2_f32_bf16 v44, v80, v15, v44
v_dot2_f32_bf16 v45, v81, v15, v45
v_dot2_f32_bf16 v44, v82, v15, v44
v_dot2_f32_bf16 v45, v83, v15, v45
s_nop 2
v_add_f32 v44, v44, v45
s_nop 0
v_mov_b32 v45, v44
s_nop 1
v_permlane32_swap_b32 v44, v45
v_add_f32 v44, v44, v45
s_nop 0
v_mov_b32 v45, v44
s_nop 1
v_permlane16_swap_b32 v44, v45
v_add_f32 v44, v44, v45
v_lshlrev_b32 v45, 16, v40
v_mul_f32 v45, 0x3fb8aa3b, v45
v_lshlrev_b32 v8, 2, v36
s_and_b32 s36, s52, 1
s_mul_i32 s36, s36, 18432
s_mov_b32 s37, 36864
v_cmp_gt_u32 vcc, 16, v2
s_and_saveexec_b64 s[38:39], vcc
buffer_store_dword v44, v8, s[32:35], s36 offen sc1
buffer_store_dword v45, v8, s[32:35], s37 offen sc1
s_mov_b64 exec, s[38:39]
s_waitcnt vmcnt(11)
s_cmp_ge_u32 s53, 144
s_cbranch_scc1 fused_kernel_pw2_1c
s_barrier
v_add_u32 v8, 36864, v3
ds_read_b64_tr_b16 v[48:49], v8 offset:0
ds_read_b64_tr_b16 v[50:51], v8 offset:512
ds_read_b64_tr_b16 v[52:53], v8 offset:4096
ds_read_b64_tr_b16 v[54:55], v8 offset:4608
ds_read_b64_tr_b16 v[56:57], v8 offset:8192
ds_read_b64_tr_b16 v[58:59], v8 offset:8704
ds_read_b64_tr_b16 v[60:61], v8 offset:12288
ds_read_b64_tr_b16 v[62:63], v8 offset:12800
ds_read_b64_tr_b16 v[64:65], v8 offset:16384
ds_read_b64_tr_b16 v[66:67], v8 offset:16896
ds_read_b64_tr_b16 v[68:69], v8 offset:20480
ds_read_b64_tr_b16 v[70:71], v8 offset:20992
ds_read_b64_tr_b16 v[72:73], v8 offset:24576
ds_read_b64_tr_b16 v[74:75], v8 offset:25088
ds_read_b64_tr_b16 v[76:77], v8 offset:28672
ds_read_b64_tr_b16 v[78:79], v8 offset:29184
ds_read_b64_tr_b16 v[80:81], v8 offset:32768
ds_read_b64_tr_b16 v[82:83], v8 offset:33280
s_waitcnt lgkmcnt(15)
buffer_store_dwordx4 v[48:51], v14, s[28:31], s56 offen sc1
s_add_u32 s56, s56, 3072
s_waitcnt lgkmcnt(14)
buffer_store_dwordx4 v[52:55], v14, s[28:31], s56 offen sc1
s_add_u32 s56, s56, 3072
s_waitcnt lgkmcnt(12)
buffer_store_dwordx4 v[56:59], v14, s[28:31], s56 offen sc1
s_add_u32 s56, s56, 3072
s_waitcnt lgkmcnt(10)
buffer_store_dwordx4 v[60:63], v14, s[28:31], s56 offen sc1
s_add_u32 s56, s56, 3072
s_waitcnt lgkmcnt(8)
buffer_store_dwordx4 v[64:67], v14, s[28:31], s56 offen sc1
s_add_u32 s56, s56, 3072
s_waitcnt lgkmcnt(6)
buffer_store_dwordx4 v[68:71], v14, s[28:31], s56 offen sc1
s_add_u32 s56, s56, 3072
s_waitcnt lgkmcnt(4)
buffer_store_dwordx4 v[72:75], v14, s[28:31], s56 offen sc1
s_add_u32 s56, s56, 3072
s_waitcnt lgkmcnt(2)
buffer_store_dwordx4 v[76:79], v14, s[28:31], s56 offen sc1
s_add_u32 s56, s56, 3072
s_waitcnt lgkmcnt(0)
buffer_store_dwordx4 v[80:83], v14, s[28:31], s56 offen sc1
s_add_u32 s56, s56, 3072
v_dot2_f32_bf16 v44, v48, v15, 0
v_dot2_f32_bf16 v45, v49, v15, 0
v_dot2_f32_bf16 v44, v50, v15, v44
v_dot2_f32_bf16 v45, v51, v15, v45
v_dot2_f32_bf16 v44, v52, v15, v44
v_dot2_f32_bf16 v45, v53, v15, v45
v_dot2_f32_bf16 v44, v54, v15, v44
v_dot2_f32_bf16 v45, v55, v15, v45
v_dot2_f32_bf16 v44, v56, v15, v44
v_dot2_f32_bf16 v45, v57, v15, v45
v_dot2_f32_bf16 v44, v58, v15, v44
v_dot2_f32_bf16 v45, v59, v15, v45
v_dot2_f32_bf16 v44, v60, v15, v44
v_dot2_f32_bf16 v45, v61, v15, v45
v_dot2_f32_bf16 v44, v62, v15, v44
v_dot2_f32_bf16 v45, v63, v15, v45
v_dot2_f32_bf16 v44, v64, v15, v44
v_dot2_f32_bf16 v45, v65, v15, v45
v_dot2_f32_bf16 v44, v66, v15, v44
v_dot2_f32_bf16 v45, v67, v15, v45
v_dot2_f32_bf16 v44, v68, v15, v44
v_dot2_f32_bf16 v45, v69, v15, v45
v_dot2_f32_bf16 v44, v70, v15, v44
v_dot2_f32_bf16 v45, v71, v15, v45
v_dot2_f32_bf16 v44, v72, v15, v44
v_dot2_f32_bf16 v45, v73, v15, v45
v_dot2_f32_bf16 v44, v74, v15, v44
v_dot2_f32_bf16 v45, v75, v15, v45
v_dot2_f32_bf16 v44, v76, v15, v44
v_dot2_f32_bf16 v45, v77, v15, v45
v_dot2_f32_bf16 v44, v78, v15, v44
v_dot2_f32_bf16 v45, v79, v15, v45
v_dot2_f32_bf16 v44, v80, v15, v44
v_dot2_f32_bf16 v45, v81, v15, v45
v_dot2_f32_bf16 v44, v82, v15, v44
v_dot2_f32_bf16 v45, v83, v15, v45
s_nop 2
v_add_f32 v44, v44, v45
s_nop 0
v_mov_b32 v45, v44
s_nop 1
v_permlane32_swap_b32 v44, v45
v_add_f32 v44, v44, v45
s_nop 0
v_mov_b32 v45, v44
s_nop 1
v_permlane16_swap_b32 v44, v45
v_add_f32 v44, v44, v45
v_lshlrev_b32 v45, 16, v41
v_mul_f32 v45, 0x3fb8aa3b, v45
v_lshlrev_b32 v8, 2, v37
s_and_b32 s36, s53, 1
s_mul_i32 s36, s36, 18432
s_mov_b32 s37, 36864
v_cmp_gt_u32 vcc, 16, v2
s_and_saveexec_b64 s[38:39], vcc
buffer_store_dword v44, v8, s[32:35], s36 offen sc1
buffer_store_dword v45, v8, s[32:35], s37 offen sc1
s_mov_b64 exec, s[38:39]
s_branch fused_kernel_pdone_1c
fused_kernel_pw2_1c:
v_add_u32 v8, 36864, v12
v_add_u32 v9, 36864, v13
ds_read_b64_tr_b16 v[48:49], v8 offset:0
ds_read_b64_tr_b16 v[50:51], v8 offset:4608
ds_read_b64_tr_b16 v[52:53], v8 offset:8
ds_read_b64_tr_b16 v[54:55], v8 offset:4616
ds_read_b64_tr_b16 v[56:57], v8 offset:64
ds_read_b64_tr_b16 v[58:59], v8 offset:4672
ds_read_b64_tr_b16 v[60:61], v8 offset:72
ds_read_b64_tr_b16 v[62:63], v8 offset:4680
ds_read_b64_tr_b16 v[64:65], v8 offset:128
ds_read_b64_tr_b16 v[66:67], v8 offset:4736
ds_read_b64_tr_b16 v[68:69], v8 offset:136
ds_read_b64_tr_b16 v[70:71], v8 offset:4744
ds_read_b64_tr_b16 v[72:73], v8 offset:192
ds_read_b64_tr_b16 v[74:75], v8 offset:4800
ds_read_b64_tr_b16 v[76:77], v8 offset:200
ds_read_b64_tr_b16 v[78:79], v8 offset:4808
ds_read_b64_tr_b16 v[80:81], v9 offset:256
ds_read_b64_tr_b16 v[82:83], v9 offset:4864
s_waitcnt lgkmcnt(15)
s_mul_i32 s36, s59, 2
s_add_u32 s36, s36, s56
s_add_u32 s36, s36, 0
buffer_store_dwordx4 v[48:51], v14, s[28:31], s36 offen sc1
s_waitcnt lgkmcnt(14)
s_mul_i32 s36, s59, 2
s_add_u32 s36, s36, s56
s_add_u32 s36, s36, 1024
buffer_store_dwordx4 v[52:55], v14, s[28:31], s36 offen sc1
s_waitcnt lgkmcnt(12)
s_mul_i32 s36, s59, 2
s_add_u32 s36, s36, s56
s_add_u32 s36, s36, 2048
buffer_store_dwordx4 v[56:59], v14, s[28:31], s36 offen sc1
s_waitcnt lgkmcnt(10)
s_mul_i32 s36, s59, 1
s_add_u32 s36, s36, s56
s_add_u32 s36, s36, 36864
buffer_store_dwordx4 v[60:63], v14, s[28:31], s36 offen sc1
s_waitcnt lgkmcnt(8)
s_mul_i32 s36, s59, 1
s_add_u32 s36, s36, s56
s_add_u32 s36, s36, 37888
buffer_store_dwordx4 v[64:67], v14, s[28:31], s36 offen sc1
s_waitcnt lgkmcnt(6)
s_mul_i32 s36, s59, 1
s_add_u32 s36, s36, s56
s_add_u32 s36, s36, 38912
buffer_store_dwordx4 v[68:71], v14, s[28:31], s36 offen sc1
s_waitcnt lgkmcnt(4)
s_mul_i32 s36, s59, 0
s_add_u32 s36, s36, s56
s_add_u32 s36, s36, 110592
buffer_store_dwordx4 v[72:75], v14, s[28:31], s36 offen sc1
s_waitcnt lgkmcnt(2)
s_mul_i32 s36, s59, 0
s_add_u32 s36, s36, s56
s_add_u32 s36, s36, 111616
buffer_store_dwordx4 v[76:79], v14, s[28:31], s36 offen sc1
s_waitcnt lgkmcnt(0)
s_mul_i32 s36, s59, 0
s_add_u32 s36, s36, s56
s_add_u32 s36, s36, 112640
buffer_store_dwordx4 v[80:83], v14, s[28:31], s36 offen sc1
fused_kernel_pdone_1c:
s_waitcnt vmcnt(0)
s_barrier
s_cmp_lg_u32 s20, 0
s_cbranch_scc1 fused_kernel_pw1b
s_lshl_b32 s78, s42, 6
s_add_u32 s78, s78, 38797312
v_mov_b32 v8, s78
v_mov_b32 v9, s76
s_mov_b64 exec, 1
global_store_dword v8, v9, s[16:17] sc1
s_mov_b64 exec, -1
fused_kernel_pw1b:
s_branch fused_kernel_auxw
fused_kernel_two:
s_sub_u32 s74, s42, 96
s_lshl_b32 s74, s74, 1
s_add_u32 s74, s74, 32
s_lshl_b32 s75, s74, 5
s_mul_i32 s36, s20, 16
s_add_u32 s36, s36, s75
v_lshrrev_b32 v8, 3, v2
v_add_u32 v9, s36, v8
v_mul_u32_u24 v10, 1152, v9
v_and_b32 v11, 7, v2
v_lshl_add_u32 v10, v11, 4, v10
s_mov_b32 s64, s10
s_and_b32 s65, s11, 0xffff
s_mov_b32 s66, 2359296
s_mov_b32 s67, 0x20000
s_mov_b32 s36, 9216
buffer_load_dwordx4 v[104:107], v10, s[64:67], 0 offen offset:0
buffer_load_dwordx4 v[108:111], v10, s[64:67], 0 offen offset:128
buffer_load_dwordx4 v[112:115], v10, s[64:67], 0 offen offset:256
buffer_load_dwordx4 v[116:119], v10, s[64:67], 0 offen offset:384
buffer_load_dwordx4 v[120:123], v10, s[64:67], 0 offen offset:512
buffer_load_dwordx4 v[124:127], v10, s[64:67], 0 offen offset:640
buffer_load_dwordx4 v[128:131], v10, s[64:67], 0 offen offset:768
buffer_load_dwordx4 v[132:135], v10, s[64:67], 0 offen offset:896
buffer_load_dwordx4 v[136:139], v10, s[64:67], 0 offen offset:1024
buffer_load_dwordx4 v[140:143], v10, s[64:67], s36 offen offset:0
buffer_load_dwordx4 v[144:147], v10, s[64:67], s36 offen offset:128
buffer_load_dwordx4 v[148:151], v10, s[64:67], s36 offen offset:256
buffer_load_dwordx4 v[152:155], v10, s[64:67], s36 offen offset:384
buffer_load_dwordx4 v[156:159], v10, s[64:67], s36 offen offset:512
buffer_load_dwordx4 v[160:163], v10, s[64:67], s36 offen offset:640
buffer_load_dwordx4 v[164:167], v10, s[64:67], s36 offen offset:768
buffer_load_dwordx4 v[168:171], v10, s[64:67], s36 offen offset:896
buffer_load_dwordx4 v[172:175], v10, s[64:67], s36 offen offset:1024
s_add_u32 s64, s16, 7143424
s_addc_u32 s65, s17, 0
s_and_b32 s65, s65, 0xffff
s_mov_b32 s66, 16384
s_mov_b32 s67, 0x20000
v_lshlrev_b32 v9, 2, v9
v_add_u32 v10, 8192, v9
v_cmp_eq_u32 s[68:69], 0, v11
s_waitcnt vmcnt(9)
v_dot2_f32_bf16 v88, v104, v15, 0
v_dot2_f32_bf16 v90, v104, v104, 0
v_dot2_f32_bf16 v89, v105, v15, 0
v_dot2_f32_bf16 v91, v105, v105, 0
v_dot2_f32_bf16 v88, v106, v15, v88
v_dot2_f32_bf16 v90, v106, v106, v90
v_dot2_f32_bf16 v89, v107, v15, v89
v_dot2_f32_bf16 v91, v107, v107, v91
v_dot2_f32_bf16 v88, v108, v15, v88
v_dot2_f32_bf16 v90, v108, v108, v90
v_dot2_f32_bf16 v89, v109, v15, v89
v_dot2_f32_bf16 v91, v109, v109, v91
v_dot2_f32_bf16 v88, v110, v15, v88
v_dot2_f32_bf16 v90, v110, v110, v90
v_dot2_f32_bf16 v89, v111, v15, v89
v_dot2_f32_bf16 v91, v111, v111, v91
v_dot2_f32_bf16 v88, v112, v15, v88
v_dot2_f32_bf16 v90, v112, v112, v90
v_dot2_f32_bf16 v89, v113, v15, v89
v_dot2_f32_bf16 v91, v113, v113, v91
v_dot2_f32_bf16 v88, v114, v15, v88
v_dot2_f32_bf16 v90, v114, v114, v90
v_dot2_f32_bf16 v89, v115, v15, v89
v_dot2_f32_bf16 v91, v115, v115, v91
v_dot2_f32_bf16 v88, v116, v15, v88
v_dot2_f32_bf16 v90, v116, v116, v90
v_dot2_f32_bf16 v89, v117, v15, v89
v_dot2_f32_bf16 v91, v117, v117, v91
v_dot2_f32_bf16 v88, v118, v15, v88
v_dot2_f32_bf16 v90, v118, v118, v90
v_dot2_f32_bf16 v89, v119, v15, v89
v_dot2_f32_bf16 v91, v119, v119, v91
v_dot2_f32_bf16 v88, v120, v15, v88
v_dot2_f32_bf16 v90, v120, v120, v90
v_dot2_f32_bf16 v89, v121, v15, v89
v_dot2_f32_bf16 v91, v121, v121, v91
v_dot2_f32_bf16 v88, v122, v15, v88
v_dot2_f32_bf16 v90, v122, v122, v90
v_dot2_f32_bf16 v89, v123, v15, v89
v_dot2_f32_bf16 v91, v123, v123, v91
v_dot2_f32_bf16 v88, v124, v15, v88
v_dot2_f32_bf16 v90, v124, v124, v90
v_dot2_f32_bf16 v89, v125, v15, v89
v_dot2_f32_bf16 v91, v125, v125, v91
v_dot2_f32_bf16 v88, v126, v15, v88
v_dot2_f32_bf16 v90, v126, v126, v90
v_dot2_f32_bf16 v89, v127, v15, v89
v_dot2_f32_bf16 v91, v127, v127, v91
v_dot2_f32_bf16 v88, v128, v15, v88
v_dot2_f32_bf16 v90, v128, v128, v90
v_dot2_f32_bf16 v89, v129, v15, v89
v_dot2_f32_bf16 v91, v129, v129, v91
v_dot2_f32_bf16 v88, v130, v15, v88
v_dot2_f32_bf16 v90, v130, v130, v90
v_dot2_f32_bf16 v89, v131, v15, v89
v_dot2_f32_bf16 v91, v131, v131, v91
v_dot2_f32_bf16 v88, v132, v15, v88
v_dot2_f32_bf16 v90, v132, v132, v90
v_dot2_f32_bf16 v89, v133, v15, v89
v_dot2_f32_bf16 v91, v133, v133, v91
v_dot2_f32_bf16 v88, v134, v15, v88
v_dot2_f32_bf16 v90, v134, v134, v90
v_dot2_f32_bf16 v89, v135, v15, v89
v_dot2_f32_bf16 v91, v135, v135, v91
v_dot2_f32_bf16 v88, v136, v15, v88
v_dot2_f32_bf16 v90, v136, v136, v90
v_dot2_f32_bf16 v89, v137, v15, v89
v_dot2_f32_bf16 v91, v137, v137, v91
v_dot2_f32_bf16 v88, v138, v15, v88
v_dot2_f32_bf16 v90, v138, v138, v90
v_dot2_f32_bf16 v89, v139, v15, v89
v_dot2_f32_bf16 v91, v139, v139, v91
s_nop 2
v_add_f32 v88, v88, v89
v_add_f32 v90, v90, v91
s_nop 1
v_add_f32_dpp v88, v88, v88 quad_perm:[1,0,3,2] row_mask:0xf bank_mask:0xf
v_add_f32_dpp v90, v90, v90 quad_perm:[1,0,3,2] row_mask:0xf bank_mask:0xf
s_nop 1
v_add_f32_dpp v88, v88, v88 quad_perm:[2,3,0,1] row_mask:0xf bank_mask:0xf
v_add_f32_dpp v90, v90, v90 quad_perm:[2,3,0,1] row_mask:0xf bank_mask:0xf
s_nop 1
v_add_f32_dpp v88, v88, v88 row_half_mirror row_mask:0xf bank_mask:0xf
v_add_f32_dpp v90, v90, v90 row_half_mirror row_mask:0xf bank_mask:0xf
v_mul_f32 v88, 0x3ae38e39, v88
v_mul_f32 v90, 0x3ae38e39, v90
v_fma_f32 v90, -v88, v88, v90
v_max_f32 v90, 0, v90
v_cvt_pk_bf16_f32 v88, v88, v88
v_and_b32 v88, 0xffff0000, v88
v_cvt_pk_bf16_f32 v90, v90, v90
v_and_b32 v90, 0xffff0000, v90
v_add_f32 v90, 0x3727c5ac, v90
v_cvt_pk_bf16_f32 v90, v90, v90
v_and_b32 v90, 0xffff0000, v90
v_sqrt_f32 v90, v90
s_nop 0
v_cvt_pk_bf16_f32 v90, v90, v90
v_and_b32 v90, 0xffff0000, v90
v_rcp_f32 v92, v90
s_nop 0
v_mul_f32 v90, v88, v92
v_sub_f32 v90, 0, v90
v_mov_b32 v88, v92
s_mov_b64 exec, s[68:69]
buffer_store_dword v88, v9, s[64:67], 0 offen offset:0 sc1
buffer_store_dword v90, v10, s[64:67], 0 offen offset:0 sc1
s_mov_b64 exec, -1
s_waitcnt vmcnt(2)
v_dot2_f32_bf16 v88, v140, v15, 0
v_dot2_f32_bf16 v90, v140, v140, 0
v_dot2_f32_bf16 v89, v141, v15, 0
v_dot2_f32_bf16 v91, v141, v141, 0
v_dot2_f32_bf16 v88, v142, v15, v88
v_dot2_f32_bf16 v90, v142, v142, v90
v_dot2_f32_bf16 v89, v143, v15, v89
v_dot2_f32_bf16 v91, v143, v143, v91
v_dot2_f32_bf16 v88, v144, v15, v88
v_dot2_f32_bf16 v90, v144, v144, v90
v_dot2_f32_bf16 v89, v145, v15, v89
v_dot2_f32_bf16 v91, v145, v145, v91
v_dot2_f32_bf16 v88, v146, v15, v88
v_dot2_f32_bf16 v90, v146, v146, v90
v_dot2_f32_bf16 v89, v147, v15, v89
v_dot2_f32_bf16 v91, v147, v147, v91
v_dot2_f32_bf16 v88, v148, v15, v88
v_dot2_f32_bf16 v90, v148, v148, v90
v_dot2_f32_bf16 v89, v149, v15, v89
v_dot2_f32_bf16 v91, v149, v149, v91
v_dot2_f32_bf16 v88, v150, v15, v88
v_dot2_f32_bf16 v90, v150, v150, v90
v_dot2_f32_bf16 v89, v151, v15, v89
v_dot2_f32_bf16 v91, v151, v151, v91
v_dot2_f32_bf16 v88, v152, v15, v88
v_dot2_f32_bf16 v90, v152, v152, v90
v_dot2_f32_bf16 v89, v153, v15, v89
v_dot2_f32_bf16 v91, v153, v153, v91
v_dot2_f32_bf16 v88, v154, v15, v88
v_dot2_f32_bf16 v90, v154, v154, v90
v_dot2_f32_bf16 v89, v155, v15, v89
v_dot2_f32_bf16 v91, v155, v155, v91
v_dot2_f32_bf16 v88, v156, v15, v88
v_dot2_f32_bf16 v90, v156, v156, v90
v_dot2_f32_bf16 v89, v157, v15, v89
v_dot2_f32_bf16 v91, v157, v157, v91
v_dot2_f32_bf16 v88, v158, v15, v88
v_dot2_f32_bf16 v90, v158, v158, v90
v_dot2_f32_bf16 v89, v159, v15, v89
v_dot2_f32_bf16 v91, v159, v159, v91
v_dot2_f32_bf16 v88, v160, v15, v88
v_dot2_f32_bf16 v90, v160, v160, v90
v_dot2_f32_bf16 v89, v161, v15, v89
v_dot2_f32_bf16 v91, v161, v161, v91
v_dot2_f32_bf16 v88, v162, v15, v88
v_dot2_f32_bf16 v90, v162, v162, v90
v_dot2_f32_bf16 v89, v163, v15, v89
v_dot2_f32_bf16 v91, v163, v163, v91
v_dot2_f32_bf16 v88, v164, v15, v88
v_dot2_f32_bf16 v90, v164, v164, v90
v_dot2_f32_bf16 v89, v165, v15, v89
v_dot2_f32_bf16 v91, v165, v165, v91
v_dot2_f32_bf16 v88, v166, v15, v88
v_dot2_f32_bf16 v90, v166, v166, v90
v_dot2_f32_bf16 v89, v167, v15, v89
v_dot2_f32_bf16 v91, v167, v167, v91
v_dot2_f32_bf16 v88, v168, v15, v88
v_dot2_f32_bf16 v90, v168, v168, v90
v_dot2_f32_bf16 v89, v169, v15, v89
v_dot2_f32_bf16 v91, v169, v169, v91
v_dot2_f32_bf16 v88, v170, v15, v88
v_dot2_f32_bf16 v90, v170, v170, v90
v_dot2_f32_bf16 v89, v171, v15, v89
v_dot2_f32_bf16 v91, v171, v171, v91
v_dot2_f32_bf16 v88, v172, v15, v88
v_dot2_f32_bf16 v90, v172, v172, v90
v_dot2_f32_bf16 v89, v173, v15, v89
v_dot2_f32_bf16 v91, v173, v173, v91
v_dot2_f32_bf16 v88, v174, v15, v88
v_dot2_f32_bf16 v90, v174, v174, v90
v_dot2_f32_bf16 v89, v175, v15, v89
v_dot2_f32_bf16 v91, v175, v175, v91
s_nop 2
v_add_f32 v88, v88, v89
v_add_f32 v90, v90, v91
s_nop 1
v_add_f32_dpp v88, v88, v88 quad_perm:[1,0,3,2] row_mask:0xf bank_mask:0xf
v_add_f32_dpp v90, v90, v90 quad_perm:[1,0,3,2] row_mask:0xf bank_mask:0xf
s_nop 1
v_add_f32_dpp v88, v88, v88 quad_perm:[2,3,0,1] row_mask:0xf bank_mask:0xf
v_add_f32_dpp v90, v90, v90 quad_perm:[2,3,0,1] row_mask:0xf bank_mask:0xf
s_nop 1
v_add_f32_dpp v88, v88, v88 row_half_mirror row_mask:0xf bank_mask:0xf
v_add_f32_dpp v90, v90, v90 row_half_mirror row_mask:0xf bank_mask:0xf
v_mul_f32 v88, 0x3ae38e39, v88
v_mul_f32 v90, 0x3ae38e39, v90
v_fma_f32 v90, -v88, v88, v90
v_max_f32 v90, 0, v90
v_cvt_pk_bf16_f32 v88, v88, v88
v_and_b32 v88, 0xffff0000, v88
v_cvt_pk_bf16_f32 v90, v90, v90
v_and_b32 v90, 0xffff0000, v90
v_add_f32 v90, 0x3727c5ac, v90
v_cvt_pk_bf16_f32 v90, v90, v90
v_and_b32 v90, 0xffff0000, v90
v_sqrt_f32 v90, v90
s_nop 0
v_cvt_pk_bf16_f32 v90, v90, v90
v_and_b32 v90, 0xffff0000, v90
v_rcp_f32 v92, v90
s_nop 0
v_mul_f32 v90, v88, v92
v_sub_f32 v90, 0, v90
v_mov_b32 v88, v92
s_mov_b64 exec, s[68:69]
buffer_store_dword v88, v9, s[64:67], 0 offen offset:32 sc1
buffer_store_dword v90, v10, s[64:67], 0 offen offset:32 sc1
s_mov_b64 exec, -1
s_waitcnt vmcnt(0)
s_barrier
s_cmp_lg_u32 s20, 0
s_cbranch_scc1 fused_kernel_psb
s_lshl_b32 s78, s74, 6
s_add_u32 s78, s78, 38928384
v_mov_b32 v8, s78
v_mov_b32 v9, s76
s_mov_b64 exec, 1
global_store_dword v8, v9, s[16:17] sc1
s_mov_b64 exec, -1
s_add_u32 s74, s74, 1
s_lshl_b32 s78, s74, 6
s_add_u32 s78, s78, 38928384
v_mov_b32 v8, s78
v_mov_b32 v9, s76
s_mov_b64 exec, 1
global_store_dword v8, v9, s[16:17] sc1
s_mov_b64 exec, -1
fused_kernel_psb:
s_add_u32 s52, s42, 0
s_lshr_b32 s36, s52, 1
s_and_b32 s37, s52, 1
s_mul_i32 s38, s37, 288
s_lshl_b32 s39, s20, 3
s_add_u32 s38, s38, s39
s_mul_i32 s38, s38, 9216
s_lshl_b32 s39, s36, 7
s_add_u32 s38, s38, s39
s_lshl_b32 s39, s20, 10
s_add_u32 s39, s39, 0
s_mov_b32 m0, s39
s_add_u32 s39, s39, 4096
buffer_load_dwordx4 v4, s[24:27], s38 offen lds
s_add_u32 s38, s38, 294912
s_mov_b32 m0, s39
s_add_u32 s39, s39, 4096
buffer_load_dwordx4 v4, s[24:27], s38 offen lds
s_add_u32 s38, s38, 294912
s_mov_b32 m0, s39
s_add_u32 s39, s39, 4096
buffer_load_dwordx4 v4, s[24:27], s38 offen lds
s_add_u32 s38, s38, 294912
s_mov_b32 m0, s39
s_add_u32 s39, s39, 4096
buffer_load_dwordx4 v4, s[24:27], s38 offen lds
s_add_u32 s38, s38, 294912
s_mov_b32 m0, s39
s_add_u32 s39, s39, 4096
buffer_load_dwordx4 v4, s[24:27], s38 offen lds
s_add_u32 s38, s38, 294912
s_mov_b32 m0, s39
s_add_u32 s39, s39, 4096
buffer_load_dwordx4 v4, s[24:27], s38 offen lds
s_add_u32 s38, s38, 294912
s_mov_b32 m0, s39
s_add_u32 s39, s39, 4096
buffer_load_dwordx4 v4, s[24:27], s38 offen lds
s_add_u32 s38, s38, 294912
s_mov_b32 m0, s39
s_add_u32 s39, s39, 4096
buffer_load_dwordx4 v4, s[24:27], s38 offen lds
s_add_u32 s38, s38, 294912
s_mov_b32 m0, s39
s_add_u32 s39, s39, 4096
buffer_load_dwordx4 v4, s[24:27], s38 offen lds
s_add_u32 s38, s38, 294912
s_lshl_b32 s36, s36, 2
s_add_u32 s36, s36, s20
v_and_b32 v8, 15, v2
s_lshl_b32 s38, s36, 4
v_add_u32 v36, s38, v8
v_lshlrev_b32 v8, 1, v36
buffer_load_ushort v40, v8, s[44:47], 0 offen
s_mul_hi_u32 s38, s36, 477218589
s_mul_i32 s40, s38, 9
s_sub_u32 s39, s36, s40
s_mul_hi_u32 s41, s39, 1431655766
s_mul_i32 s40, s41, 3
s_sub_u32 s43, s39, s40
s_mul_i32 s38, s38, 331776
s_mul_i32 s41, s41, 55296
s_add_u32 s38, s38, s41
s_lshl_b32 s43, s43, 10
s_add_u32 s38, s38, s43
s_mul_i32 s37, s37, 27648
s_add_u32 s55, s38, s37
s_add_u32 s53, s42, 112
s_cmp_ge_u32 s53, 144
s_cbranch_scc1 fused_kernel_iw2_1b
s_lshr_b32 s36, s53, 1
s_and_b32 s37, s53, 1
s_mul_i32 s38, s37, 288
s_lshl_b32 s39, s20, 3
s_add_u32 s38, s38, s39
s_mul_i32 s38, s38, 9216
s_lshl_b32 s39, s36, 7
s_add_u32 s38, s38, s39
s_lshl_b32 s39, s20, 10
s_add_u32 s39, s39, 36864
s_mov_b32 m0, s39
s_add_u32 s39, s39, 4096
buffer_load_dwordx4 v4, s[24:27], s38 offen lds
s_add_u32 s38, s38, 294912
s_mov_b32 m0, s39
s_add_u32 s39, s39, 4096
buffer_load_dwordx4 v4, s[24:27], s38 offen lds
s_add_u32 s38, s38, 294912
s_mov_b32 m0, s39
s_add_u32 s39, s39, 4096
buffer_load_dwordx4 v4, s[24:27], s38 offen lds
s_add_u32 s38, s38, 294912
s_mov_b32 m0, s39
s_add_u32 s39, s39, 4096
buffer_load_dwordx4 v4, s[24:27], s38 offen lds
s_add_u32 s38, s38, 294912
s_mov_b32 m0, s39
s_add_u32 s39, s39, 4096
buffer_load_dwordx4 v4, s[24:27], s38 offen lds
s_add_u32 s38, s38, 294912
s_mov_b32 m0, s39
s_add_u32 s39, s39, 4096
buffer_load_dwordx4 v4, s[24:27], s38 offen lds
s_add_u32 s38, s38, 294912
s_mov_b32 m0, s39
s_add_u32 s39, s39, 4096
buffer_load_dwordx4 v4, s[24:27], s38 offen lds
s_add_u32 s38, s38, 294912
s_mov_b32 m0, s39
s_add_u32 s39, s39, 4096
buffer_load_dwordx4 v4, s[24:27], s38 offen lds
s_add_u32 s38, s38, 294912
s_mov_b32 m0, s39
s_add_u32 s39, s39, 4096
buffer_load_dwordx4 v4, s[24:27], s38 offen lds
s_add_u32 s38, s38, 294912
s_lshl_b32 s36, s36, 2
s_add_u32 s36, s36, s20
v_and_b32 v8, 15, v2
s_lshl_b32 s38, s36, 4
v_add_u32 v37, s38, v8
v_lshlrev_b32 v8, 1, v37
buffer_load_ushort v41, v8, s[44:47], 0 offen
s_mul_hi_u32 s38, s36, 477218589
s_mul_i32 s40, s38, 9
s_sub_u32 s39, s36, s40
s_mul_hi_u32 s41, s39, 1431655766
s_mul_i32 s40, s41, 3
s_sub_u32 s43, s39, s40
s_mul_i32 s38, s38, 331776
s_mul_i32 s41, s41, 55296
s_add_u32 s38, s38, s41
s_lshl_b32 s43, s43, 10
s_add_u32 s38, s38, s43
s_mul_i32 s37, s37, 27648
s_add_u32 s56, s38, s37
s_branch fused_kernel_idone_1b
fused_kernel_iw2_1b:
s_sub_u32 s36, s53, 144
s_mul_hi_u32 s37, s36, 238609295
s_mul_i32 s40, s37, 18
s_sub_u32 s41, s36, s40
s_lshr_b32 s39, s41, 2
s_lshl_b32 s39, s39, 5
s_and_b32 s40, s41, 3
s_mul_i32 s40, s40, 144
s_add_u32 s39, s39, s40
s_sub_u32 s40, s41, 16
s_mul_i32 s40, s40, 288
s_add_u32 s40, s40, 128
s_cmp_ge_u32 s41, 16
s_cselect_b32 s39, s40, s39
s_cselect_b32 s38, 147456, 0
s_mul_i32 s40, s37, 576
s_add_u32 s39, s39, s40
s_mul_i32 s39, s39, 1152
s_mul_i32 s40, s20, 288
s_add_u32 s39, s39, s40
v_add_u32 v25, 0, v2
v_mul_u32_u24 v26, 3641, v25
v_lshrrev_b32 v26, 16, v26
v_mul_u32_u24 v27, 18, v26
v_sub_u32 v25, v25, v27
v_mul_u32_u24 v27, 1152, v26
v_lshl_add_u32 v25, v25, 4, v27
v_lshrrev_b32 v26, 4, v26
v_mad_u32_u24 v16, v26, s38, v25
v_add_u32 v25, 64, v2
v_mul_u32_u24 v26, 3641, v25
v_lshrrev_b32 v26, 16, v26
v_mul_u32_u24 v27, 18, v26
v_sub_u32 v25, v25, v27
v_mul_u32_u24 v27, 1152, v26
v_lshl_add_u32 v25, v25, 4, v27
v_lshrrev_b32 v26, 4, v26
v_mad_u32_u24 v17, v26, s38, v25
v_add_u32 v25, 128, v2
v_mul_u32_u24 v26, 3641, v25
v_lshrrev_b32 v26, 16, v26
v_mul_u32_u24 v27, 18, v26
v_sub_u32 v25, v25, v27
v_mul_u32_u24 v27, 1152, v26
v_lshl_add_u32 v25, v25, 4, v27
v_lshrrev_b32 v26, 4, v26
v_mad_u32_u24 v18, v26, s38, v25
v_add_u32 v25, 192, v2
v_mul_u32_u24 v26, 3641, v25
v_lshrrev_b32 v26, 16, v26
v_mul_u32_u24 v27, 18, v26
v_sub_u32 v25, v25, v27
v_mul_u32_u24 v27, 1152, v26
v_lshl_add_u32 v25, v25, 4, v27
v_lshrrev_b32 v26, 4, v26
v_mad_u32_u24 v19, v26, s38, v25
v_add_u32 v25, 256, v2
v_mul_u32_u24 v26, 3641, v25
v_lshrrev_b32 v26, 16, v26
v_mul_u32_u24 v27, 18, v26
v_sub_u32 v25, v25, v27
v_mul_u32_u24 v27, 1152, v26
v_lshl_add_u32 v25, v25, 4, v27
v_lshrrev_b32 v26, 4, v26
v_mad_u32_u24 v20, v26, s38, v25
v_add_u32 v25, 320, v2
v_mul_u32_u24 v26, 3641, v25
v_lshrrev_b32 v26, 16, v26
v_mul_u32_u24 v27, 18, v26
v_sub_u32 v25, v25, v27
v_mul_u32_u24 v27, 1152, v26
v_lshl_add_u32 v25, v25, 4, v27
v_lshrrev_b32 v26, 4, v26
v_mad_u32_u24 v21, v26, s38, v25
v_add_u32 v25, 384, v2
v_mul_u32_u24 v26, 3641, v25
v_lshrrev_b32 v26, 16, v26
v_mul_u32_u24 v27, 18, v26
v_sub_u32 v25, v25, v27
v_mul_u32_u24 v27, 1152, v26
v_lshl_add_u32 v25, v25, 4, v27
v_lshrrev_b32 v26, 4, v26
v_mad_u32_u24 v22, v26, s38, v25
v_add_u32 v25, 448, v2
v_mul_u32_u24 v26, 3641, v25
v_lshrrev_b32 v26, 16, v26
v_mul_u32_u24 v27, 18, v26
v_sub_u32 v25, v25, v27
v_mul_u32_u24 v27, 1152, v26
v_lshl_add_u32 v25, v25, 4, v27
v_lshrrev_b32 v26, 4, v26
v_mad_u32_u24 v23, v26, s38, v25
v_add_u32 v25, 512, v2
v_mul_u32_u24 v26, 3641, v25
v_lshrrev_b32 v26, 16, v26
v_mul_u32_u24 v27, 18, v26
v_sub_u32 v25, v25, v27
v_mul_u32_u24 v27, 1152, v26
v_lshl_add_u32 v25, v25, 4, v27
v_lshrrev_b32 v26, 4, v26
v_mad_u32_u24 v24, v26, s38, v25
s_lshl_b32 s40, s37, 2
s_add_u32 s40, s40, s20
s_mul_i32 s40, s40, 331776
s_mul_i32 s38, s41, 3072
s_add_u32 s40, s40, s38
s_add_u32 s56, s40, 165888
s_cmp_ge_u32 s41, 12
s_cselect_b32 s59, 18432, 0
s_mul_i32 s41, s20, 9216
s_add_u32 s41, s41, 36864
s_mov_b32 m0, s41
s_add_u32 s41, s41, 1024
buffer_load_dwordx4 v16, s[48:51], s39 offen lds
s_mov_b32 m0, s41
s_add_u32 s41, s41, 1024
buffer_load_dwordx4 v17, s[48:51], s39 offen lds
s_mov_b32 m0, s41
s_add_u32 s41, s41, 1024
buffer_load_dwordx4 v18, s[48:51], s39 offen lds
s_mov_b32 m0, s41
s_add_u32 s41, s41, 1024
buffer_load_dwordx4 v19, s[48:51], s39 offen lds
s_mov_b32 m0, s41
s_add_u32 s41, s41, 1024
buffer_load_dwordx4 v20, s[48:51], s39 offen lds
s_mov_b32 m0, s41
s_add_u32 s41, s41, 1024
buffer_load_dwordx4 v21, s[48:51], s39 offen lds
s_mov_b32 m0, s41
s_add_u32 s41, s41, 1024
buffer_load_dwordx4 v22, s[48:51], s39 offen lds
s_mov_b32 m0, s41
s_add_u32 s41, s41, 1024
buffer_load_dwordx4 v23, s[48:51], s39 offen lds
s_mov_b32 m0, s41
s_add_u32 s41, s41, 1024
buffer_load_dwordx4 v24, s[48:51], s39 offen lds
buffer_load_ushort v41, v14, s[44:47], 0 offen
fused_kernel_idone_1b:
s_waitcnt vmcnt(10)
s_barrier
v_add_u32 v8, 0, v3
ds_read_b64_tr_b16 v[48:49], v8 offset:0
ds_read_b64_tr_b16 v[50:51], v8 offset:512
ds_read_b64_tr_b16 v[52:53], v8 offset:4096
ds_read_b64_tr_b16 v[54:55], v8 offset:4608
ds_read_b64_tr_b16 v[56:57], v8 offset:8192
ds_read_b64_tr_b16 v[58:59], v8 offset:8704
ds_read_b64_tr_b16 v[60:61], v8 offset:12288
ds_read_b64_tr_b16 v[62:63], v8 offset:12800
ds_read_b64_tr_b16 v[64:65], v8 offset:16384
ds_read_b64_tr_b16 v[66:67], v8 offset:16896
ds_read_b64_tr_b16 v[68:69], v8 offset:20480
ds_read_b64_tr_b16 v[70:71], v8 offset:20992
ds_read_b64_tr_b16 v[72:73], v8 offset:24576
ds_read_b64_tr_b16 v[74:75], v8 offset:25088
ds_read_b64_tr_b16 v[76:77], v8 offset:28672
ds_read_b64_tr_b16 v[78:79], v8 offset:29184
ds_read_b64_tr_b16 v[80:81], v8 offset:32768
ds_read_b64_tr_b16 v[82:83], v8 offset:33280
s_waitcnt lgkmcnt(15)
buffer_store_dwordx4 v[48:51], v14, s[28:31], s55 offen sc1
s_add_u32 s55, s55, 3072
s_waitcnt lgkmcnt(14)
buffer_store_dwordx4 v[52:55], v14, s[28:31], s55 offen sc1
s_add_u32 s55, s55, 3072
s_waitcnt lgkmcnt(12)
buffer_store_dwordx4 v[56:59], v14, s[28:31], s55 offen sc1
s_add_u32 s55, s55, 3072
s_waitcnt lgkmcnt(10)
buffer_store_dwordx4 v[60:63], v14, s[28:31], s55 offen sc1
s_add_u32 s55, s55, 3072
s_waitcnt lgkmcnt(8)
buffer_store_dwordx4 v[64:67], v14, s[28:31], s55 offen sc1
s_add_u32 s55, s55, 3072
s_waitcnt lgkmcnt(6)
buffer_store_dwordx4 v[68:71], v14, s[28:31], s55 offen sc1
s_add_u32 s55, s55, 3072
s_waitcnt lgkmcnt(4)
buffer_store_dwordx4 v[72:75], v14, s[28:31], s55 offen sc1
s_add_u32 s55, s55, 3072
s_waitcnt lgkmcnt(2)
buffer_store_dwordx4 v[76:79], v14, s[28:31], s55 offen sc1
s_add_u32 s55, s55, 3072
s_waitcnt lgkmcnt(0)
buffer_store_dwordx4 v[80:83], v14, s[28:31], s55 offen sc1
s_add_u32 s55, s55, 3072
v_dot2_f32_bf16 v44, v48, v15, 0
v_dot2_f32_bf16 v45, v49, v15, 0
v_dot2_f32_bf16 v44, v50, v15, v44
v_dot2_f32_bf16 v45, v51, v15, v45
v_dot2_f32_bf16 v44, v52, v15, v44
v_dot2_f32_bf16 v45, v53, v15, v45
v_dot2_f32_bf16 v44, v54, v15, v44
v_dot2_f32_bf16 v45, v55, v15, v45
v_dot2_f32_bf16 v44, v56, v15, v44
v_dot2_f32_bf16 v45, v57, v15, v45
v_dot2_f32_bf16 v44, v58, v15, v44
v_dot2_f32_bf16 v45, v59, v15, v45
v_dot2_f32_bf16 v44, v60, v15, v44
v_dot2_f32_bf16 v45, v61, v15, v45
v_dot2_f32_bf16 v44, v62, v15, v44
v_dot2_f32_bf16 v45, v63, v15, v45
v_dot2_f32_bf16 v44, v64, v15, v44
v_dot2_f32_bf16 v45, v65, v15, v45
v_dot2_f32_bf16 v44, v66, v15, v44
v_dot2_f32_bf16 v45, v67, v15, v45
v_dot2_f32_bf16 v44, v68, v15, v44
v_dot2_f32_bf16 v45, v69, v15, v45
v_dot2_f32_bf16 v44, v70, v15, v44
v_dot2_f32_bf16 v45, v71, v15, v45
v_dot2_f32_bf16 v44, v72, v15, v44
v_dot2_f32_bf16 v45, v73, v15, v45
v_dot2_f32_bf16 v44, v74, v15, v44
v_dot2_f32_bf16 v45, v75, v15, v45
v_dot2_f32_bf16 v44, v76, v15, v44
v_dot2_f32_bf16 v45, v77, v15, v45
v_dot2_f32_bf16 v44, v78, v15, v44
v_dot2_f32_bf16 v45, v79, v15, v45
v_dot2_f32_bf16 v44, v80, v15, v44
v_dot2_f32_bf16 v45, v81, v15, v45
v_dot2_f32_bf16 v44, v82, v15, v44
v_dot2_f32_bf16 v45, v83, v15, v45
s_nop 2
v_add_f32 v44, v44, v45
s_nop 0
v_mov_b32 v45, v44
s_nop 1
v_permlane32_swap_b32 v44, v45
v_add_f32 v44, v44, v45
s_nop 0
v_mov_b32 v45, v44
s_nop 1
v_permlane16_swap_b32 v44, v45
v_add_f32 v44, v44, v45
v_lshlrev_b32 v45, 16, v40
v_mul_f32 v45, 0x3fb8aa3b, v45
v_lshlrev_b32 v8, 2, v36
s_and_b32 s36, s52, 1
s_mul_i32 s36, s36, 18432
s_mov_b32 s37, 36864
v_cmp_gt_u32 vcc, 16, v2
s_and_saveexec_b64 s[38:39], vcc
buffer_store_dword v44, v8, s[32:35], s36 offen sc1
buffer_store_dword v45, v8, s[32:35], s37 offen sc1
s_mov_b64 exec, s[38:39]
s_waitcnt vmcnt(9)
s_cmp_ge_u32 s53, 144
s_cbranch_scc1 fused_kernel_pw2_1b
s_barrier
v_add_u32 v8, 36864, v3
ds_read_b64_tr_b16 v[48:49], v8 offset:0
ds_read_b64_tr_b16 v[50:51], v8 offset:512
ds_read_b64_tr_b16 v[52:53], v8 offset:4096
ds_read_b64_tr_b16 v[54:55], v8 offset:4608
ds_read_b64_tr_b16 v[56:57], v8 offset:8192
ds_read_b64_tr_b16 v[58:59], v8 offset:8704
ds_read_b64_tr_b16 v[60:61], v8 offset:12288
ds_read_b64_tr_b16 v[62:63], v8 offset:12800
ds_read_b64_tr_b16 v[64:65], v8 offset:16384
ds_read_b64_tr_b16 v[66:67], v8 offset:16896
ds_read_b64_tr_b16 v[68:69], v8 offset:20480
ds_read_b64_tr_b16 v[70:71], v8 offset:20992
ds_read_b64_tr_b16 v[72:73], v8 offset:24576
ds_read_b64_tr_b16 v[74:75], v8 offset:25088
ds_read_b64_tr_b16 v[76:77], v8 offset:28672
ds_read_b64_tr_b16 v[78:79], v8 offset:29184
ds_read_b64_tr_b16 v[80:81], v8 offset:32768
ds_read_b64_tr_b16 v[82:83], v8 offset:33280
s_waitcnt lgkmcnt(15)
buffer_store_dwordx4 v[48:51], v14, s[28:31], s56 offen sc1
s_add_u32 s56, s56, 3072
s_waitcnt lgkmcnt(14)
buffer_store_dwordx4 v[52:55], v14, s[28:31], s56 offen sc1
s_add_u32 s56, s56, 3072
s_waitcnt lgkmcnt(12)
buffer_store_dwordx4 v[56:59], v14, s[28:31], s56 offen sc1
s_add_u32 s56, s56, 3072
s_waitcnt lgkmcnt(10)
buffer_store_dwordx4 v[60:63], v14, s[28:31], s56 offen sc1
s_add_u32 s56, s56, 3072
s_waitcnt lgkmcnt(8)
buffer_store_dwordx4 v[64:67], v14, s[28:31], s56 offen sc1
s_add_u32 s56, s56, 3072
s_waitcnt lgkmcnt(6)
buffer_store_dwordx4 v[68:71], v14, s[28:31], s56 offen sc1
s_add_u32 s56, s56, 3072
s_waitcnt lgkmcnt(4)
buffer_store_dwordx4 v[72:75], v14, s[28:31], s56 offen sc1
s_add_u32 s56, s56, 3072
s_waitcnt lgkmcnt(2)
buffer_store_dwordx4 v[76:79], v14, s[28:31], s56 offen sc1
s_add_u32 s56, s56, 3072
s_waitcnt lgkmcnt(0)
buffer_store_dwordx4 v[80:83], v14, s[28:31], s56 offen sc1
s_add_u32 s56, s56, 3072
v_dot2_f32_bf16 v44, v48, v15, 0
v_dot2_f32_bf16 v45, v49, v15, 0
v_dot2_f32_bf16 v44, v50, v15, v44
v_dot2_f32_bf16 v45, v51, v15, v45
v_dot2_f32_bf16 v44, v52, v15, v44
v_dot2_f32_bf16 v45, v53, v15, v45
v_dot2_f32_bf16 v44, v54, v15, v44
v_dot2_f32_bf16 v45, v55, v15, v45
v_dot2_f32_bf16 v44, v56, v15, v44
v_dot2_f32_bf16 v45, v57, v15, v45
v_dot2_f32_bf16 v44, v58, v15, v44
v_dot2_f32_bf16 v45, v59, v15, v45
v_dot2_f32_bf16 v44, v60, v15, v44
v_dot2_f32_bf16 v45, v61, v15, v45
v_dot2_f32_bf16 v44, v62, v15, v44
v_dot2_f32_bf16 v45, v63, v15, v45
v_dot2_f32_bf16 v44, v64, v15, v44
v_dot2_f32_bf16 v45, v65, v15, v45
v_dot2_f32_bf16 v44, v66, v15, v44
v_dot2_f32_bf16 v45, v67, v15, v45
v_dot2_f32_bf16 v44, v68, v15, v44
v_dot2_f32_bf16 v45, v69, v15, v45
v_dot2_f32_bf16 v44, v70, v15, v44
v_dot2_f32_bf16 v45, v71, v15, v45
v_dot2_f32_bf16 v44, v72, v15, v44
v_dot2_f32_bf16 v45, v73, v15, v45
v_dot2_f32_bf16 v44, v74, v15, v44
v_dot2_f32_bf16 v45, v75, v15, v45
v_dot2_f32_bf16 v44, v76, v15, v44
v_dot2_f32_bf16 v45, v77, v15, v45
v_dot2_f32_bf16 v44, v78, v15, v44
v_dot2_f32_bf16 v45, v79, v15, v45
v_dot2_f32_bf16 v44, v80, v15, v44
v_dot2_f32_bf16 v45, v81, v15, v45
v_dot2_f32_bf16 v44, v82, v15, v44
v_dot2_f32_bf16 v45, v83, v15, v45
s_nop 2
v_add_f32 v44, v44, v45
s_nop 0
v_mov_b32 v45, v44
s_nop 1
v_permlane32_swap_b32 v44, v45
v_add_f32 v44, v44, v45
s_nop 0
v_mov_b32 v45, v44
s_nop 1
v_permlane16_swap_b32 v44, v45
v_add_f32 v44, v44, v45
v_lshlrev_b32 v45, 16, v41
v_mul_f32 v45, 0x3fb8aa3b, v45
v_lshlrev_b32 v8, 2, v37
s_and_b32 s36, s53, 1
s_mul_i32 s36, s36, 18432
s_mov_b32 s37, 36864
v_cmp_gt_u32 vcc, 16, v2
s_and_saveexec_b64 s[38:39], vcc
buffer_store_dword v44, v8, s[32:35], s36 offen sc1
buffer_store_dword v45, v8, s[32:35], s37 offen sc1
s_mov_b64 exec, s[38:39]
s_branch fused_kernel_pdone_1b
fused_kernel_pw2_1b:
v_add_u32 v8, 36864, v12
v_add_u32 v9, 36864, v13
ds_read_b64_tr_b16 v[48:49], v8 offset:0
ds_read_b64_tr_b16 v[50:51], v8 offset:4608
ds_read_b64_tr_b16 v[52:53], v8 offset:8
ds_read_b64_tr_b16 v[54:55], v8 offset:4616
ds_read_b64_tr_b16 v[56:57], v8 offset:64
ds_read_b64_tr_b16 v[58:59], v8 offset:4672
ds_read_b64_tr_b16 v[60:61], v8 offset:72
ds_read_b64_tr_b16 v[62:63], v8 offset:4680
ds_read_b64_tr_b16 v[64:65], v8 offset:128
ds_read_b64_tr_b16 v[66:67], v8 offset:4736
ds_read_b64_tr_b16 v[68:69], v8 offset:136
ds_read_b64_tr_b16 v[70:71], v8 offset:4744
ds_read_b64_tr_b16 v[72:73], v8 offset:192
ds_read_b64_tr_b16 v[74:75], v8 offset:4800
ds_read_b64_tr_b16 v[76:77], v8 offset:200
ds_read_b64_tr_b16 v[78:79], v8 offset:4808
ds_read_b64_tr_b16 v[80:81], v9 offset:256
ds_read_b64_tr_b16 v[82:83], v9 offset:4864
s_waitcnt lgkmcnt(15)
s_mul_i32 s36, s59, 2
s_add_u32 s36, s36, s56
s_add_u32 s36, s36, 0
buffer_store_dwordx4 v[48:51], v14, s[28:31], s36 offen sc1
s_waitcnt lgkmcnt(14)
s_mul_i32 s36, s59, 2
s_add_u32 s36, s36, s56
s_add_u32 s36, s36, 1024
buffer_store_dwordx4 v[52:55], v14, s[28:31], s36 offen sc1
s_waitcnt lgkmcnt(12)
s_mul_i32 s36, s59, 2
s_add_u32 s36, s36, s56
s_add_u32 s36, s36, 2048
buffer_store_dwordx4 v[56:59], v14, s[28:31], s36 offen sc1
s_waitcnt lgkmcnt(10)
s_mul_i32 s36, s59, 1
s_add_u32 s36, s36, s56
s_add_u32 s36, s36, 36864
buffer_store_dwordx4 v[60:63], v14, s[28:31], s36 offen sc1
s_waitcnt lgkmcnt(8)
s_mul_i32 s36, s59, 1
s_add_u32 s36, s36, s56
s_add_u32 s36, s36, 37888
buffer_store_dwordx4 v[64:67], v14, s[28:31], s36 offen sc1
s_waitcnt lgkmcnt(6)
s_mul_i32 s36, s59, 1
s_add_u32 s36, s36, s56
s_add_u32 s36, s36, 38912
buffer_store_dwordx4 v[68:71], v14, s[28:31], s36 offen sc1
s_waitcnt lgkmcnt(4)
s_mul_i32 s36, s59, 0
s_add_u32 s36, s36, s56
s_add_u32 s36, s36, 110592
buffer_store_dwordx4 v[72:75], v14, s[28:31], s36 offen sc1
s_waitcnt lgkmcnt(2)
s_mul_i32 s36, s59, 0
s_add_u32 s36, s36, s56
s_add_u32 s36, s36, 111616
buffer_store_dwordx4 v[76:79], v14, s[28:31], s36 offen sc1
s_waitcnt lgkmcnt(0)
s_mul_i32 s36, s59, 0
s_add_u32 s36, s36, s56
s_add_u32 s36, s36, 112640
buffer_store_dwordx4 v[80:83], v14, s[28:31], s36 offen sc1
fused_kernel_pdone_1b:
s_waitcnt vmcnt(9)
s_barrier
s_cmp_lg_u32 s20, 0
s_cbranch_scc1 fused_kernel_pw1c
s_lshl_b32 s78, s42, 6
s_add_u32 s78, s78, 38797312
v_mov_b32 v8, s78
v_mov_b32 v9, s76
s_mov_b64 exec, 1
global_store_dword v8, v9, s[16:17] sc1
s_mov_b64 exec, -1
fused_kernel_pw1c:
fused_kernel_auxw:
s_waitcnt vmcnt(0) lgkmcnt(0)
s_barrier
s_cmp_lg_u32 s20, 0
s_cbranch_scc1 fused_kernel_auxp
s_sub_u32 s36, s42, 32
s_and_b32 s36, s36, 127
s_lshl_b32 s78, s36, 6
s_add_u32 s78, s78, 39190528
v_mov_b32 v8, s78
v_mov_b32 v9, s76
s_mov_b64 exec, 1
global_store_dword v8, v9, s[16:17] sc1
s_mov_b64 exec, -1
fused_kernel_auxp:
s_and_b32 s36, s2, 7
s_lshr_b32 s37, s2, 3
s_and_b32 s22, s36, 3
s_lshl_b32 s22, s22, 1
s_and_b32 s38, s37, 1
s_add_u32 s22, s22, s38
s_lshr_b32 s23, s36, 2
s_lshl_b32 s23, s23, 4
s_lshr_b32 s38, s37, 1
s_add_u32 s23, s23, s38
s_mul_i32 s36, s22, 18
v_min_u32 v24, 17, v2
v_add_u32 v24, s36, v24
v_subrev_u32 v25, 112, v24
v_min_u32 v24, v24, v25
v_lshlrev_b32 v24, 6, v24
v_add_u32 v24, 38797312, v24
s_cmp_lg_u32 s20, 0
s_cbranch_scc1 fused_kernel_naw
s_mov_b32 s77, 400000
fused_kernel_pm3:
global_load_dword v26, v24, s[16:17] sc1
s_waitcnt vmcnt(0)
v_cmp_ne_u32 vcc, s76, v26
s_sub_u32 s77, s77, 1
s_cselect_b64 vcc, 0, vcc
s_cmp_eq_u64 vcc, 0
s_cbranch_scc1 fused_kernel_pmd3
s_mov_b64 exec, vcc
s_branch fused_kernel_pm3
fused_kernel_pmd3:
s_mov_b64 exec, -1
fused_kernel_naw:
s_barrier
global_load_dword v254, v28, s[72:73]
global_load_dword v254, v29, s[72:73]
s_mov_b32 s75, 0
fused_kernel_p3:
s_and_b32 s36, s2, 7
s_lshr_b32 s37, s2, 3
s_and_b32 s22, s36, 3
s_lshl_b32 s22, s22, 1
s_and_b32 s38, s37, 1
s_add_u32 s22, s22, s38
s_lshr_b32 s23, s36, 2
s_lshl_b32 s23, s23, 4
s_lshr_b32 s38, s37, 1
s_add_u32 s23, s23, s38
v_lshlrev_b32 v3, 4, v2
s_lshl_b32 s36, s22, 2
s_add_u32 s36, s36, s20
s_mul_i32 s40, s36, 331776
s_add_u32 s36, s40, 7344128
s_add_u32 s80, s16, s36
s_addc_u32 s81, s17, 0
s_add_u32 s28, s16, 7340032
s_addc_u32 s29, s17, 0
s_and_b32 s29, s29, 0xffff
s_mov_b32 s30, 10616832
s_mov_b32 s31, 0x20000
s_add_u32 s32, s16, 7159808
s_addc_u32 s33, s17, 0
s_and_b32 s33, s33, 0xffff
s_mov_b32 s34, 55296
s_mov_b32 s35, 0x20000
s_add_u32 s24, s16, 4784128
s_addc_u32 s25, s17, 0
s_and_b32 s25, s25, 0xffff
s_mov_b32 s26, 2359296
s_mov_b32 s27, 0x20000
s_and_b32 s36, s23, 15
s_mul_i32 s36, s36, 3456
s_add_u32 s36, s36, 165888
s_add_u32 s72, s36, s40
v_lshrrev_b32 v24, 3, v2
v_bfe_u32 v25, v2, 4, 1
v_lshlrev_b32 v25, 1, v25
v_and_b32 v7, 7, v2
v_xor_b32 v7, v7, v25
v_lshlrev_b32 v7, 4, v7
v_xor_b32 v7, s21, v7
v_mul_u32_u24 v24, 4096, v24
v_add_u32 v7, v7, v24
s_xor_b32 s36, s20, 0
v_bfe_u32 v24, v2, 2, 2
v_lshrrev_b32 v25, 4, v2
v_lshl_add_u32 v8, v25, 3, v24
v_lshlrev_b32 v8, 7, v8
v_lshrrev_b32 v24, 1, v24
v_and_b32 v25, 1, v25
v_lshl_or_b32 v24, v25, 1, v24
v_xor_b32 v24, s36, v24
v_and_b32 v26, 3, v2
v_lshlrev_b32 v26, 3, v26
v_lshl_add_u32 v24, v24, 5, v26
v_add_u32 v8, v8, v24
v_add_u32 v12, 0x10000, v8
s_mul_i32 s37, s36, 18432
s_add_u32 s37, s37, 73728
v_add_u32 v16, s37, v3
s_lshl_b32 s38, s20, 10
v_add_u32 v20, s38, v16
s_xor_b32 s36, s20, 1
v_bfe_u32 v24, v2, 2, 2
v_lshrrev_b32 v25, 4, v2
v_lshl_add_u32 v9, v25, 3, v24
v_lshlrev_b32 v9, 7, v9
v_lshrrev_b32 v24, 1, v24
v_and_b32 v25, 1, v25
v_lshl_or_b32 v24, v25, 1, v24
v_xor_b32 v24, s36, v24
v_and_b32 v26, 3, v2
v_lshlrev_b32 v26, 3, v26
v_lshl_add_u32 v24, v24, 5, v26
v_add_u32 v9, v9, v24
v_add_u32 v13, 0x10000, v9
s_mul_i32 s37, s36, 18432
s_add_u32 s37, s37, 73728
v_add_u32 v17, s37, v3
s_lshl_b32 s38, s20, 10
v_add_u32 v21, s38, v17
s_xor_b32 s36, s20, 2
v_bfe_u32 v24, v2, 2, 2
v_lshrrev_b32 v25, 4, v2
v_lshl_add_u32 v10, v25, 3, v24
v_lshlrev_b32 v10, 7, v10
v_lshrrev_b32 v24, 1, v24
v_and_b32 v25, 1, v25
v_lshl_or_b32 v24, v25, 1, v24
v_xor_b32 v24, s36, v24
v_and_b32 v26, 3, v2
v_lshlrev_b32 v26, 3, v26
v_lshl_add_u32 v24, v24, 5, v26
v_add_u32 v10, v10, v24
v_add_u32 v14, 0x10000, v10
s_mul_i32 s37, s36, 18432
s_add_u32 s37, s37, 73728
v_add_u32 v18, s37, v3
s_lshl_b32 s38, s20, 10
v_add_u32 v22, s38, v18
s_xor_b32 s36, s20, 3
v_bfe_u32 v24, v2, 2, 2
v_lshrrev_b32 v25, 4, v2
v_lshl_add_u32 v11, v25, 3, v24
v_lshlrev_b32 v11, 7, v11
v_lshrrev_b32 v24, 1, v24
v_and_b32 v25, 1, v25
v_lshl_or_b32 v24, v25, 1, v24
v_xor_b32 v24, s36, v24
v_and_b32 v26, 3, v2
v_lshlrev_b32 v26, 3, v26
v_lshl_add_u32 v24, v24, 5, v26
v_add_u32 v11, v11, v24
v_add_u32 v15, 0x10000, v11
s_mul_i32 s37, s36, 18432
s_add_u32 s37, s37, 73728
v_add_u32 v19, s37, v3
s_lshl_b32 s38, s20, 10
v_add_u32 v23, s38, v19
v_lshrrev_b32 v24, 4, v2
s_mul_i32 s36, s20, 576
s_add_u32 s36, s36, 147456
v_lshl_add_u32 v4, v24, 4, s36
v_and_b32 v25, 15, v2
s_lshl_b32 s36, s20, 7
s_add_u32 s36, s36, 156672
v_lshl_add_u32 v6, v25, 3, s36
v_lshrrev_b32 v26, 2, v25
v_cmp_eq_u32 vcc, v26, v24
v_lshlrev_b32 v27, 3, v2
v_add_u32 v27, 157184, v27
v_cndmask_b32 v5, v27, v6, vcc
v_and_b32 v26, 3, v2
v_cmp_eq_u32 s[66:67], 1, v26
v_cmp_eq_u32 s[68:69], 2, v26
v_cmp_eq_u32 s[70:71], 3, v26
v_mov_b32 v212, 0x3f803f80
v_mov_b32 v213, 0x3f803f80
v_mov_b32 v214, 0x3f803f80
v_mov_b32 v215, 0x3f803f80
s_add_u32 s44, s16, 18874368
s_addc_u32 s45, s17, 0
s_and_b32 s45, s45, 0xffff
s_mov_b32 s46, 18874368
s_mov_b32 s47, 0x20000
s_mul_i32 s36, s22, 2359296
s_mul_i32 s37, s23, 73728
s_add_u32 s36, s36, s37
s_mul_i32 s37, s20, 18432
s_add_u32 s36, s36, s37
s_xor_b32 s37, s20, 0
s_lshl_b32 s37, s37, 10
s_add_u32 s37, s37, s36
s_add_u32 s48, s37, 0
s_xor_b32 s38, s20, 0
s_add_u32 s38, s38, 0
s_cmp_eq_u32 s38, s22
s_cselect_b32 s48, 0x40000000, s48
s_add_u32 s52, s37, 4096
s_xor_b32 s38, s20, 0
s_add_u32 s38, s38, 4
s_cmp_eq_u32 s38, s22
s_cselect_b32 s52, 0x40000000, s52
s_add_u32 s56, s37, 8192
s_xor_b32 s38, s20, 0
s_add_u32 s38, s38, 0
s_cmp_eq_u32 s38, s22
s_cselect_b32 s56, 0x40000000, s56
s_add_u32 s60, s37, 12288
s_xor_b32 s38, s20, 0
s_add_u32 s38, s38, 4
s_cmp_eq_u32 s38, s22
s_cselect_b32 s60, 0x40000000, s60
s_xor_b32 s37, s20, 1
s_lshl_b32 s37, s37, 10
s_add_u32 s37, s37, s36
s_add_u32 s49, s37, 0
s_xor_b32 s38, s20, 1
s_add_u32 s38, s38, 0
s_cmp_eq_u32 s38, s22
s_cselect_b32 s49, 0x40000000, s49
s_add_u32 s53, s37, 4096
s_xor_b32 s38, s20, 1
s_add_u32 s38, s38, 4
s_cmp_eq_u32 s38, s22
s_cselect_b32 s53, 0x40000000, s53
s_add_u32 s57, s37, 8192
s_xor_b32 s38, s20, 1
s_add_u32 s38, s38, 0
s_cmp_eq_u32 s38, s22
s_cselect_b32 s57, 0x40000000, s57
s_add_u32 s61, s37, 12288
s_xor_b32 s38, s20, 1
s_add_u32 s38, s38, 4
s_cmp_eq_u32 s38, s22
s_cselect_b32 s61, 0x40000000, s61
s_xor_b32 s37, s20, 2
s_lshl_b32 s37, s37, 10
s_add_u32 s37, s37, s36
s_add_u32 s50, s37, 0
s_xor_b32 s38, s20, 2
s_add_u32 s38, s38, 0
s_cmp_eq_u32 s38, s22
s_cselect_b32 s50, 0x40000000, s50
s_add_u32 s54, s37, 4096
s_xor_b32 s38, s20, 2
s_add_u32 s38, s38, 4
s_cmp_eq_u32 s38, s22
s_cselect_b32 s54, 0x40000000, s54
s_add_u32 s58, s37, 8192
s_xor_b32 s38, s20, 2
s_add_u32 s38, s38, 0
s_cmp_eq_u32 s38, s22
s_cselect_b32 s58, 0x40000000, s58
s_add_u32 s62, s37, 12288
s_xor_b32 s38, s20, 2
s_add_u32 s38, s38, 4
s_cmp_eq_u32 s38, s22
s_cselect_b32 s62, 0x40000000, s62
s_xor_b32 s37, s20, 3
s_lshl_b32 s37, s37, 10
s_add_u32 s37, s37, s36
s_add_u32 s51, s37, 0
s_xor_b32 s38, s20, 3
s_add_u32 s38, s38, 0
s_cmp_eq_u32 s38, s22
s_cselect_b32 s51, 0x40000000, s51
s_add_u32 s55, s37, 4096
s_xor_b32 s38, s20, 3
s_add_u32 s38, s38, 4
s_cmp_eq_u32 s38, s22
s_cselect_b32 s55, 0x40000000, s55
s_add_u32 s59, s37, 8192
s_xor_b32 s38, s20, 3
s_add_u32 s38, s38, 0
s_cmp_eq_u32 s38, s22
s_cselect_b32 s59, 0x40000000, s59
s_add_u32 s63, s37, 12288
s_xor_b32 s38, s20, 3
s_add_u32 s38, s38, 4
s_cmp_eq_u32 s38, s22
s_cselect_b32 s63, 0x40000000, s63
s_lshr_b32 s37, s20, 1
s_xor_b32 s37, s37, 0
s_lshl_b32 s37, s37, 10
s_add_u32 s37, s37, s36
s_add_u32 s64, s37, 16384
s_lshr_b32 s37, s20, 1
s_xor_b32 s37, s37, 0
s_lshl_b32 s38, s20, 1
s_add_u32 s37, s37, s38
s_cmp_eq_u32 s37, s22
s_cselect_b32 s64, 0x40000000, s64
s_lshr_b32 s37, s20, 1
s_xor_b32 s37, s37, 1
s_lshl_b32 s37, s37, 10
s_add_u32 s37, s37, s36
s_add_u32 s65, s37, 16384
s_lshr_b32 s37, s20, 1
s_xor_b32 s37, s37, 1
s_lshl_b32 s38, s20, 1
s_add_u32 s37, s37, s38
s_cmp_eq_u32 s37, s22
s_cselect_b32 s65, 0x40000000, s65
s_lshr_b32 s36, s20, 1
s_add_u32 s36, s36, 16
s_sub_u32 s36, s36, s20
s_lshl_b32 s36, s36, 10
s_and_b32 s37, s20, 1
s_lshl_b32 s37, s37, 3
s_add_u32 s41, s36, s37
s_mul_i32 s37, s20, 32768
s_lshl_b32 s38, s23, 7
s_add_u32 s37, s37, s38
s_lshl_b32 s39, s20, 10
s_mul_i32 s36, s20, 36
v_min_u32 v28, 35, v2
v_add_u32 v28, s36, v28
v_lshlrev_b32 v28, 6, v28
v_add_u32 v28, 38993920, v28
v_min_u32 v27, 26, v2
v_lshlrev_b32 v27, 7, v27
s_cmp_eq_u32 s75, 0
s_cbranch_scc1 fused_kernel_p3b
s_mul_i32 s36, s22, 18
v_min_u32 v24, 17, v2
v_add_u32 v24, s36, v24
v_subrev_u32 v25, 112, v24
v_min_u32 v24, v24, v25
v_lshlrev_b32 v24, 6, v24
v_add_u32 v24, 38797312, v24
global_load_dword v25, v24, s[16:17] sc1
s_waitcnt vmcnt(0)
s_barrier
s_cmp_lg_u32 s20, 0
s_cbranch_scc1 fused_kernel_p3b
s_lshl_b32 s78, s2, 6
s_add_u32 s78, s78, 38993920
v_mov_b32 v30, s78
v_mov_b32 v31, s76
s_mov_b64 exec, 1
global_store_dword v30, v31, s[16:17] sc1
s_mov_b64 exec, -1
fused_kernel_p3b:
s_cmp_eq_u32 s75, 0
s_cbranch_scc1 fused_kernel_ringnow
s_mov_b32 s77, 400000
s_branch fused_kernel_pollc4
fused_kernel_poll4:
global_load_dword v25, v24, s[16:17] sc1
s_waitcnt vmcnt(0)
fused_kernel_pollc4:
v_xor_b32 v25, s76, v25
v_cmp_ne_u32 vcc, 0, v25
s_sub_u32 s77, s77, 1
s_cselect_b64 vcc, 0, vcc
s_cmp_lg_u64 vcc, 0
s_cbranch_scc1 fused_kernel_poll4
fused_kernel_ringnow:
global_load_dwordx4 v[80:83], v3, s[80:81] offset:-4096 sc1
global_load_dwordx4 v[84:87], v3, s[80:81] offset:-3072 sc1
global_load_dwordx4 v[88:91], v3, s[80:81] offset:-2048 sc1
global_load_dwordx4 v[92:95], v3, s[80:81] offset:-1024 sc1
global_load_dwordx4 v[96:99], v3, s[80:81] offset:0 sc1
global_load_dwordx4 v[100:103], v3, s[80:81] offset:1024 sc1
global_load_dwordx4 v[104:107], v3, s[80:81] offset:2048 sc1
global_load_dwordx4 v[108:111], v3, s[80:81] offset:3072 sc1
s_add_u32 s80, s80, 8192
s_addc_u32 s81, s81, 0
global_load_dwordx4 v[112:115], v3, s[80:81] offset:-4096 sc1
global_load_dwordx4 v[116:119], v3, s[80:81] offset:-3072 sc1
global_load_dwordx4 v[120:123], v3, s[80:81] offset:-2048 sc1
global_load_dwordx4 v[124:127], v3, s[80:81] offset:-1024 sc1
global_load_dwordx4 a[216:219], v3, s[80:81] offset:0 sc1
global_load_dwordx4 a[220:223], v3, s[80:81] offset:1024 sc1
global_load_dwordx4 a[224:227], v3, s[80:81] offset:2048 sc1
global_load_dwordx4 a[228:231], v3, s[80:81] offset:3072 sc1
s_add_u32 s80, s80, 8192
s_addc_u32 s81, s81, 0
global_load_dwordx4 a[232:235], v3, s[80:81] offset:-4096 sc1
global_load_dwordx4 a[236:239], v3, s[80:81] offset:-3072 sc1
global_load_dwordx4 a[240:243], v3, s[80:81] offset:-2048 sc1
global_load_dwordx4 a[244:247], v3, s[80:81] offset:-1024 sc1
global_load_dwordx4 a[248:251], v3, s[80:81] offset:0 sc1
global_load_dwordx4 a[252:255], v3, s[80:81] offset:1024 sc1
global_load_dwordx4 v[128:131], v3, s[80:81] offset:2048 sc1
global_load_dwordx4 v[132:135], v3, s[80:81] offset:3072 sc1
s_add_u32 s80, s80, 8192
s_addc_u32 s81, s81, 0
global_load_dwordx4 v[136:139], v3, s[80:81] offset:-4096 sc1
global_load_dwordx4 v[140:143], v3, s[80:81] offset:-3072 sc1
global_load_dwordx4 v[144:147], v3, s[80:81] offset:-2048 sc1
global_load_dwordx4 v[148:151], v3, s[80:81] offset:-1024 sc1
global_load_dwordx4 v[152:155], v3, s[80:81] offset:0 sc1
global_load_dwordx4 v[156:159], v3, s[80:81] offset:1024 sc1
s_cmp_lg_u32 s20, 0
s_cbranch_scc1 fused_kernel_nopoll
v_min_u32 v28, 47, v2
v_lshlrev_b32 v28, 6, v28
v_add_u32 v28, 38993920, v28
v_add_u32 v29, 3072, v28
v_add_u32 v30, 6144, v28
global_load_dword v160, v28, s[16:17] sc1
global_load_dword v161, v29, s[16:17] sc1
global_load_dword v162, v30, s[16:17] sc1
s_waitcnt vmcnt(0)
s_mov_b32 s77, 400000
s_branch fused_kernel_pollc5
fused_kernel_poll5:
global_load_dword v160, v28, s[16:17] sc1
global_load_dword v161, v29, s[16:17] sc1
global_load_dword v162, v30, s[16:17] sc1
s_waitcnt vmcnt(0)
fused_kernel_pollc5:
v_xor_b32 v160, s76, v160
v_xor_b32 v161, s76, v161
v_xor_b32 v162, s76, v162
v_or_b32 v160, v160, v161
v_or_b32 v160, v160, v162
v_cmp_ne_u32 vcc, 0, v160
s_sub_u32 s77, s77, 1
s_cselect_b64 vcc, 0, vcc
s_cmp_lg_u64 vcc, 0
s_cbranch_scc1 fused_kernel_poll5
fused_kernel_nopoll:
s_barrier
s_mov_b32 m0, s39
s_add_u32 s39, s39, 4096
buffer_load_dwordx4 v7, s[24:27], s37 offen sc1 lds
s_add_u32 s37, s37, 131072
s_mov_b32 m0, s39
s_add_u32 s39, s39, 4096
buffer_load_dwordx4 v7, s[24:27], s37 offen sc1 lds
s_add_u32 s37, s37, 131072
s_mov_b32 m0, s39
s_add_u32 s39, s39, 4096
buffer_load_dwordx4 v7, s[24:27], s37 offen sc1 lds
s_add_u32 s37, s37, 131072
s_mov_b32 m0, s39
s_add_u32 s39, s39, 4096
buffer_load_dwordx4 v7, s[24:27], s37 offen sc1 lds
s_add_u32 s37, s37, 131072
s_mov_b32 m0, s39
s_add_u32 s39, s39, 4096
buffer_load_dwordx4 v7, s[24:27], s37 offen sc1 lds
s_add_u32 s37, s37, 131072
s_mov_b32 m0, s39
s_add_u32 s39, s39, 4096
buffer_load_dwordx4 v7, s[24:27], s37 offen sc1 lds
s_add_u32 s37, s37, 131072
s_mul_i32 s36, s22, 18
v_min_u32 v28, 17, v2
v_add_u32 v28, s36, v28
v_subrev_u32 v29, 80, v28
v_min_u32 v28, v28, v29
v_lshlrev_b32 v28, 6, v28
v_add_u32 v28, 39190528, v28
s_waitcnt vmcnt(4)
s_barrier
ds_read_b64_tr_b16 a[0:1], v8 offset:0
ds_read_b64_tr_b16 a[2:3], v8 offset:512
ds_read_b64_tr_b16 a[4:5], v9 offset:0
ds_read_b64_tr_b16 a[6:7], v9 offset:512
ds_read_b64_tr_b16 a[8:9], v10 offset:0
ds_read_b64_tr_b16 a[10:11], v10 offset:512
ds_read_b64_tr_b16 v[160:161], v11 offset:0
ds_read_b64_tr_b16 v[162:163], v11 offset:512
s_waitcnt lgkmcnt(0)
v_mfma_f32_16x16x32_bf16 v[32:35], v[80:83], a[0:3], 0
ds_read_b64_tr_b16 v[164:165], v11 offset:4096
ds_read_b64_tr_b16 v[166:167], v11 offset:4608
v_mfma_f32_16x16x32_bf16 v[36:39], v[80:83], a[4:7], 0
ds_read_b64_tr_b16 a[12:13], v8 offset:4096
ds_read_b64_tr_b16 a[14:15], v8 offset:4608
v_mfma_f32_16x16x32_bf16 v[40:43], v[80:83], a[8:11], 0
ds_read_b64_tr_b16 a[16:17], v9 offset:4096
ds_read_b64_tr_b16 a[18:19], v9 offset:4608
v_mfma_f32_16x16x32_bf16 v[44:47], v[80:83], v[160:163], 0
ds_read_b64_tr_b16 a[20:21], v10 offset:4096
ds_read_b64_tr_b16 a[22:23], v10 offset:4608
v_mfma_f32_16x16x32_bf16 v[204:207], v[212:215], a[0:3], 0
s_mov_b32 m0, s39
s_add_u32 s39, s39, 4096
buffer_load_dwordx4 v7, s[24:27], s37 offen sc1 lds
v_mfma_f32_16x16x32_bf16 v[208:211], a[0:3], a[0:3], 0
v_mfma_f32_16x16x32_bf16 v[48:51], v[84:87], a[0:3], 0
v_mfma_f32_16x16x32_bf16 v[52:55], v[84:87], a[4:7], 0
s_add_u32 s37, s37, 131072
s_mov_b32 m0, s39
s_add_u32 s39, s39, 4096
buffer_load_dwordx4 v7, s[24:27], s37 offen sc1 lds
v_mfma_f32_16x16x32_bf16 v[56:59], v[84:87], a[8:11], 0
v_mfma_f32_16x16x32_bf16 v[60:63], v[84:87], v[160:163], 0
v_mfma_f32_16x16x32_bf16 v[64:67], v[88:91], a[0:3], 0
v_mfma_f32_16x16x32_bf16 v[68:71], v[88:91], a[4:7], 0
s_add_u32 s37, s37, 131072
s_mov_b32 m0, s39
s_add_u32 s39, s39, 4096
buffer_load_dwordx4 v7, s[24:27], s37 offen sc1 lds
v_mfma_f32_16x16x32_bf16 v[72:75], v[88:91], a[8:11], 0
s_waitcnt vmcnt(33) lgkmcnt(0)
v_mfma_f32_16x16x32_bf16 v[76:79], v[88:91], v[160:163], 0
v_mfma_f32_16x16x32_bf16 v[32:35], v[92:95], a[12:15], v[32:35]
s_waitcnt vmcnt(3)
s_barrier
s_add_u32 s37, s37, 131072
s_mov_b32 m0, s39
s_add_u32 s39, s39, 4096
buffer_load_dwordx4 v7, s[24:27], s37 offen sc1 lds
v_mfma_f32_16x16x32_bf16 v[36:39], v[92:95], a[16:19], v[36:39]
ds_read_b64_tr_b16 v[160:161], v11 offset:8192
ds_read_b64_tr_b16 v[162:163], v11 offset:8704
v_mfma_f32_16x16x32_bf16 v[40:43], v[92:95], a[20:23], v[40:43]
ds_read_b64_tr_b16 a[24:25], v8 offset:8192
ds_read_b64_tr_b16 a[26:27], v8 offset:8704
v_mfma_f32_16x16x32_bf16 v[44:47], v[92:95], v[164:167], v[44:47]
ds_read_b64_tr_b16 a[28:29], v9 offset:8192
ds_read_b64_tr_b16 a[30:31], v9 offset:8704
v_mfma_f32_16x16x32_bf16 v[204:207], v[212:215], a[12:15], v[204:207]
ds_read_b64_tr_b16 a[32:33], v10 offset:8192
ds_read_b64_tr_b16 a[34:35], v10 offset:8704
v_mfma_f32_16x16x32_bf16 v[208:211], a[12:15], a[12:15], v[208:211]
v_mfma_f32_16x16x32_bf16 v[48:51], v[96:99], a[12:15], v[48:51]
v_mfma_f32_16x16x32_bf16 v[52:55], v[96:99], a[16:19], v[52:55]
s_add_u32 s37, s37, 131072
s_mov_b32 m0, s39
s_add_u32 s39, s39, 4096
buffer_load_dwordx4 v7, s[24:27], s37 offen sc1 lds
v_mfma_f32_16x16x32_bf16 v[56:59], v[96:99], a[20:23], v[56:59]
v_mfma_f32_16x16x32_bf16 v[60:63], v[96:99], v[164:167], v[60:63]
v_mfma_f32_16x16x32_bf16 v[64:67], v[100:103], a[12:15], v[64:67]
v_mfma_f32_16x16x32_bf16 v[68:71], v[100:103], a[16:19], v[68:71]
s_add_u32 s37, s37, 131072
s_mov_b32 m0, s39
s_add_u32 s39, s39, 4096
buffer_load_dwordx4 v7, s[24:27], s37 offen sc1 lds
v_mfma_f32_16x16x32_bf16 v[72:75], v[100:103], a[20:23], v[72:75]
s_waitcnt vmcnt(33) lgkmcnt(0)
v_mfma_f32_16x16x32_bf16 v[76:79], v[100:103], v[164:167], v[76:79]
v_mfma_f32_16x16x32_bf16 v[32:35], v[104:107], a[24:27], v[32:35]
ds_read_b64_tr_b16 v[164:165], v11 offset:12288
ds_read_b64_tr_b16 v[166:167], v11 offset:12800
v_mfma_f32_16x16x32_bf16 v[36:39], v[104:107], a[28:31], v[36:39]
ds_read_b64_tr_b16 a[36:37], v8 offset:12288
ds_read_b64_tr_b16 a[38:39], v8 offset:12800
v_mfma_f32_16x16x32_bf16 v[40:43], v[104:107], a[32:35], v[40:43]
ds_read_b64_tr_b16 a[40:41], v9 offset:12288
ds_read_b64_tr_b16 a[42:43], v9 offset:12800
v_mfma_f32_16x16x32_bf16 v[44:47], v[104:107], v[160:163], v[44:47]
ds_read_b64_tr_b16 a[44:45], v10 offset:12288
ds_read_b64_tr_b16 a[46:47], v10 offset:12800
v_mfma_f32_16x16x32_bf16 v[204:207], v[212:215], a[24:27], v[204:207]
s_add_u32 s37, s37, 131072
s_mov_b32 m0, s39
s_add_u32 s39, s39, 4096
buffer_load_dwordx4 v7, s[24:27], s37 offen sc1 lds
v_mfma_f32_16x16x32_bf16 v[208:211], a[24:27], a[24:27], v[208:211]
v_mfma_f32_16x16x32_bf16 v[48:51], v[108:111], a[24:27], v[48:51]
v_mfma_f32_16x16x32_bf16 v[52:55], v[108:111], a[28:31], v[52:55]
s_add_u32 s37, s37, 131072
s_mov_b32 m0, s39
s_add_u32 s39, s39, 4096
buffer_load_dwordx4 v7, s[24:27], s37 offen sc1 lds
v_mfma_f32_16x16x32_bf16 v[56:59], v[108:111], a[32:35], v[56:59]
v_mfma_f32_16x16x32_bf16 v[60:63], v[108:111], v[160:163], v[60:63]
v_mfma_f32_16x16x32_bf16 v[64:67], v[112:115], a[24:27], v[64:67]
v_mfma_f32_16x16x32_bf16 v[68:71], v[112:115], a[28:31], v[68:71]
s_add_u32 s37, s37, 131072
s_mov_b32 m0, s39
s_add_u32 s39, s39, 4096
buffer_load_dwordx4 v7, s[24:27], s37 offen sc1 lds
v_mfma_f32_16x16x32_bf16 v[72:75], v[112:115], a[32:35], v[72:75]
s_waitcnt vmcnt(33) lgkmcnt(0)
v_mfma_f32_16x16x32_bf16 v[76:79], v[112:115], v[160:163], v[76:79]
v_mfma_f32_16x16x32_bf16 v[32:35], v[116:119], a[36:39], v[32:35]
ds_read_b64_tr_b16 v[160:161], v11 offset:16384
ds_read_b64_tr_b16 v[162:163], v11 offset:16896
v_mfma_f32_16x16x32_bf16 v[36:39], v[116:119], a[40:43], v[36:39]
ds_read_b64_tr_b16 a[48:49], v8 offset:16384
ds_read_b64_tr_b16 a[50:51], v8 offset:16896
v_mfma_f32_16x16x32_bf16 v[40:43], v[116:119], a[44:47], v[40:43]
ds_read_b64_tr_b16 a[52:53], v9 offset:16384
ds_read_b64_tr_b16 a[54:55], v9 offset:16896
v_mfma_f32_16x16x32_bf16 v[44:47], v[116:119], v[164:167], v[44:47]
ds_read_b64_tr_b16 a[56:57], v10 offset:16384
ds_read_b64_tr_b16 a[58:59], v10 offset:16896
v_mfma_f32_16x16x32_bf16 v[204:207], v[212:215], a[36:39], v[204:207]
s_add_u32 s37, s37, 131072
s_mov_b32 m0, s39
s_add_u32 s39, s39, 4096
buffer_load_dwordx4 v7, s[24:27], s37 offen sc1 lds
v_mfma_f32_16x16x32_bf16 v[208:211], a[36:39], a[36:39], v[208:211]
v_mfma_f32_16x16x32_bf16 v[48:51], v[120:123], a[36:39], v[48:51]
v_mfma_f32_16x16x32_bf16 v[52:55], v[120:123], a[40:43], v[52:55]
s_add_u32 s37, s37, 131072
s_mov_b32 m0, s39
s_add_u32 s39, s39, 4096
buffer_load_dwordx4 v7, s[24:27], s37 offen sc1 lds
v_mfma_f32_16x16x32_bf16 v[56:59], v[120:123], a[44:47], v[56:59]
v_mfma_f32_16x16x32_bf16 v[60:63], v[120:123], v[164:167], v[60:63]
v_mfma_f32_16x16x32_bf16 v[64:67], v[124:127], a[36:39], v[64:67]
v_mfma_f32_16x16x32_bf16 v[68:71], v[124:127], a[40:43], v[68:71]
s_add_u32 s37, s37, 131072
s_mov_b32 m0, s39
s_add_u32 s39, s39, 4096
buffer_load_dwordx4 v7, s[24:27], s37 offen sc1 lds
v_mfma_f32_16x16x32_bf16 v[72:75], v[124:127], a[44:47], v[72:75]
s_waitcnt vmcnt(33) lgkmcnt(0)
v_mfma_f32_16x16x32_bf16 v[76:79], v[124:127], v[164:167], v[76:79]
s_add_u32 s37, s37, 131072
s_cmp_eq_u32 s20, 3
s_cselect_b32 s36, 0, s20
s_mul_i32 s37, s36, 18432
s_mul_i32 s38, s22, 2304
s_add_u32 s37, s37, s38
s_mul_i32 s38, s36, 3072
s_add_u32 s38, s38, 147456
s_mov_b32 m0, s38
s_nop 0
buffer_load_dwordx4 v3, s[32:35], s37 offen offset:0 sc1 lds
v_mfma_f32_16x16x32_bf16 v[32:35], a[216:219], a[48:51], v[32:35]
ds_read_b64_tr_b16 v[164:165], v11 offset:20480
ds_read_b64_tr_b16 v[166:167], v11 offset:20992
v_mfma_f32_16x16x32_bf16 v[36:39], a[216:219], a[52:55], v[36:39]
ds_read_b64_tr_b16 a[60:61], v8 offset:20480
ds_read_b64_tr_b16 a[62:63], v8 offset:20992
v_mfma_f32_16x16x32_bf16 v[40:43], a[216:219], a[56:59], v[40:43]
ds_read_b64_tr_b16 a[64:65], v9 offset:20480
ds_read_b64_tr_b16 a[66:67], v9 offset:20992
v_mfma_f32_16x16x32_bf16 v[44:47], a[216:219], v[160:163], v[44:47]
global_load_dwordx4 a[216:219], v3, s[80:81] offset:2048 sc1
v_mfma_f32_16x16x32_bf16 v[204:207], v[212:215], a[48:51], v[204:207]
ds_read_b64_tr_b16 a[68:69], v10 offset:20480
ds_read_b64_tr_b16 a[70:71], v10 offset:20992
v_mfma_f32_16x16x32_bf16 v[208:211], a[48:51], a[48:51], v[208:211]
v_mfma_f32_16x16x32_bf16 v[48:51], a[220:223], a[48:51], v[48:51]
v_mfma_f32_16x16x32_bf16 v[52:55], a[220:223], a[52:55], v[52:55]
buffer_load_dwordx4 v3, s[32:35], s37 offen offset:1024 sc1 lds
v_mfma_f32_16x16x32_bf16 v[56:59], a[220:223], a[56:59], v[56:59]
v_mfma_f32_16x16x32_bf16 v[60:63], a[220:223], v[160:163], v[60:63]
global_load_dwordx4 a[220:223], v3, s[80:81] offset:3072 sc1
s_add_u32 s80, s80, 8192
s_addc_u32 s81, s81, 0
v_mfma_f32_16x16x32_bf16 v[64:67], a[224:227], a[48:51], v[64:67]
v_mfma_f32_16x16x32_bf16 v[68:71], a[224:227], a[52:55], v[68:71]
buffer_load_dwordx4 v3, s[32:35], s37 offen offset:2048 sc1 lds
v_mfma_f32_16x16x32_bf16 v[72:75], a[224:227], a[56:59], v[72:75]
s_waitcnt vmcnt(35) lgkmcnt(0)
v_mfma_f32_16x16x32_bf16 v[76:79], a[224:227], v[160:163], v[76:79]
global_load_dwordx4 a[224:227], v3, s[80:81] offset:-4096 sc1
v_mfma_f32_16x16x32_bf16 v[32:35], a[228:231], a[60:63], v[32:35]
s_waitcnt vmcnt(14)
s_barrier
v_mfma_f32_16x16x32_bf16 v[36:39], a[228:231], a[64:67], v[36:39]
ds_read_b64_tr_b16 v[160:161], v11 offset:24576
ds_read_b64_tr_b16 v[162:163], v11 offset:25088
v_mfma_f32_16x16x32_bf16 v[40:43], a[228:231], a[68:71], v[40:43]
ds_read_b64_tr_b16 a[72:73], v8 offset:24576
ds_read_b64_tr_b16 a[74:75], v8 offset:25088
v_mfma_f32_16x16x32_bf16 v[44:47], a[228:231], v[164:167], v[44:47]
global_load_dwordx4 a[228:231], v3, s[80:81] offset:-3072 sc1
v_mfma_f32_16x16x32_bf16 v[204:207], v[212:215], a[60:63], v[204:207]
ds_read_b64_tr_b16 a[76:77], v9 offset:24576
ds_read_b64_tr_b16 a[78:79], v9 offset:25088
v_mfma_f32_16x16x32_bf16 v[208:211], a[60:63], a[60:63], v[208:211]
ds_read_b64_tr_b16 a[80:81], v10 offset:24576
ds_read_b64_tr_b16 a[82:83], v10 offset:25088
v_mfma_f32_16x16x32_bf16 v[48:51], a[232:235], a[60:63], v[48:51]
v_mfma_f32_16x16x32_bf16 v[52:55], a[232:235], a[64:67], v[52:55]
v_mfma_f32_16x16x32_bf16 v[56:59], a[232:235], a[68:71], v[56:59]
v_mfma_f32_16x16x32_bf16 v[60:63], a[232:235], v[164:167], v[60:63]
global_load_dwordx4 a[232:235], v3, s[80:81] offset:-2048 sc1
v_mfma_f32_16x16x32_bf16 v[64:67], a[236:239], a[60:63], v[64:67]
v_mfma_f32_16x16x32_bf16 v[68:71], a[236:239], a[64:67], v[68:71]
v_mfma_f32_16x16x32_bf16 v[72:75], a[236:239], a[68:71], v[72:75]
s_waitcnt vmcnt(35) lgkmcnt(0)
v_mfma_f32_16x16x32_bf16 v[76:79], a[236:239], v[164:167], v[76:79]
global_load_dwordx4 a[236:239], v3, s[80:81] offset:-1024 sc1
v_mfma_f32_16x16x32_bf16 v[32:35], a[240:243], a[72:75], v[32:35]
ds_read_b64_tr_b16 v[164:165], v11 offset:28672
ds_read_b64_tr_b16 v[166:167], v11 offset:29184
v_mfma_f32_16x16x32_bf16 v[36:39], a[240:243], a[76:79], v[36:39]
ds_read_b64_tr_b16 a[84:85], v8 offset:28672
ds_read_b64_tr_b16 a[86:87], v8 offset:29184
v_mfma_f32_16x16x32_bf16 v[40:43], a[240:243], a[80:83], v[40:43]
ds_read_b64_tr_b16 a[88:89], v9 offset:28672
ds_read_b64_tr_b16 a[90:91], v9 offset:29184
v_mfma_f32_16x16x32_bf16 v[44:47], a[240:243], v[160:163], v[44:47]
global_load_dwordx4 a[240:243], v3, s[80:81] offset:0 sc1
v_mfma_f32_16x16x32_bf16 v[204:207], v[212:215], a[72:75], v[204:207]
ds_read_b64_tr_b16 a[92:93], v10 offset:28672
ds_read_b64_tr_b16 a[94:95], v10 offset:29184
v_mfma_f32_16x16x32_bf16 v[208:211], a[72:75], a[72:75], v[208:211]
v_mfma_f32_16x16x32_bf16 v[48:51], a[244:247], a[72:75], v[48:51]
v_mfma_f32_16x16x32_bf16 v[52:55], a[244:247], a[76:79], v[52:55]
v_mfma_f32_16x16x32_bf16 v[56:59], a[244:247], a[80:83], v[56:59]
v_mfma_f32_16x16x32_bf16 v[60:63], a[244:247], v[160:163], v[60:63]
global_load_dwordx4 a[244:247], v3, s[80:81] offset:1024 sc1
v_mfma_f32_16x16x32_bf16 v[64:67], a[248:251], a[72:75], v[64:67]
v_mfma_f32_16x16x32_bf16 v[68:71], a[248:251], a[76:79], v[68:71]
v_mfma_f32_16x16x32_bf16 v[72:75], a[248:251], a[80:83], v[72:75]
s_waitcnt vmcnt(35) lgkmcnt(0)
v_mfma_f32_16x16x32_bf16 v[76:79], a[248:251], v[160:163], v[76:79]
global_load_dwordx4 a[248:251], v3, s[80:81] offset:2048 sc1
v_mfma_f32_16x16x32_bf16 v[32:35], a[252:255], a[84:87], v[32:35]
ds_read_b64_tr_b16 v[160:161], v11 offset:32768
ds_read_b64_tr_b16 v[162:163], v11 offset:33280
v_mfma_f32_16x16x32_bf16 v[36:39], a[252:255], a[88:91], v[36:39]
ds_read_b64_tr_b16 a[96:97], v8 offset:32768
ds_read_b64_tr_b16 a[98:99], v8 offset:33280
v_mfma_f32_16x16x32_bf16 v[40:43], a[252:255], a[92:95], v[40:43]
ds_read_b64_tr_b16 a[100:101], v9 offset:32768
ds_read_b64_tr_b16 a[102:103], v9 offset:33280
v_mfma_f32_16x16x32_bf16 v[44:47], a[252:255], v[164:167], v[44:47]
global_load_dwordx4 a[252:255], v3, s[80:81] offset:3072 sc1
s_add_u32 s80, s80, 8192
s_addc_u32 s81, s81, 0
v_mfma_f32_16x16x32_bf16 v[204:207], v[212:215], a[84:87], v[204:207]
ds_read_b64_tr_b16 a[104:105], v10 offset:32768
ds_read_b64_tr_b16 a[106:107], v10 offset:33280
v_mfma_f32_16x16x32_bf16 v[208:211], a[84:87], a[84:87], v[208:211]
v_mfma_f32_16x16x32_bf16 v[48:51], v[128:131], a[84:87], v[48:51]
v_mfma_f32_16x16x32_bf16 v[52:55], v[128:131], a[88:91], v[52:55]
v_mfma_f32_16x16x32_bf16 v[56:59], v[128:131], a[92:95], v[56:59]
v_mfma_f32_16x16x32_bf16 v[60:63], v[128:131], v[164:167], v[60:63]
global_load_dwordx4 v[128:131], v3, s[80:81] offset:-4096 sc1
v_mfma_f32_16x16x32_bf16 v[64:67], v[132:135], a[84:87], v[64:67]
v_mfma_f32_16x16x32_bf16 v[68:71], v[132:135], a[88:91], v[68:71]
v_mfma_f32_16x16x32_bf16 v[72:75], v[132:135], a[92:95], v[72:75]
s_waitcnt vmcnt(35) lgkmcnt(0)
v_mfma_f32_16x16x32_bf16 v[76:79], v[132:135], v[164:167], v[76:79]
global_load_dwordx4 v[132:135], v3, s[80:81] offset:-3072 sc1
v_mfma_f32_16x16x32_bf16 v[32:35], v[136:139], a[96:99], v[32:35]
ds_read_b64_tr_b16 v[164:165], v11 offset:36864
ds_read_b64_tr_b16 v[166:167], v11 offset:37376
v_mfma_f32_16x16x32_bf16 v[36:39], v[136:139], a[100:103], v[36:39]
ds_read_b64_tr_b16 a[108:109], v8 offset:36864
ds_read_b64_tr_b16 a[110:111], v8 offset:37376
v_mfma_f32_16x16x32_bf16 v[40:43], v[136:139], a[104:107], v[40:43]
ds_read_b64_tr_b16 a[112:113], v9 offset:36864
ds_read_b64_tr_b16 a[114:115], v9 offset:37376
v_mfma_f32_16x16x32_bf16 v[44:47], v[136:139], v[160:163], v[44:47]
global_load_dwordx4 v[136:139], v3, s[80:81] offset:-2048 sc1
v_mfma_f32_16x16x32_bf16 v[204:207], v[212:215], a[96:99], v[204:207]
ds_read_b64_tr_b16 a[116:117], v10 offset:36864
ds_read_b64_tr_b16 a[118:119], v10 offset:37376
v_mfma_f32_16x16x32_bf16 v[208:211], a[96:99], a[96:99], v[208:211]
v_mfma_f32_16x16x32_bf16 v[48:51], v[140:143], a[96:99], v[48:51]
v_mfma_f32_16x16x32_bf16 v[52:55], v[140:143], a[100:103], v[52:55]
v_mfma_f32_16x16x32_bf16 v[56:59], v[140:143], a[104:107], v[56:59]
v_mfma_f32_16x16x32_bf16 v[60:63], v[140:143], v[160:163], v[60:63]
global_load_dwordx4 v[140:143], v3, s[80:81] offset:-1024 sc1
v_mfma_f32_16x16x32_bf16 v[64:67], v[144:147], a[96:99], v[64:67]
v_mfma_f32_16x16x32_bf16 v[68:71], v[144:147], a[100:103], v[68:71]
v_mfma_f32_16x16x32_bf16 v[72:75], v[144:147], a[104:107], v[72:75]
s_waitcnt vmcnt(35) lgkmcnt(0)
v_mfma_f32_16x16x32_bf16 v[76:79], v[144:147], v[160:163], v[76:79]
global_load_dwordx4 v[144:147], v3, s[80:81] offset:0 sc1
v_mfma_f32_16x16x32_bf16 v[32:35], v[148:151], a[108:111], v[32:35]
s_waitcnt vmcnt(13)
s_barrier
v_mfma_f32_16x16x32_bf16 v[36:39], v[148:151], a[112:115], v[36:39]
ds_read_b64_tr_b16 v[160:161], v11 offset:40960
ds_read_b64_tr_b16 v[162:163], v11 offset:41472
v_mfma_f32_16x16x32_bf16 v[40:43], v[148:151], a[116:119], v[40:43]
ds_read_b64_tr_b16 a[124:125], v9 offset:40960
ds_read_b64_tr_b16 a[126:127], v9 offset:41472
v_mfma_f32_16x16x32_bf16 v[44:47], v[148:151], v[164:167], v[44:47]
global_load_dwordx4 v[148:151], v3, s[80:81] offset:1024 sc1
v_mfma_f32_16x16x32_bf16 v[204:207], v[212:215], a[108:111], v[204:207]
ds_read_b64_tr_b16 a[128:129], v10 offset:40960
ds_read_b64_tr_b16 a[130:131], v10 offset:41472
v_mfma_f32_16x16x32_bf16 v[208:211], a[108:111], a[108:111], v[208:211]
ds_read_b64_tr_b16 a[120:121], v8 offset:40960
ds_read_b64_tr_b16 a[122:123], v8 offset:41472
v_mfma_f32_16x16x32_bf16 v[48:51], v[152:155], a[108:111], v[48:51]
ds_read_b64_tr_b16 a[132:133], v8 offset:45056
ds_read_b64_tr_b16 a[134:135], v8 offset:45568
v_mfma_f32_16x16x32_bf16 v[52:55], v[152:155], a[112:115], v[52:55]
ds_read_b64_tr_b16 a[144:145], v8 offset:49152
ds_read_b64_tr_b16 a[146:147], v8 offset:49664
v_mfma_f32_16x16x32_bf16 v[56:59], v[152:155], a[116:119], v[56:59]
v_mfma_f32_16x16x32_bf16 v[60:63], v[152:155], v[164:167], v[60:63]
global_load_dwordx4 v[152:155], v3, s[80:81] offset:2048 sc1
v_mfma_f32_16x16x32_bf16 v[64:67], v[156:159], a[108:111], v[64:67]
v_mfma_f32_16x16x32_bf16 v[68:71], v[156:159], a[112:115], v[68:71]
v_mfma_f32_16x16x32_bf16 v[72:75], v[156:159], a[116:119], v[72:75]
s_waitcnt vmcnt(14) lgkmcnt(0)
v_mfma_f32_16x16x32_bf16 v[76:79], v[156:159], v[164:167], v[76:79]
global_load_dwordx4 v[156:159], v3, s[80:81] offset:3072 sc1
s_add_u32 s80, s80, 8192
s_addc_u32 s81, s81, 0
v_mfma_f32_16x16x32_bf16 v[32:35], a[216:219], a[120:123], v[32:35]
ds_read_b64_tr_b16 v[164:165], v11 offset:45056
ds_read_b64_tr_b16 v[166:167], v11 offset:45568
v_mfma_f32_16x16x32_bf16 v[36:39], a[216:219], a[124:127], v[36:39]
ds_read_b64_tr_b16 a[136:137], v9 offset:45056
ds_read_b64_tr_b16 a[138:139], v9 offset:45568
v_mfma_f32_16x16x32_bf16 v[40:43], a[216:219], a[128:131], v[40:43]
ds_read_b64_tr_b16 a[140:141], v10 offset:45056
ds_read_b64_tr_b16 a[142:143], v10 offset:45568
v_mfma_f32_16x16x32_bf16 v[44:47], a[216:219], v[160:163], v[44:47]
global_load_dwordx4 a[216:219], v3, s[80:81] offset:-4096 sc1
v_mfma_f32_16x16x32_bf16 v[204:207], v[212:215], a[120:123], v[204:207]
ds_read_b64_tr_b16 a[156:157], v8 offset:53248
ds_read_b64_tr_b16 a[158:159], v8 offset:53760
v_mfma_f32_16x16x32_bf16 v[208:211], a[120:123], a[120:123], v[208:211]
ds_read_b64_tr_b16 a[168:169], v8 offset:57344
ds_read_b64_tr_b16 a[170:171], v8 offset:57856
v_mfma_f32_16x16x32_bf16 v[48:51], a[220:223], a[120:123], v[48:51]
ds_read_b64_tr_b16 a[180:181], v8 offset:61440
ds_read_b64_tr_b16 a[182:183], v8 offset:61952
v_mfma_f32_16x16x32_bf16 v[52:55], a[220:223], a[124:127], v[52:55]
v_mfma_f32_16x16x32_bf16 v[56:59], a[220:223], a[128:131], v[56:59]
v_mfma_f32_16x16x32_bf16 v[60:63], a[220:223], v[160:163], v[60:63]
global_load_dwordx4 a[220:223], v3, s[80:81] offset:-3072 sc1
v_mfma_f32_16x16x32_bf16 v[204:207], v[212:215], a[132:135], v[204:207]
v_mfma_f32_16x16x32_bf16 v[208:211], a[132:135], a[132:135], v[208:211]
v_mfma_f32_16x16x32_bf16 v[64:67], a[224:227], a[120:123], v[64:67]
v_mfma_f32_16x16x32_bf16 v[68:71], a[224:227], a[124:127], v[68:71]
v_mfma_f32_16x16x32_bf16 v[72:75], a[224:227], a[128:131], v[72:75]
v_mfma_f32_16x16x32_bf16 v[76:79], a[224:227], v[160:163], v[76:79]
global_load_dwordx4 a[224:227], v3, s[80:81] offset:-2048 sc1
v_mfma_f32_16x16x32_bf16 v[204:207], v[212:215], a[144:147], v[204:207]
s_waitcnt vmcnt(15) lgkmcnt(0)
v_mfma_f32_16x16x32_bf16 v[208:211], a[144:147], a[144:147], v[208:211]
v_mfma_f32_16x16x32_bf16 v[32:35], a[228:231], a[132:135], v[32:35]
ds_read_b64_tr_b16 v[160:161], v11 offset:49152
ds_read_b64_tr_b16 v[162:163], v11 offset:49664
v_mfma_f32_16x16x32_bf16 v[36:39], a[228:231], a[136:139], v[36:39]
ds_read_b64_tr_b16 a[148:149], v9 offset:49152
ds_read_b64_tr_b16 a[150:151], v9 offset:49664
v_mfma_f32_16x16x32_bf16 v[40:43], a[228:231], a[140:143], v[40:43]
ds_read_b64_tr_b16 a[152:153], v10 offset:49152
ds_read_b64_tr_b16 a[154:155], v10 offset:49664
v_mfma_f32_16x16x32_bf16 v[44:47], a[228:231], v[164:167], v[44:47]
global_load_dwordx4 a[228:231], v3, s[80:81] offset:-1024 sc1
v_mfma_f32_16x16x32_bf16 v[204:207], v[212:215], a[156:159], v[204:207]
ds_read_b64_tr_b16 a[192:193], v12 offset:0
ds_read_b64_tr_b16 a[194:195], v12 offset:512
v_mfma_f32_16x16x32_bf16 v[208:211], a[156:159], a[156:159], v[208:211]
ds_read_b64_tr_b16 a[204:205], v12 offset:4096
ds_read_b64_tr_b16 a[206:207], v12 offset:4608
v_mfma_f32_16x16x32_bf16 v[48:51], a[232:235], a[132:135], v[48:51]
v_mfma_f32_16x16x32_bf16 v[52:55], a[232:235], a[136:139], v[52:55]
v_mfma_f32_16x16x32_bf16 v[56:59], a[232:235], a[140:143], v[56:59]
v_mfma_f32_16x16x32_bf16 v[60:63], a[232:235], v[164:167], v[60:63]
global_load_dwordx4 a[232:235], v3, s[80:81] offset:0 sc1
v_mfma_f32_16x16x32_bf16 v[204:207], v[212:215], a[168:171], v[204:207]
v_mfma_f32_16x16x32_bf16 v[208:211], a[168:171], a[168:171], v[208:211]
v_mfma_f32_16x16x32_bf16 v[64:67], a[236:239], a[132:135], v[64:67]
v_mfma_f32_16x16x32_bf16 v[68:71], a[236:239], a[136:139], v[68:71]
v_mfma_f32_16x16x32_bf16 v[72:75], a[236:239], a[140:143], v[72:75]
v_mfma_f32_16x16x32_bf16 v[76:79], a[236:239], v[164:167], v[76:79]
global_load_dwordx4 a[236:239], v3, s[80:81] offset:1024 sc1
v_mfma_f32_16x16x32_bf16 v[204:207], v[212:215], a[180:183], v[204:207]
s_waitcnt vmcnt(15) lgkmcnt(0)
v_mfma_f32_16x16x32_bf16 v[208:211], a[180:183], a[180:183], v[208:211]
v_mfma_f32_16x16x32_bf16 v[32:35], a[240:243], a[144:147], v[32:35]
ds_read_b64_tr_b16 v[164:165], v11 offset:53248
ds_read_b64_tr_b16 v[166:167], v11 offset:53760
v_mfma_f32_16x16x32_bf16 v[36:39], a[240:243], a[148:151], v[36:39]
ds_read_b64_tr_b16 a[160:161], v9 offset:53248
ds_read_b64_tr_b16 a[162:163], v9 offset:53760
v_mfma_f32_16x16x32_bf16 v[40:43], a[240:243], a[152:155], v[40:43]
ds_read_b64_tr_b16 a[164:165], v10 offset:53248
ds_read_b64_tr_b16 a[166:167], v10 offset:53760
v_mfma_f32_16x16x32_bf16 v[44:47], a[240:243], v[160:163], v[44:47]
global_load_dwordx4 a[240:243], v3, s[80:81] offset:2048 sc1
v_mfma_f32_16x16x32_bf16 v[204:207], v[212:215], a[192:195], v[204:207]
v_mfma_f32_16x16x32_bf16 v[208:211], a[192:195], a[192:195], v[208:211]
v_mfma_f32_16x16x32_bf16 v[48:51], a[244:247], a[144:147], v[48:51]
v_mfma_f32_16x16x32_bf16 v[52:55], a[244:247], a[148:151], v[52:55]
v_mfma_f32_16x16x32_bf16 v[56:59], a[244:247], a[152:155], v[56:59]
v_mfma_f32_16x16x32_bf16 v[60:63], a[244:247], v[160:163], v[60:63]
global_load_dwordx4 a[244:247], v3, s[80:81] offset:3072 sc1
s_add_u32 s80, s80, 8192
s_addc_u32 s81, s81, 0
v_mfma_f32_16x16x32_bf16 v[204:207], v[212:215], a[204:207], v[204:207]
v_mfma_f32_16x16x32_bf16 v[208:211], a[204:207], a[204:207], v[208:211]
v_mfma_f32_16x16x32_bf16 v[64:67], a[248:251], a[144:147], v[64:67]
v_mfma_f32_16x16x32_bf16 v[68:71], a[248:251], a[148:151], v[68:71]
v_mfma_f32_16x16x32_bf16 v[72:75], a[248:251], a[152:155], v[72:75]
s_waitcnt vmcnt(14) lgkmcnt(0)
v_mfma_f32_16x16x32_bf16 v[76:79], a[248:251], v[160:163], v[76:79]
global_load_dwordx4 a[248:251], v3, s[80:81] offset:-4096 sc1
v_mfma_f32_16x16x32_bf16 v[32:35], a[252:255], a[156:159], v[32:35]
global_load_dword v30, v28, s[16:17] sc1
v_mfma_f32_16x16x32_bf16 v[36:39], a[252:255], a[160:163], v[36:39]
ds_read_b64_tr_b16 v[160:161], v11 offset:57344
ds_read_b64_tr_b16 v[162:163], v11 offset:57856
v_mfma_f32_16x16x32_bf16 v[40:43], a[252:255], a[164:167], v[40:43]
ds_read_b64_tr_b16 a[172:173], v9 offset:57344
ds_read_b64_tr_b16 a[174:175], v9 offset:57856
v_mfma_f32_16x16x32_bf16 v[44:47], a[252:255], v[164:167], v[44:47]
global_load_dwordx4 a[252:255], v3, s[80:81] offset:-3072 sc1
v_mfma_f32_16x16x32_bf16 v[48:51], v[128:131], a[156:159], v[48:51]
ds_read_b64_tr_b16 a[176:177], v10 offset:57344
ds_read_b64_tr_b16 a[178:179], v10 offset:57856
v_mfma_f32_16x16x32_bf16 v[52:55], v[128:131], a[160:163], v[52:55]
v_mfma_f32_16x16x32_bf16 v[56:59], v[128:131], a[164:167], v[56:59]
v_mfma_f32_16x16x32_bf16 v[60:63], v[128:131], v[164:167], v[60:63]
global_load_dwordx4 v[128:131], v3, s[80:81] offset:-2048 sc1
v_mfma_f32_16x16x32_bf16 v[64:67], v[132:135], a[156:159], v[64:67]
v_mfma_f32_16x16x32_bf16 v[68:71], v[132:135], a[160:163], v[68:71]
v_mfma_f32_16x16x32_bf16 v[72:75], v[132:135], a[164:167], v[72:75]
s_waitcnt vmcnt(15) lgkmcnt(0)
v_mfma_f32_16x16x32_bf16 v[76:79], v[132:135], v[164:167], v[76:79]
global_load_dwordx4 v[132:135], v3, s[80:81] offset:-1024 sc1
v_mfma_f32_16x16x32_bf16 v[32:35], v[136:139], a[168:171], v[32:35]
ds_read_b64_tr_b16 v[164:165], v11 offset:61440
ds_read_b64_tr_b16 v[166:167], v11 offset:61952
v_mfma_f32_16x16x32_bf16 v[36:39], v[136:139], a[172:175], v[36:39]
ds_read_b64_tr_b16 a[184:185], v9 offset:61440
ds_read_b64_tr_b16 a[186:187], v9 offset:61952
v_mfma_f32_16x16x32_bf16 v[40:43], v[136:139], a[176:179], v[40:43]
ds_read_b64_tr_b16 a[188:189], v10 offset:61440
ds_read_b64_tr_b16 a[190:191], v10 offset:61952
v_mfma_f32_16x16x32_bf16 v[44:47], v[136:139], v[160:163], v[44:47]
global_load_dwordx4 v[136:139], v3, s[80:81] offset:0 sc1
v_cndmask_b32 v208, v208, v209, s[66:67]
v_mfma_f32_16x16x32_bf16 v[48:51], v[140:143], a[168:171], v[48:51]
v_cndmask_b32 v208, v208, v210, s[68:69]
v_cndmask_b32 v208, v208, v211, s[70:71]
v_mfma_f32_16x16x32_bf16 v[52:55], v[140:143], a[172:175], v[52:55]
v_mul_f32 v204, 0x3ae38e39, v204
v_mul_f32 v208, 0x3ae38e39, v208
v_mfma_f32_16x16x32_bf16 v[56:59], v[140:143], a[176:179], v[56:59]
v_fma_f32 v208, -v204, v204, v208
v_max_f32 v208, 0, v208
v_mfma_f32_16x16x32_bf16 v[60:63], v[140:143], v[160:163], v[60:63]
global_load_dwordx4 v[140:143], v3, s[80:81] offset:1024 sc1
v_cvt_pk_bf16_f32 v204, v204, v204
v_mfma_f32_16x16x32_bf16 v[64:67], v[144:147], a[168:171], v[64:67]
v_and_b32 v204, 0xffff0000, v204
v_cvt_pk_bf16_f32 v208, v208, v208
v_mfma_f32_16x16x32_bf16 v[68:71], v[144:147], a[172:175], v[68:71]
v_and_b32 v208, 0xffff0000, v208
v_add_f32 v208, 0x3727c5ac, v208
v_mfma_f32_16x16x32_bf16 v[72:75], v[144:147], a[176:179], v[72:75]
s_waitcnt vmcnt(15) lgkmcnt(0)
v_cvt_pk_bf16_f32 v208, v208, v208
v_mfma_f32_16x16x32_bf16 v[76:79], v[144:147], v[160:163], v[76:79]
global_load_dwordx4 v[144:147], v3, s[80:81] offset:2048 sc1
v_and_b32 v208, 0xffff0000, v208
v_mfma_f32_16x16x32_bf16 v[32:35], v[148:151], a[180:183], v[32:35]
ds_read_b64_tr_b16 v[160:161], v15 offset:0
ds_read_b64_tr_b16 v[162:163], v15 offset:512
v_mfma_f32_16x16x32_bf16 v[36:39], v[148:151], a[184:187], v[36:39]
ds_read_b64_tr_b16 a[196:197], v13 offset:0
ds_read_b64_tr_b16 a[198:199], v13 offset:512
v_mfma_f32_16x16x32_bf16 v[40:43], v[148:151], a[188:191], v[40:43]
ds_read_b64_tr_b16 a[200:201], v14 offset:0
ds_read_b64_tr_b16 a[202:203], v14 offset:512
v_mfma_f32_16x16x32_bf16 v[44:47], v[148:151], v[164:167], v[44:47]
global_load_dwordx4 v[148:151], v3, s[80:81] offset:3072 sc1
s_add_u32 s80, s80, 8192
s_addc_u32 s81, s81, 0
v_mfma_f32_16x16x32_bf16 v[48:51], v[152:155], a[180:183], v[48:51]
v_sqrt_f32 v208, v208
v_mfma_f32_16x16x32_bf16 v[52:55], v[152:155], a[184:187], v[52:55]
s_nop 0
v_cvt_pk_bf16_f32 v208, v208, v208
v_mfma_f32_16x16x32_bf16 v[56:59], v[152:155], a[188:191], v[56:59]
v_and_b32 v208, 0xffff0000, v208
v_mfma_f32_16x16x32_bf16 v[60:63], v[152:155], v[164:167], v[60:63]
global_load_dwordx4 v[152:155], v3, s[80:81] offset:-4096 sc1
v_mfma_f32_16x16x32_bf16 v[64:67], v[156:159], a[180:183], v[64:67]
v_rcp_f32 v216, v208
v_mfma_f32_16x16x32_bf16 v[68:71], v[156:159], a[184:187], v[68:71]
s_nop 0
v_mul_f32 v216, 0x3fb8aa3b, v216
v_mfma_f32_16x16x32_bf16 v[72:75], v[156:159], a[188:191], v[72:75]
s_waitcnt vmcnt(15) lgkmcnt(0)
v_mul_f32 v208, v204, v216
v_sub_f32 v208, 0, v208
v_mfma_f32_16x16x32_bf16 v[76:79], v[156:159], v[164:167], v[76:79]
global_load_dwordx4 v[156:159], v3, s[80:81] offset:-3072 sc1
v_mov_b32 v204, v216
v_mfma_f32_16x16x32_bf16 v[32:35], a[216:219], a[192:195], v[32:35]
ds_read_b64_tr_b16 v[164:165], v15 offset:4096
ds_read_b64_tr_b16 v[166:167], v15 offset:4608
v_mfma_f32_16x16x32_bf16 v[36:39], a[216:219], a[196:199], v[36:39]
ds_read_b64_tr_b16 a[208:209], v13 offset:4096
ds_read_b64_tr_b16 a[210:211], v13 offset:4608
v_mfma_f32_16x16x32_bf16 v[40:43], a[216:219], a[200:203], v[40:43]
ds_read_b64_tr_b16 a[212:213], v14 offset:4096
ds_read_b64_tr_b16 a[214:215], v14 offset:4608
v_mfma_f32_16x16x32_bf16 v[44:47], a[216:219], v[160:163], v[44:47]
global_load_dwordx4 a[216:219], v3, s[80:81] offset:-2048 sc1
v_mov_b32 v205, v208
v_mfma_f32_16x16x32_bf16 v[48:51], a[220:223], a[192:195], v[48:51]
ds_write_b64 v5, v[204:205]
ds_read_b128 v[168:171], v4 offset:0
v_mfma_f32_16x16x32_bf16 v[52:55], a[220:223], a[196:199], v[52:55]
ds_read_b128 v[180:183], v4 offset:3072
ds_read_b128 v[192:195], v4 offset:6144
v_mfma_f32_16x16x32_bf16 v[56:59], a[220:223], a[200:203], v[56:59]
ds_read_b128 v[172:175], v4 offset:64
ds_read_b128 v[184:187], v4 offset:3136
v_mfma_f32_16x16x32_bf16 v[60:63], a[220:223], v[160:163], v[60:63]
global_load_dwordx4 a[220:223], v3, s[80:81] offset:-1024 sc1
ds_read_b128 v[196:199], v4 offset:6208
v_mfma_f32_16x16x32_bf16 v[64:67], a[224:227], a[192:195], v[64:67]
ds_read_b128 v[176:179], v4 offset:128
ds_read_b128 v[188:191], v4 offset:3200
v_mfma_f32_16x16x32_bf16 v[68:71], a[224:227], a[196:199], v[68:71]
ds_read_b128 v[200:203], v4 offset:6272
s_waitcnt lgkmcnt(9)
s_barrier
ds_read_b64 v[244:245], v6
v_mfma_f32_16x16x32_bf16 v[72:75], a[224:227], a[200:203], v[72:75]
s_waitcnt vmcnt(15) lgkmcnt(11)
v_xor_b32 v217, 128, v6
ds_read_b64 v[246:247], v217
v_mfma_f32_16x16x32_bf16 v[76:79], a[224:227], v[160:163], v[76:79]
global_load_dwordx4 a[224:227], v3, s[80:81] offset:0 sc1
v_xor_b32 v218, 256, v6
v_mfma_f32_16x16x32_bf16 v[32:35], a[228:231], a[204:207], v[32:35]
ds_read_b64_tr_b16 v[160:161], v11 offset:0
ds_read_b64_tr_b16 v[162:163], v11 offset:512
v_mfma_f32_16x16x32_bf16 v[36:39], a[228:231], a[208:211], v[36:39]
ds_read_b64 v[248:249], v218
v_xor_b32 v219, 384, v6
v_mfma_f32_16x16x32_bf16 v[40:43], a[228:231], a[212:215], v[40:43]
ds_read_b64 v[250:251], v219
s_waitcnt lgkmcnt(12)
v_add_f32 v168, v168, v180
v_mfma_f32_16x16x32_bf16 v[44:47], a[228:231], v[164:167], v[44:47]
global_load_dwordx4 a[228:231], v3, s[80:81] offset:1024 sc1
v_add_f32 v169, v169, v181
v_mfma_f32_16x16x32_bf16 v[48:51], a[232:235], a[204:207], v[48:51]
v_add_f32 v170, v170, v182
v_add_f32 v171, v171, v183
v_mfma_f32_16x16x32_bf16 v[52:55], a[232:235], a[208:211], v[52:55]
s_waitcnt lgkmcnt(9)
v_add_f32 v172, v172, v184
v_mfma_f32_16x16x32_bf16 v[56:59], a[232:235], a[212:215], v[56:59]
v_add_f32 v173, v173, v185
v_mfma_f32_16x16x32_bf16 v[60:63], a[232:235], v[164:167], v[60:63]
global_load_dwordx4 a[232:235], v3, s[80:81] offset:2048 sc1
v_add_f32 v174, v174, v186
v_mfma_f32_16x16x32_bf16 v[64:67], a[236:239], a[204:207], v[64:67]
v_add_f32 v175, v175, v187
v_mfma_f32_16x16x32_bf16 v[68:71], a[236:239], a[208:211], v[68:71]
s_waitcnt lgkmcnt(6)
v_add_f32 v176, v176, v188
v_add_f32 v177, v177, v189
v_mfma_f32_16x16x32_bf16 v[72:75], a[236:239], a[212:215], v[72:75]
s_waitcnt vmcnt(15) lgkmcnt(2)
v_add_f32 v178, v178, v190
v_mfma_f32_16x16x32_bf16 v[76:79], a[236:239], v[164:167], v[76:79]
global_load_dwordx4 a[236:239], v3, s[80:81] offset:3072 sc1
s_add_u32 s80, s80, 8192
s_addc_u32 s81, s81, 0
v_add_f32 v179, v179, v191
s_waitcnt lgkmcnt(0)
s_waitcnt vmcnt(15)
s_mov_b32 s77, 400000
s_branch fused_kernel_pollc6
fused_kernel_poll6:
global_load_dword v30, v28, s[16:17] sc1
s_waitcnt vmcnt(0)
fused_kernel_pollc6:
v_xor_b32 v30, s76, v30
v_cmp_ne_u32 vcc, 0, v30
s_sub_u32 s77, s77, 1
s_cselect_b64 vcc, 0, vcc
s_cmp_lg_u64 vcc, 0
s_cbranch_scc1 fused_kernel_poll6
v_mfma_f32_16x16x32_bf16 v[80:83], a[240:243], a[0:3], 0
ds_read_b64_tr_b16 v[164:165], v11 offset:4096
ds_read_b64_tr_b16 v[166:167], v11 offset:4608
v_mfma_f32_16x16x32_bf16 v[84:87], a[240:243], a[4:7], 0
v_fma_f32 v204, v245, v168, v192
v_fma_f32 v205, v245, v169, v193
v_mfma_f32_16x16x32_bf16 v[88:91], a[240:243], a[8:11], 0
v_fma_f32 v206, v245, v170, v194
v_fma_f32 v207, v245, v171, v195
v_fma_f32 v32, v244, v32, v204
v_mfma_f32_16x16x32_bf16 v[92:95], a[240:243], v[160:163], 0
global_load_dwordx4 a[240:243], v3, s[80:81] offset:-4096 sc1
v_fma_f32 v33, v244, v33, v205
v_fma_f32 v34, v244, v34, v206
v_mfma_f32_16x16x32_bf16 v[96:99], a[244:247], a[0:3], 0
v_fma_f32 v35, v244, v35, v207
v_exp_f32 v204, v32
v_mfma_f32_16x16x32_bf16 v[100:103], a[244:247], a[4:7], 0
v_exp_f32 v205, v33
v_mfma_f32_16x16x32_bf16 v[104:107], a[244:247], a[8:11], 0
v_exp_f32 v206, v34
v_mfma_f32_16x16x32_bf16 v[108:111], a[244:247], v[160:163], 0
global_load_dwordx4 a[244:247], v3, s[80:81] offset:-3072 sc1
v_exp_f32 v207, v35
v_mfma_f32_16x16x32_bf16 v[112:115], a[248:251], a[0:3], 0
v_fma_f32 v208, v204, 0.5, 1.0
v_fma_f32 v209, v205, 0.5, 1.0
v_mfma_f32_16x16x32_bf16 v[116:119], a[248:251], a[4:7], 0
v_fma_f32 v210, v206, 0.5, 1.0
v_fma_f32 v211, v207, 0.5, 1.0
v_fma_f32 v208, v204, v208, 1.0
v_mfma_f32_16x16x32_bf16 v[120:123], a[248:251], a[8:11], 0
s_waitcnt vmcnt(14) lgkmcnt(0)
v_fma_f32 v209, v205, v209, 1.0
v_fma_f32 v210, v206, v210, 1.0
v_fma_f32 v211, v207, v211, 1.0
v_mfma_f32_16x16x32_bf16 v[124:127], a[248:251], v[160:163], 0
global_load_dwordx4 a[248:251], v3, s[80:81] offset:-2048 sc1
v_rcp_f32 v208, v208
v_mfma_f32_16x16x32_bf16 v[80:83], a[252:255], a[12:15], v[80:83]
ds_read_b64_tr_b16 v[160:161], v11 offset:8192
ds_read_b64_tr_b16 v[162:163], v11 offset:8704
v_mfma_f32_16x16x32_bf16 v[84:87], a[252:255], a[16:19], v[84:87]
v_rcp_f32 v209, v209
v_mfma_f32_16x16x32_bf16 v[88:91], a[252:255], a[20:23], v[88:91]
v_rcp_f32 v210, v210
v_mfma_f32_16x16x32_bf16 v[92:95], a[252:255], v[164:167], v[92:95]
global_load_dwordx4 a[252:255], v3, s[80:81] offset:-1024 sc1
v_rcp_f32 v211, v211
v_mfma_f32_16x16x32_bf16 v[96:99], v[128:131], a[12:15], v[96:99]
v_fma_f32 v32, -v32, v208, v32
v_fma_f32 v33, -v33, v209, v33
v_fma_f32 v34, -v34, v210, v34
v_mfma_f32_16x16x32_bf16 v[100:103], v[128:131], a[16:19], v[100:103]
v_fma_f32 v35, -v35, v211, v35
v_cvt_pk_bf16_f32 v228, v32, v33
v_mfma_f32_16x16x32_bf16 v[104:107], v[128:131], a[20:23], v[104:107]
v_cvt_pk_bf16_f32 v229, v34, v35
v_fma_f32 v212, v247, v168, v192
v_fma_f32 v213, v247, v169, v193
v_mfma_f32_16x16x32_bf16 v[108:111], v[128:131], v[164:167], v[108:111]
global_load_dwordx4 v[128:131], v3, s[80:81] offset:0 sc1
v_fma_f32 v214, v247, v170, v194
v_fma_f32 v215, v247, v171, v195
v_mfma_f32_16x16x32_bf16 v[112:115], v[132:135], a[12:15], v[112:115]
v_fma_f32 v36, v246, v36, v212
v_fma_f32 v37, v246, v37, v213
v_fma_f32 v38, v246, v38, v214
v_mfma_f32_16x16x32_bf16 v[116:119], v[132:135], a[16:19], v[116:119]
v_fma_f32 v39, v246, v39, v215
v_exp_f32 v212, v36
v_mfma_f32_16x16x32_bf16 v[120:123], v[132:135], a[20:23], v[120:123]
s_waitcnt vmcnt(14) lgkmcnt(0)
v_exp_f32 v213, v37
v_mfma_f32_16x16x32_bf16 v[124:127], v[132:135], v[164:167], v[124:127]
global_load_dwordx4 v[132:135], v3, s[80:81] offset:1024 sc1
v_exp_f32 v214, v38
v_mfma_f32_16x16x32_bf16 v[80:83], v[136:139], a[24:27], v[80:83]
ds_read_b64_tr_b16 v[164:165], v11 offset:12288
ds_read_b64_tr_b16 v[166:167], v11 offset:12800
v_mfma_f32_16x16x32_bf16 v[84:87], v[136:139], a[28:31], v[84:87]
v_exp_f32 v215, v39
v_fma_f32 v216, v212, 0.5, 1.0
v_mfma_f32_16x16x32_bf16 v[88:91], v[136:139], a[32:35], v[88:91]
v_fma_f32 v217, v213, 0.5, 1.0
v_fma_f32 v218, v214, 0.5, 1.0
v_mfma_f32_16x16x32_bf16 v[92:95], v[136:139], v[160:163], v[92:95]
global_load_dwordx4 v[136:139], v3, s[80:81] offset:2048 sc1
v_fma_f32 v219, v215, 0.5, 1.0
v_fma_f32 v216, v212, v216, 1.0
v_mfma_f32_16x16x32_bf16 v[96:99], v[140:143], a[24:27], v[96:99]
v_fma_f32 v217, v213, v217, 1.0
v_fma_f32 v218, v214, v218, 1.0
v_fma_f32 v219, v215, v219, 1.0
v_mfma_f32_16x16x32_bf16 v[100:103], v[140:143], a[28:31], v[100:103]
v_rcp_f32 v216, v216
v_mfma_f32_16x16x32_bf16 v[104:107], v[140:143], a[32:35], v[104:107]
v_rcp_f32 v217, v217
v_mfma_f32_16x16x32_bf16 v[108:111], v[140:143], v[160:163], v[108:111]
global_load_dwordx4 v[140:143], v3, s[80:81] offset:3072 sc1
s_add_u32 s80, s80, 8192
s_addc_u32 s81, s81, 0
v_rcp_f32 v218, v218
v_mfma_f32_16x16x32_bf16 v[112:115], v[144:147], a[24:27], v[112:115]
v_rcp_f32 v219, v219
v_mfma_f32_16x16x32_bf16 v[116:119], v[144:147], a[28:31], v[116:119]
v_fma_f32 v36, -v36, v216, v36
v_fma_f32 v37, -v37, v217, v37
v_fma_f32 v38, -v38, v218, v38
v_mfma_f32_16x16x32_bf16 v[120:123], v[144:147], a[32:35], v[120:123]
s_waitcnt vmcnt(14) lgkmcnt(0)
v_fma_f32 v39, -v39, v219, v39
v_cvt_pk_bf16_f32 v232, v36, v37
v_mfma_f32_16x16x32_bf16 v[124:127], v[144:147], v[160:163], v[124:127]
global_load_dwordx4 v[144:147], v3, s[80:81] offset:-4096 sc1
v_cvt_pk_bf16_f32 v233, v38, v39
v_fma_f32 v220, v249, v168, v192
v_mfma_f32_16x16x32_bf16 v[80:83], v[148:151], a[36:39], v[80:83]
ds_read_b64_tr_b16 v[160:161], v11 offset:16384
ds_read_b64_tr_b16 v[162:163], v11 offset:16896
v_fma_f32 v221, v249, v169, v193
v_mfma_f32_16x16x32_bf16 v[84:87], v[148:151], a[40:43], v[84:87]
v_fma_f32 v222, v249, v170, v194
v_fma_f32 v223, v249, v171, v195
v_fma_f32 v40, v248, v40, v220
v_mfma_f32_16x16x32_bf16 v[88:91], v[148:151], a[44:47], v[88:91]
v_fma_f32 v41, v248, v41, v221
v_fma_f32 v42, v248, v42, v222
v_fma_f32 v43, v248, v43, v223
v_mfma_f32_16x16x32_bf16 v[92:95], v[148:151], v[164:167], v[92:95]
global_load_dwordx4 v[148:151], v3, s[80:81] offset:-3072 sc1
v_exp_f32 v220, v40
v_mfma_f32_16x16x32_bf16 v[96:99], v[152:155], a[36:39], v[96:99]
v_exp_f32 v221, v41
v_mfma_f32_16x16x32_bf16 v[100:103], v[152:155], a[40:43], v[100:103]
v_exp_f32 v222, v42
v_mfma_f32_16x16x32_bf16 v[104:107], v[152:155], a[44:47], v[104:107]
v_exp_f32 v223, v43
v_mfma_f32_16x16x32_bf16 v[108:111], v[152:155], v[164:167], v[108:111]
global_load_dwordx4 v[152:155], v3, s[80:81] offset:-2048 sc1
v_fma_f32 v224, v220, 0.5, 1.0
v_fma_f32 v225, v221, 0.5, 1.0
v_mfma_f32_16x16x32_bf16 v[112:115], v[156:159], a[36:39], v[112:115]
v_fma_f32 v226, v222, 0.5, 1.0
v_fma_f32 v227, v223, 0.5, 1.0
v_fma_f32 v224, v220, v224, 1.0
v_mfma_f32_16x16x32_bf16 v[116:119], v[156:159], a[40:43], v[116:119]
v_fma_f32 v225, v221, v225, 1.0
v_fma_f32 v226, v222, v226, 1.0
v_mfma_f32_16x16x32_bf16 v[120:123], v[156:159], a[44:47], v[120:123]
s_waitcnt vmcnt(14) lgkmcnt(0)
v_fma_f32 v227, v223, v227, 1.0
v_rcp_f32 v224, v224
v_mfma_f32_16x16x32_bf16 v[124:127], v[156:159], v[164:167], v[124:127]
global_load_dwordx4 v[156:159], v3, s[80:81] offset:-1024 sc1
v_rcp_f32 v225, v225
v_mfma_f32_16x16x32_bf16 v[80:83], a[216:219], a[48:51], v[80:83]
ds_read_b64_tr_b16 v[164:165], v11 offset:20480
ds_read_b64_tr_b16 v[166:167], v11 offset:20992
v_mfma_f32_16x16x32_bf16 v[84:87], a[216:219], a[52:55], v[84:87]
v_rcp_f32 v226, v226
v_mfma_f32_16x16x32_bf16 v[88:91], a[216:219], a[56:59], v[88:91]
v_rcp_f32 v227, v227
v_fma_f32 v40, -v40, v224, v40
v_mfma_f32_16x16x32_bf16 v[92:95], a[216:219], v[160:163], v[92:95]
global_load_dwordx4 a[216:219], v3, s[80:81] offset:0 sc1
v_fma_f32 v41, -v41, v225, v41
v_fma_f32 v42, -v42, v226, v42
v_mfma_f32_16x16x32_bf16 v[96:99], a[220:223], a[48:51], v[96:99]
v_fma_f32 v43, -v43, v227, v43
v_cvt_pk_bf16_f32 v236, v40, v41
v_cvt_pk_bf16_f32 v237, v42, v43
v_mfma_f32_16x16x32_bf16 v[100:103], a[220:223], a[52:55], v[100:103]
v_fma_f32 v204, v251, v168, v192
v_fma_f32 v205, v251, v169, v193
v_fma_f32 v206, v251, v170, v194
v_mfma_f32_16x16x32_bf16 v[104:107], a[220:223], a[56:59], v[104:107]
v_fma_f32 v207, v251, v171, v195
ds_read_b128 v[168:171], v4 offset:192
v_mfma_f32_16x16x32_bf16 v[108:111], a[220:223], v[160:163], v[108:111]
global_load_dwordx4 a[220:223], v3, s[80:81] offset:1024 sc1
ds_read_b128 v[180:183], v4 offset:3264
ds_read_b128 v[192:195], v4 offset:6336
v_mfma_f32_16x16x32_bf16 v[112:115], a[224:227], a[48:51], v[112:115]
v_fma_f32 v44, v250, v44, v204
v_fma_f32 v45, v250, v45, v205
v_fma_f32 v46, v250, v46, v206
v_mfma_f32_16x16x32_bf16 v[116:119], a[224:227], a[52:55], v[116:119]
v_fma_f32 v47, v250, v47, v207
v_exp_f32 v204, v44
v_mfma_f32_16x16x32_bf16 v[120:123], a[224:227], a[56:59], v[120:123]
s_waitcnt vmcnt(14) lgkmcnt(3)
v_exp_f32 v205, v45
v_mfma_f32_16x16x32_bf16 v[124:127], a[224:227], v[160:163], v[124:127]
global_load_dwordx4 a[224:227], v3, s[80:81] offset:2048 sc1
v_exp_f32 v206, v46
v_mfma_f32_16x16x32_bf16 v[80:83], a[228:231], a[60:63], v[80:83]
ds_read_b64_tr_b16 v[160:161], v11 offset:24576
ds_read_b64_tr_b16 v[162:163], v11 offset:25088
v_mfma_f32_16x16x32_bf16 v[84:87], a[228:231], a[64:67], v[84:87]
v_exp_f32 v207, v47
v_fma_f32 v208, v204, 0.5, 1.0
v_mfma_f32_16x16x32_bf16 v[88:91], a[228:231], a[68:71], v[88:91]
v_fma_f32 v209, v205, 0.5, 1.0
v_fma_f32 v210, v206, 0.5, 1.0
v_mfma_f32_16x16x32_bf16 v[92:95], a[228:231], v[164:167], v[92:95]
global_load_dwordx4 a[228:231], v3, s[80:81] offset:3072 sc1
s_add_u32 s80, s80, 8192
s_addc_u32 s81, s81, 0
v_fma_f32 v211, v207, 0.5, 1.0
v_fma_f32 v208, v204, v208, 1.0
v_mfma_f32_16x16x32_bf16 v[96:99], a[232:235], a[60:63], v[96:99]
v_fma_f32 v209, v205, v209, 1.0
v_fma_f32 v210, v206, v210, 1.0
v_fma_f32 v211, v207, v211, 1.0
v_mfma_f32_16x16x32_bf16 v[100:103], a[232:235], a[64:67], v[100:103]
v_rcp_f32 v208, v208
v_mfma_f32_16x16x32_bf16 v[104:107], a[232:235], a[68:71], v[104:107]
v_rcp_f32 v209, v209
v_mfma_f32_16x16x32_bf16 v[108:111], a[232:235], v[164:167], v[108:111]
global_load_dwordx4 a[232:235], v3, s[80:81] offset:-4096 sc1
v_rcp_f32 v210, v210
v_mfma_f32_16x16x32_bf16 v[112:115], a[236:239], a[60:63], v[112:115]
v_rcp_f32 v211, v211
v_fma_f32 v44, -v44, v208, v44
v_mfma_f32_16x16x32_bf16 v[116:119], a[236:239], a[64:67], v[116:119]
v_fma_f32 v45, -v45, v209, v45
v_fma_f32 v46, -v46, v210, v46
v_fma_f32 v47, -v47, v211, v47
v_mfma_f32_16x16x32_bf16 v[120:123], a[236:239], a[68:71], v[120:123]
s_waitcnt vmcnt(14) lgkmcnt(0)
v_cvt_pk_bf16_f32 v240, v44, v45
v_cvt_pk_bf16_f32 v241, v46, v47
v_fma_f32 v212, v245, v172, v196
v_mfma_f32_16x16x32_bf16 v[124:127], a[236:239], v[164:167], v[124:127]
global_load_dwordx4 a[236:239], v3, s[80:81] offset:-3072 sc1
v_fma_f32 v213, v245, v173, v197
v_fma_f32 v214, v245, v174, v198
v_mfma_f32_16x16x32_bf16 v[80:83], a[240:243], a[72:75], v[80:83]
ds_read_b64_tr_b16 v[164:165], v11 offset:28672
ds_read_b64_tr_b16 v[166:167], v11 offset:29184
v_fma_f32 v215, v245, v175, v199
v_mfma_f32_16x16x32_bf16 v[84:87], a[240:243], a[76:79], v[84:87]
v_fma_f32 v48, v244, v48, v212
v_fma_f32 v49, v244, v49, v213
v_fma_f32 v50, v244, v50, v214
v_mfma_f32_16x16x32_bf16 v[88:91], a[240:243], a[80:83], v[88:91]
v_fma_f32 v51, v244, v51, v215
v_exp_f32 v212, v48
v_mfma_f32_16x16x32_bf16 v[92:95], a[240:243], v[160:163], v[92:95]
global_load_dwordx4 a[240:243], v3, s[80:81] offset:-2048 sc1
v_exp_f32 v213, v49
v_mfma_f32_16x16x32_bf16 v[96:99], a[244:247], a[72:75], v[96:99]
v_exp_f32 v214, v50
v_mfma_f32_16x16x32_bf16 v[100:103], a[244:247], a[76:79], v[100:103]
v_exp_f32 v215, v51
v_mfma_f32_16x16x32_bf16 v[104:107], a[244:247], a[80:83], v[104:107]
v_fma_f32 v216, v212, 0.5, 1.0
v_fma_f32 v217, v213, 0.5, 1.0
v_mfma_f32_16x16x32_bf16 v[108:111], a[244:247], v[160:163], v[108:111]
global_load_dwordx4 a[244:247], v3, s[80:81] offset:-1024 sc1
v_fma_f32 v218, v214, 0.5, 1.0
v_fma_f32 v219, v215, 0.5, 1.0
v_mfma_f32_16x16x32_bf16 v[112:115], a[248:251], a[72:75], v[112:115]
v_fma_f32 v216, v212, v216, 1.0
v_fma_f32 v217, v213, v217, 1.0
v_fma_f32 v218, v214, v218, 1.0
v_mfma_f32_16x16x32_bf16 v[116:119], a[248:251], a[76:79], v[116:119]
v_fma_f32 v219, v215, v219, 1.0
v_rcp_f32 v216, v216
v_mfma_f32_16x16x32_bf16 v[120:123], a[248:251], a[80:83], v[120:123]
s_waitcnt vmcnt(14) lgkmcnt(0)
v_rcp_f32 v217, v217
v_mfma_f32_16x16x32_bf16 v[124:127], a[248:251], v[160:163], v[124:127]
global_load_dwordx4 a[248:251], v3, s[80:81] offset:0 sc1
v_rcp_f32 v218, v218
v_mfma_f32_16x16x32_bf16 v[80:83], a[252:255], a[84:87], v[80:83]
ds_read_b64_tr_b16 v[160:161], v11 offset:32768
ds_read_b64_tr_b16 v[162:163], v11 offset:33280
v_mfma_f32_16x16x32_bf16 v[84:87], a[252:255], a[88:91], v[84:87]
v_rcp_f32 v219, v219
v_mfma_f32_16x16x32_bf16 v[88:91], a[252:255], a[92:95], v[88:91]
v_fma_f32 v48, -v48, v216, v48
v_fma_f32 v49, -v49, v217, v49
v_fma_f32 v50, -v50, v218, v50
v_mfma_f32_16x16x32_bf16 v[92:95], a[252:255], v[164:167], v[92:95]
global_load_dwordx4 a[252:255], v3, s[80:81] offset:1024 sc1
v_fma_f32 v51, -v51, v219, v51
v_cvt_pk_bf16_f32 v230, v48, v49
v_mfma_f32_16x16x32_bf16 v[96:99], v[128:131], a[84:87], v[96:99]
v_cvt_pk_bf16_f32 v231, v50, v51
ds_write_b128 v20, v[228:231] offset:0
v_mfma_f32_16x16x32_bf16 v[100:103], v[128:131], a[88:91], v[100:103]
v_fma_f32 v220, v247, v172, v196
v_fma_f32 v221, v247, v173, v197
v_mfma_f32_16x16x32_bf16 v[104:107], v[128:131], a[92:95], v[104:107]
v_fma_f32 v222, v247, v174, v198
v_fma_f32 v223, v247, v175, v199
v_fma_f32 v52, v246, v52, v220
v_mfma_f32_16x16x32_bf16 v[108:111], v[128:131], v[164:167], v[108:111]
global_load_dwordx4 v[128:131], v3, s[80:81] offset:2048 sc1
v_fma_f32 v53, v246, v53, v221
v_fma_f32 v54, v246, v54, v222
v_mfma_f32_16x16x32_bf16 v[112:115], v[132:135], a[84:87], v[112:115]
v_fma_f32 v55, v246, v55, v223
v_exp_f32 v220, v52
v_mfma_f32_16x16x32_bf16 v[116:119], v[132:135], a[88:91], v[116:119]
v_exp_f32 v221, v53
v_mfma_f32_16x16x32_bf16 v[120:123], v[132:135], a[92:95], v[120:123]
s_waitcnt vmcnt(14) lgkmcnt(1)
v_exp_f32 v222, v54
v_mfma_f32_16x16x32_bf16 v[124:127], v[132:135], v[164:167], v[124:127]
global_load_dwordx4 v[132:135], v3, s[80:81] offset:3072 sc1
s_add_u32 s80, s80, 8192
s_addc_u32 s81, s81, 0
v_exp_f32 v223, v55
v_mfma_f32_16x16x32_bf16 v[80:83], v[136:139], a[96:99], v[80:83]
ds_read_b64_tr_b16 v[164:165], v11 offset:36864
ds_read_b64_tr_b16 v[166:167], v11 offset:37376
v_mfma_f32_16x16x32_bf16 v[84:87], v[136:139], a[100:103], v[84:87]
v_fma_f32 v224, v220, 0.5, 1.0
v_fma_f32 v225, v221, 0.5, 1.0
v_mfma_f32_16x16x32_bf16 v[88:91], v[136:139], a[104:107], v[88:91]
v_fma_f32 v226, v222, 0.5, 1.0
v_fma_f32 v227, v223, 0.5, 1.0
v_fma_f32 v224, v220, v224, 1.0
v_mfma_f32_16x16x32_bf16 v[92:95], v[136:139], v[160:163], v[92:95]
global_load_dwordx4 v[136:139], v3, s[80:81] offset:-4096 sc1
v_fma_f32 v225, v221, v225, 1.0
v_fma_f32 v226, v222, v226, 1.0
v_mfma_f32_16x16x32_bf16 v[96:99], v[140:143], a[96:99], v[96:99]
v_fma_f32 v227, v223, v227, 1.0
v_rcp_f32 v224, v224
v_mfma_f32_16x16x32_bf16 v[100:103], v[140:143], a[100:103], v[100:103]
v_rcp_f32 v225, v225
v_mfma_f32_16x16x32_bf16 v[104:107], v[140:143], a[104:107], v[104:107]
v_rcp_f32 v226, v226
v_mfma_f32_16x16x32_bf16 v[108:111], v[140:143], v[160:163], v[108:111]
global_load_dwordx4 v[140:143], v3, s[80:81] offset:-3072 sc1
v_rcp_f32 v227, v227
v_mfma_f32_16x16x32_bf16 v[112:115], v[144:147], a[96:99], v[112:115]
v_fma_f32 v52, -v52, v224, v52
v_fma_f32 v53, -v53, v225, v53
v_mfma_f32_16x16x32_bf16 v[116:119], v[144:147], a[100:103], v[116:119]
v_fma_f32 v54, -v54, v226, v54
v_fma_f32 v55, -v55, v227, v55
v_cvt_pk_bf16_f32 v234, v52, v53
v_mfma_f32_16x16x32_bf16 v[120:123], v[144:147], a[104:107], v[120:123]
s_waitcnt vmcnt(14) lgkmcnt(0)
v_cvt_pk_bf16_f32 v235, v54, v55
ds_write_b128 v21, v[232:235] offset:0
v_mfma_f32_16x16x32_bf16 v[124:127], v[144:147], v[160:163], v[124:127]
global_load_dwordx4 v[144:147], v3, s[80:81] offset:-2048 sc1
v_fma_f32 v204, v249, v172, v196
v_mfma_f32_16x16x32_bf16 v[80:83], v[148:151], a[108:111], v[80:83]
ds_read_b64_tr_b16 v[160:161], v11 offset:40960
ds_read_b64_tr_b16 v[162:163], v11 offset:41472
v_fma_f32 v205, v249, v173, v197
v_mfma_f32_16x16x32_bf16 v[84:87], v[148:151], a[112:115], v[84:87]
v_fma_f32 v206, v249, v174, v198
v_fma_f32 v207, v249, v175, v199
v_fma_f32 v56, v248, v56, v204
v_mfma_f32_16x16x32_bf16 v[88:91], v[148:151], a[116:119], v[88:91]
v_fma_f32 v57, v248, v57, v205
v_fma_f32 v58, v248, v58, v206
v_fma_f32 v59, v248, v59, v207
v_mfma_f32_16x16x32_bf16 v[92:95], v[148:151], v[164:167], v[92:95]
global_load_dwordx4 v[148:151], v3, s[80:81] offset:-1024 sc1
v_exp_f32 v204, v56
v_mfma_f32_16x16x32_bf16 v[96:99], v[152:155], a[108:111], v[96:99]
v_exp_f32 v205, v57
v_mfma_f32_16x16x32_bf16 v[100:103], v[152:155], a[112:115], v[100:103]
v_exp_f32 v206, v58
v_mfma_f32_16x16x32_bf16 v[104:107], v[152:155], a[116:119], v[104:107]
v_exp_f32 v207, v59
v_mfma_f32_16x16x32_bf16 v[108:111], v[152:155], v[164:167], v[108:111]
global_load_dwordx4 v[152:155], v3, s[80:81] offset:0 sc1
v_fma_f32 v208, v204, 0.5, 1.0
v_fma_f32 v209, v205, 0.5, 1.0
v_mfma_f32_16x16x32_bf16 v[112:115], v[156:159], a[108:111], v[112:115]
v_fma_f32 v210, v206, 0.5, 1.0
v_fma_f32 v211, v207, 0.5, 1.0
v_mfma_f32_16x16x32_bf16 v[116:119], v[156:159], a[112:115], v[116:119]
v_fma_f32 v208, v204, v208, 1.0
v_fma_f32 v209, v205, v209, 1.0
v_fma_f32 v210, v206, v210, 1.0
v_mfma_f32_16x16x32_bf16 v[120:123], v[156:159], a[116:119], v[120:123]
s_waitcnt vmcnt(14) lgkmcnt(0)
v_fma_f32 v211, v207, v211, 1.0
v_rcp_f32 v208, v208
v_mfma_f32_16x16x32_bf16 v[124:127], v[156:159], v[164:167], v[124:127]
global_load_dwordx4 v[156:159], v3, s[80:81] offset:1024 sc1
v_rcp_f32 v209, v209
v_mfma_f32_16x16x32_bf16 v[80:83], a[216:219], a[120:123], v[80:83]
ds_read_b64_tr_b16 v[164:165], v11 offset:45056
ds_read_b64_tr_b16 v[166:167], v11 offset:45568
v_mfma_f32_16x16x32_bf16 v[84:87], a[216:219], a[124:127], v[84:87]
v_rcp_f32 v210, v210
v_mfma_f32_16x16x32_bf16 v[88:91], a[216:219], a[128:131], v[88:91]
v_rcp_f32 v211, v211
v_fma_f32 v56, -v56, v208, v56
v_mfma_f32_16x16x32_bf16 v[92:95], a[216:219], v[160:163], v[92:95]
global_load_dwordx4 a[216:219], v3, s[80:81] offset:2048 sc1
v_fma_f32 v57, -v57, v209, v57
v_fma_f32 v58, -v58, v210, v58
v_mfma_f32_16x16x32_bf16 v[96:99], a[220:223], a[120:123], v[96:99]
v_fma_f32 v59, -v59, v211, v59
v_cvt_pk_bf16_f32 v238, v56, v57
v_cvt_pk_bf16_f32 v239, v58, v59
v_mfma_f32_16x16x32_bf16 v[100:103], a[220:223], a[124:127], v[100:103]
ds_write_b128 v22, v[236:239] offset:0
v_mfma_f32_16x16x32_bf16 v[104:107], a[220:223], a[128:131], v[104:107]
v_fma_f32 v212, v251, v172, v196
v_fma_f32 v213, v251, v173, v197
v_mfma_f32_16x16x32_bf16 v[108:111], a[220:223], v[160:163], v[108:111]
global_load_dwordx4 a[220:223], v3, s[80:81] offset:3072 sc1
s_add_u32 s80, s80, 8192
s_addc_u32 s81, s81, 0
v_fma_f32 v214, v251, v174, v198
v_fma_f32 v215, v251, v175, v199
v_mfma_f32_16x16x32_bf16 v[112:115], a[224:227], a[120:123], v[112:115]
ds_read_b128 v[172:175], v4 offset:256
ds_read_b128 v[184:187], v4 offset:3328
ds_read_b128 v[196:199], v4 offset:6400
v_mfma_f32_16x16x32_bf16 v[116:119], a[224:227], a[124:127], v[116:119]
v_fma_f32 v60, v250, v60, v212
v_fma_f32 v61, v250, v61, v213
v_fma_f32 v62, v250, v62, v214
v_mfma_f32_16x16x32_bf16 v[120:123], a[224:227], a[128:131], v[120:123]
s_waitcnt vmcnt(14) lgkmcnt(4)
v_fma_f32 v63, v250, v63, v215
v_exp_f32 v212, v60
v_mfma_f32_16x16x32_bf16 v[124:127], a[224:227], v[160:163], v[124:127]
global_load_dwordx4 a[224:227], v3, s[80:81] offset:-4096 sc1
v_exp_f32 v213, v61
v_mfma_f32_16x16x32_bf16 v[80:83], a[228:231], a[132:135], v[80:83]
ds_read_b64_tr_b16 v[160:161], v11 offset:49152
ds_read_b64_tr_b16 v[162:163], v11 offset:49664
v_mfma_f32_16x16x32_bf16 v[84:87], a[228:231], a[136:139], v[84:87]
v_exp_f32 v214, v62
v_mfma_f32_16x16x32_bf16 v[88:91], a[228:231], a[140:143], v[88:91]
v_exp_f32 v215, v63
v_fma_f32 v216, v212, 0.5, 1.0
v_mfma_f32_16x16x32_bf16 v[92:95], a[228:231], v[164:167], v[92:95]
global_load_dwordx4 a[228:231], v3, s[80:81] offset:-3072 sc1
v_fma_f32 v217, v213, 0.5, 1.0
v_fma_f32 v218, v214, 0.5, 1.0
v_mfma_f32_16x16x32_bf16 v[96:99], a[232:235], a[132:135], v[96:99]
v_fma_f32 v219, v215, 0.5, 1.0
v_fma_f32 v216, v212, v216, 1.0
v_mfma_f32_16x16x32_bf16 v[100:103], a[232:235], a[136:139], v[100:103]
v_fma_f32 v217, v213, v217, 1.0
v_fma_f32 v218, v214, v218, 1.0
v_mfma_f32_16x16x32_bf16 v[104:107], a[232:235], a[140:143], v[104:107]
v_fma_f32 v219, v215, v219, 1.0
v_rcp_f32 v216, v216
v_mfma_f32_16x16x32_bf16 v[108:111], a[232:235], v[164:167], v[108:111]
global_load_dwordx4 a[232:235], v3, s[80:81] offset:-2048 sc1
v_rcp_f32 v217, v217
v_mfma_f32_16x16x32_bf16 v[112:115], a[236:239], a[132:135], v[112:115]
v_rcp_f32 v218, v218
v_mfma_f32_16x16x32_bf16 v[116:119], a[236:239], a[136:139], v[116:119]
v_rcp_f32 v219, v219
v_mfma_f32_16x16x32_bf16 v[120:123], a[236:239], a[140:143], v[120:123]
s_waitcnt vmcnt(14) lgkmcnt(0)
v_fma_f32 v60, -v60, v216, v60
v_fma_f32 v61, -v61, v217, v61
v_fma_f32 v62, -v62, v218, v62
v_mfma_f32_16x16x32_bf16 v[124:127], a[236:239], v[164:167], v[124:127]
global_load_dwordx4 a[236:239], v3, s[80:81] offset:-1024 sc1
v_fma_f32 v63, -v63, v219, v63
v_cvt_pk_bf16_f32 v242, v60, v61
v_mfma_f32_16x16x32_bf16 v[80:83], a[240:243], a[144:147], v[80:83]
ds_read_b64_tr_b16 v[164:165], v11 offset:53248
ds_read_b64_tr_b16 v[166:167], v11 offset:53760
v_cvt_pk_bf16_f32 v243, v62, v63
v_mfma_f32_16x16x32_bf16 v[84:87], a[240:243], a[148:151], v[84:87]
ds_write_b128 v23, v[240:243] offset:0
v_fma_f32 v220, v245, v176, v200
v_mfma_f32_16x16x32_bf16 v[88:91], a[240:243], a[152:155], v[88:91]
v_fma_f32 v221, v245, v177, v201
v_fma_f32 v222, v245, v178, v202
v_mfma_f32_16x16x32_bf16 v[92:95], a[240:243], v[160:163], v[92:95]
global_load_dwordx4 a[240:243], v3, s[80:81] offset:0 sc1
v_fma_f32 v223, v245, v179, v203
v_fma_f32 v64, v244, v64, v220
v_mfma_f32_16x16x32_bf16 v[96:99], a[244:247], a[144:147], v[96:99]
v_fma_f32 v65, v244, v65, v221
v_fma_f32 v66, v244, v66, v222
v_fma_f32 v67, v244, v67, v223
v_mfma_f32_16x16x32_bf16 v[100:103], a[244:247], a[148:151], v[100:103]
v_exp_f32 v220, v64
v_mfma_f32_16x16x32_bf16 v[104:107], a[244:247], a[152:155], v[104:107]
v_exp_f32 v221, v65
v_mfma_f32_16x16x32_bf16 v[108:111], a[244:247], v[160:163], v[108:111]
global_load_dwordx4 a[244:247], v3, s[80:81] offset:1024 sc1
v_exp_f32 v222, v66
v_mfma_f32_16x16x32_bf16 v[112:115], a[248:251], a[144:147], v[112:115]
v_exp_f32 v223, v67
v_mfma_f32_16x16x32_bf16 v[116:119], a[248:251], a[148:151], v[116:119]
v_fma_f32 v224, v220, 0.5, 1.0
v_fma_f32 v225, v221, 0.5, 1.0
v_fma_f32 v226, v222, 0.5, 1.0
v_mfma_f32_16x16x32_bf16 v[120:123], a[248:251], a[152:155], v[120:123]
s_waitcnt vmcnt(14) lgkmcnt(1)
v_fma_f32 v227, v223, 0.5, 1.0
v_fma_f32 v224, v220, v224, 1.0
v_mfma_f32_16x16x32_bf16 v[124:127], a[248:251], v[160:163], v[124:127]
global_load_dwordx4 a[248:251], v3, s[80:81] offset:2048 sc1
v_fma_f32 v225, v221, v225, 1.0
v_fma_f32 v226, v222, v226, 1.0
v_mfma_f32_16x16x32_bf16 v[80:83], a[252:255], a[156:159], v[80:83]
ds_read_b64_tr_b16 v[160:161], v11 offset:57344
ds_read_b64_tr_b16 v[162:163], v11 offset:57856
v_fma_f32 v227, v223, v227, 1.0
v_mfma_f32_16x16x32_bf16 v[84:87], a[252:255], a[160:163], v[84:87]
v_rcp_f32 v224, v224
v_mfma_f32_16x16x32_bf16 v[88:91], a[252:255], a[164:167], v[88:91]
v_rcp_f32 v225, v225
v_mfma_f32_16x16x32_bf16 v[92:95], a[252:255], v[164:167], v[92:95]
global_load_dwordx4 a[252:255], v3, s[80:81] offset:3072 sc1
s_add_u32 s80, s80, 8192
s_addc_u32 s81, s81, 0
v_rcp_f32 v226, v226
v_mfma_f32_16x16x32_bf16 v[96:99], v[128:131], a[156:159], v[96:99]
v_rcp_f32 v227, v227
v_fma_f32 v64, -v64, v224, v64
v_mfma_f32_16x16x32_bf16 v[100:103], v[128:131], a[160:163], v[100:103]
v_fma_f32 v65, -v65, v225, v65
v_fma_f32 v66, -v66, v226, v66
v_fma_f32 v67, -v67, v227, v67
v_mfma_f32_16x16x32_bf16 v[104:107], v[128:131], a[164:167], v[104:107]
v_cvt_pk_bf16_f32 v228, v64, v65
v_cvt_pk_bf16_f32 v229, v66, v67
v_mfma_f32_16x16x32_bf16 v[108:111], v[128:131], v[164:167], v[108:111]
global_load_dwordx4 v[128:131], v3, s[80:81] offset:-4096 sc1
v_fma_f32 v204, v247, v176, v200
v_fma_f32 v205, v247, v177, v201
v_mfma_f32_16x16x32_bf16 v[112:115], v[132:135], a[156:159], v[112:115]
v_fma_f32 v206, v247, v178, v202
v_fma_f32 v207, v247, v179, v203
v_fma_f32 v68, v246, v68, v204
v_mfma_f32_16x16x32_bf16 v[116:119], v[132:135], a[160:163], v[116:119]
v_fma_f32 v69, v246, v69, v205
v_fma_f32 v70, v246, v70, v206
v_mfma_f32_16x16x32_bf16 v[120:123], v[132:135], a[164:167], v[120:123]
s_waitcnt vmcnt(14) lgkmcnt(0)
v_fma_f32 v71, v246, v71, v207
v_exp_f32 v204, v68
v_mfma_f32_16x16x32_bf16 v[124:127], v[132:135], v[164:167], v[124:127]
global_load_dwordx4 v[132:135], v3, s[80:81] offset:-3072 sc1
v_exp_f32 v205, v69
v_mfma_f32_16x16x32_bf16 v[80:83], v[136:139], a[168:171], v[80:83]
ds_read_b64_tr_b16 v[164:165], v11 offset:61440
ds_read_b64_tr_b16 v[166:167], v11 offset:61952
v_mfma_f32_16x16x32_bf16 v[84:87], v[136:139], a[172:175], v[84:87]
v_exp_f32 v206, v70
v_mfma_f32_16x16x32_bf16 v[88:91], v[136:139], a[176:179], v[88:91]
v_exp_f32 v207, v71
v_fma_f32 v208, v204, 0.5, 1.0
v_mfma_f32_16x16x32_bf16 v[92:95], v[136:139], v[160:163], v[92:95]
global_load_dwordx4 v[136:139], v3, s[80:81] offset:-2048 sc1
v_fma_f32 v209, v205, 0.5, 1.0
v_fma_f32 v210, v206, 0.5, 1.0
v_mfma_f32_16x16x32_bf16 v[96:99], v[140:143], a[168:171], v[96:99]
v_fma_f32 v211, v207, 0.5, 1.0
v_fma_f32 v208, v204, v208, 1.0
v_fma_f32 v209, v205, v209, 1.0
v_mfma_f32_16x16x32_bf16 v[100:103], v[140:143], a[172:175], v[100:103]
v_fma_f32 v210, v206, v210, 1.0
v_fma_f32 v211, v207, v211, 1.0
v_mfma_f32_16x16x32_bf16 v[104:107], v[140:143], a[176:179], v[104:107]
v_rcp_f32 v208, v208
v_mfma_f32_16x16x32_bf16 v[108:111], v[140:143], v[160:163], v[108:111]
global_load_dwordx4 v[140:143], v3, s[80:81] offset:-1024 sc1
v_rcp_f32 v209, v209
v_mfma_f32_16x16x32_bf16 v[112:115], v[144:147], a[168:171], v[112:115]
v_rcp_f32 v210, v210
v_mfma_f32_16x16x32_bf16 v[116:119], v[144:147], a[172:175], v[116:119]
v_rcp_f32 v211, v211
v_fma_f32 v68, -v68, v208, v68
v_mfma_f32_16x16x32_bf16 v[120:123], v[144:147], a[176:179], v[120:123]
s_waitcnt vmcnt(14) lgkmcnt(0)
v_fma_f32 v69, -v69, v209, v69
v_fma_f32 v70, -v70, v210, v70
v_fma_f32 v71, -v71, v211, v71
v_mfma_f32_16x16x32_bf16 v[124:127], v[144:147], v[160:163], v[124:127]
global_load_dwordx4 v[144:147], v3, s[80:81] offset:0 sc1
v_cvt_pk_bf16_f32 v232, v68, v69
v_cvt_pk_bf16_f32 v233, v70, v71
v_mfma_f32_16x16x32_bf16 v[80:83], v[148:151], a[180:183], v[80:83]
ds_read_b64_tr_b16 v[160:161], v15 offset:0
ds_read_b64_tr_b16 v[162:163], v15 offset:512
v_fma_f32 v212, v249, v176, v200
v_mfma_f32_16x16x32_bf16 v[84:87], v[148:151], a[184:187], v[84:87]
v_fma_f32 v213, v249, v177, v201
v_fma_f32 v214, v249, v178, v202
v_fma_f32 v215, v249, v179, v203
v_mfma_f32_16x16x32_bf16 v[88:91], v[148:151], a[188:191], v[88:91]
v_fma_f32 v72, v248, v72, v212
v_fma_f32 v73, v248, v73, v213
v_mfma_f32_16x16x32_bf16 v[92:95], v[148:151], v[164:167], v[92:95]
global_load_dwordx4 v[148:151], v3, s[80:81] offset:1024 sc1
v_fma_f32 v74, v248, v74, v214
v_fma_f32 v75, v248, v75, v215
v_mfma_f32_16x16x32_bf16 v[96:99], v[152:155], a[180:183], v[96:99]
v_exp_f32 v212, v72
v_mfma_f32_16x16x32_bf16 v[100:103], v[152:155], a[184:187], v[100:103]
v_exp_f32 v213, v73
v_mfma_f32_16x16x32_bf16 v[104:107], v[152:155], a[188:191], v[104:107]
v_exp_f32 v214, v74
v_mfma_f32_16x16x32_bf16 v[108:111], v[152:155], v[164:167], v[108:111]
global_load_dwordx4 v[152:155], v3, s[80:81] offset:2048 sc1
v_exp_f32 v215, v75
v_mfma_f32_16x16x32_bf16 v[112:115], v[156:159], a[180:183], v[112:115]
v_fma_f32 v216, v212, 0.5, 1.0
v_fma_f32 v217, v213, 0.5, 1.0
v_fma_f32 v218, v214, 0.5, 1.0
v_mfma_f32_16x16x32_bf16 v[116:119], v[156:159], a[184:187], v[116:119]
v_fma_f32 v219, v215, 0.5, 1.0
v_fma_f32 v216, v212, v216, 1.0
v_fma_f32 v217, v213, v217, 1.0
v_mfma_f32_16x16x32_bf16 v[120:123], v[156:159], a[188:191], v[120:123]
s_waitcnt vmcnt(14) lgkmcnt(0)
v_fma_f32 v218, v214, v218, 1.0
v_fma_f32 v219, v215, v219, 1.0
v_mfma_f32_16x16x32_bf16 v[124:127], v[156:159], v[164:167], v[124:127]
global_load_dwordx4 v[156:159], v3, s[80:81] offset:3072 sc1
s_add_u32 s80, s80, 8192
s_addc_u32 s81, s81, 0
v_rcp_f32 v216, v216
v_mfma_f32_16x16x32_bf16 v[80:83], a[216:219], a[192:195], v[80:83]
ds_read_b64_tr_b16 v[164:165], v15 offset:4096
ds_read_b64_tr_b16 v[166:167], v15 offset:4608
v_mfma_f32_16x16x32_bf16 v[84:87], a[216:219], a[196:199], v[84:87]
v_rcp_f32 v217, v217
v_mfma_f32_16x16x32_bf16 v[88:91], a[216:219], a[200:203], v[88:91]
v_rcp_f32 v218, v218
v_mfma_f32_16x16x32_bf16 v[92:95], a[216:219], v[160:163], v[92:95]
global_load_dwordx4 a[216:219], v3, s[80:81] offset:-4096 sc1
v_rcp_f32 v219, v219
v_mfma_f32_16x16x32_bf16 v[96:99], a[220:223], a[192:195], v[96:99]
v_fma_f32 v72, -v72, v216, v72
v_fma_f32 v73, -v73, v217, v73
v_fma_f32 v74, -v74, v218, v74
v_mfma_f32_16x16x32_bf16 v[100:103], a[220:223], a[196:199], v[100:103]
v_fma_f32 v75, -v75, v219, v75
v_cvt_pk_bf16_f32 v236, v72, v73
v_cvt_pk_bf16_f32 v237, v74, v75
v_mfma_f32_16x16x32_bf16 v[104:107], a[220:223], a[200:203], v[104:107]
v_fma_f32 v220, v251, v176, v200
v_fma_f32 v221, v251, v177, v201
v_fma_f32 v222, v251, v178, v202
v_mfma_f32_16x16x32_bf16 v[108:111], a[220:223], v[160:163], v[108:111]
global_load_dwordx4 a[220:223], v3, s[80:81] offset:-3072 sc1
v_fma_f32 v223, v251, v179, v203
ds_read_b128 v[176:179], v4 offset:320
v_mfma_f32_16x16x32_bf16 v[112:115], a[224:227], a[192:195], v[112:115]
ds_read_b128 v[188:191], v4 offset:3392
ds_read_b128 v[200:203], v4 offset:6464
v_fma_f32 v76, v250, v76, v220
v_mfma_f32_16x16x32_bf16 v[116:119], a[224:227], a[196:199], v[116:119]
v_fma_f32 v77, v250, v77, v221
v_fma_f32 v78, v250, v78, v222
v_mfma_f32_16x16x32_bf16 v[120:123], a[224:227], a[200:203], v[120:123]
s_waitcnt vmcnt(14) lgkmcnt(3)
v_fma_f32 v79, v250, v79, v223
v_exp_f32 v220, v76
v_mfma_f32_16x16x32_bf16 v[124:127], a[224:227], v[160:163], v[124:127]
global_load_dwordx4 a[224:227], v3, s[80:81] offset:-2048 sc1
v_exp_f32 v221, v77
v_mfma_f32_16x16x32_bf16 v[80:83], a[228:231], a[204:207], v[80:83]
ds_read_b64_tr_b16 v[160:161], v11 offset:0
ds_read_b64_tr_b16 v[162:163], v11 offset:512
v_mfma_f32_16x16x32_bf16 v[84:87], a[228:231], a[208:211], v[84:87]
v_exp_f32 v222, v78
v_mfma_f32_16x16x32_bf16 v[88:91], a[228:231], a[212:215], v[88:91]
v_exp_f32 v223, v79
v_fma_f32 v224, v220, 0.5, 1.0
v_mfma_f32_16x16x32_bf16 v[92:95], a[228:231], v[164:167], v[92:95]
global_load_dwordx4 a[228:231], v3, s[80:81] offset:-1024 sc1
v_fma_f32 v225, v221, 0.5, 1.0
v_fma_f32 v226, v222, 0.5, 1.0
v_mfma_f32_16x16x32_bf16 v[96:99], a[232:235], a[204:207], v[96:99]
v_fma_f32 v227, v223, 0.5, 1.0
v_fma_f32 v224, v220, v224, 1.0
v_fma_f32 v225, v221, v225, 1.0
v_mfma_f32_16x16x32_bf16 v[100:103], a[232:235], a[208:211], v[100:103]
v_fma_f32 v226, v222, v226, 1.0
v_fma_f32 v227, v223, v227, 1.0
v_mfma_f32_16x16x32_bf16 v[104:107], a[232:235], a[212:215], v[104:107]
v_rcp_f32 v224, v224
v_mfma_f32_16x16x32_bf16 v[108:111], a[232:235], v[164:167], v[108:111]
global_load_dwordx4 a[232:235], v3, s[80:81] offset:0 sc1
v_rcp_f32 v225, v225
v_mfma_f32_16x16x32_bf16 v[112:115], a[236:239], a[204:207], v[112:115]
v_rcp_f32 v226, v226
v_mfma_f32_16x16x32_bf16 v[116:119], a[236:239], a[208:211], v[116:119]
v_rcp_f32 v227, v227
v_fma_f32 v76, -v76, v224, v76
v_mfma_f32_16x16x32_bf16 v[120:123], a[236:239], a[212:215], v[120:123]
s_waitcnt vmcnt(14) lgkmcnt(0)
v_fma_f32 v77, -v77, v225, v77
v_fma_f32 v78, -v78, v226, v78
v_fma_f32 v79, -v79, v227, v79
v_mfma_f32_16x16x32_bf16 v[124:127], a[236:239], v[164:167], v[124:127]
global_load_dwordx4 a[236:239], v3, s[80:81] offset:1024 sc1
v_cvt_pk_bf16_f32 v240, v76, v77
v_cvt_pk_bf16_f32 v241, v78, v79
v_mfma_f32_16x16x32_bf16 v[32:35], a[240:243], a[0:3], 0
ds_read_b64_tr_b16 v[164:165], v11 offset:4096
ds_read_b64_tr_b16 v[166:167], v11 offset:4608
s_waitcnt lgkmcnt(15)
v_add_f32 v168, v168, v180
v_mfma_f32_16x16x32_bf16 v[36:39], a[240:243], a[4:7], 0
v_add_f32 v169, v169, v181
v_add_f32 v170, v170, v182
v_add_f32 v171, v171, v183
v_mfma_f32_16x16x32_bf16 v[40:43], a[240:243], a[8:11], 0
v_fma_f32 v204, v245, v168, v192
v_fma_f32 v205, v245, v169, v193
v_fma_f32 v206, v245, v170, v194
v_mfma_f32_16x16x32_bf16 v[44:47], a[240:243], v[160:163], 0
global_load_dwordx4 a[240:243], v3, s[80:81] offset:2048 sc1
v_fma_f32 v207, v245, v171, v195
v_fma_f32 v80, v244, v80, v204
v_mfma_f32_16x16x32_bf16 v[48:51], a[244:247], a[0:3], 0
v_fma_f32 v81, v244, v81, v205
v_fma_f32 v82, v244, v82, v206
v_fma_f32 v83, v244, v83, v207
v_mfma_f32_16x16x32_bf16 v[52:55], a[244:247], a[4:7], 0
v_exp_f32 v204, v80
v_mfma_f32_16x16x32_bf16 v[56:59], a[244:247], a[8:11], 0
v_exp_f32 v205, v81
v_mfma_f32_16x16x32_bf16 v[60:63], a[244:247], v[160:163], 0
global_load_dwordx4 a[244:247], v3, s[80:81] offset:3072 sc1
s_add_u32 s80, s80, 8192
s_addc_u32 s81, s81, 0
v_exp_f32 v206, v82
v_mfma_f32_16x16x32_bf16 v[64:67], a[248:251], a[0:3], 0
v_exp_f32 v207, v83
v_fma_f32 v208, v204, 0.5, 1.0
v_mfma_f32_16x16x32_bf16 v[68:71], a[248:251], a[4:7], 0
v_fma_f32 v209, v205, 0.5, 1.0
v_fma_f32 v210, v206, 0.5, 1.0
v_fma_f32 v211, v207, 0.5, 1.0
v_mfma_f32_16x16x32_bf16 v[72:75], a[248:251], a[8:11], 0
s_waitcnt vmcnt(14) lgkmcnt(0)
v_fma_f32 v208, v204, v208, 1.0
v_fma_f32 v209, v205, v209, 1.0
v_fma_f32 v210, v206, v210, 1.0
v_mfma_f32_16x16x32_bf16 v[76:79], a[248:251], v[160:163], 0
global_load_dwordx4 a[248:251], v3, s[80:81] offset:-4096 sc1
v_fma_f32 v211, v207, v211, 1.0
v_rcp_f32 v208, v208
v_mfma_f32_16x16x32_bf16 v[32:35], a[252:255], a[12:15], v[32:35]
ds_read_b64_tr_b16 v[160:161], v11 offset:8192
ds_read_b64_tr_b16 v[162:163], v11 offset:8704
v_rcp_f32 v209, v209
v_mfma_f32_16x16x32_bf16 v[36:39], a[252:255], a[16:19], v[36:39]
v_rcp_f32 v210, v210
v_mfma_f32_16x16x32_bf16 v[40:43], a[252:255], a[20:23], v[40:43]
v_rcp_f32 v211, v211
v_mfma_f32_16x16x32_bf16 v[44:47], a[252:255], v[164:167], v[44:47]
global_load_dwordx4 a[252:255], v3, s[80:81] offset:-3072 sc1
v_fma_f32 v80, -v80, v208, v80
v_fma_f32 v81, -v81, v209, v81
v_mfma_f32_16x16x32_bf16 v[48:51], v[128:131], a[12:15], v[48:51]
v_fma_f32 v82, -v82, v210, v82
v_fma_f32 v83, -v83, v211, v83
v_cvt_pk_bf16_f32 v230, v80, v81
v_mfma_f32_16x16x32_bf16 v[52:55], v[128:131], a[16:19], v[52:55]
v_cvt_pk_bf16_f32 v231, v82, v83
ds_write_b128 v20, v[228:231] offset:4096
v_mfma_f32_16x16x32_bf16 v[56:59], v[128:131], a[20:23], v[56:59]
v_fma_f32 v212, v247, v168, v192
v_fma_f32 v213, v247, v169, v193
v_mfma_f32_16x16x32_bf16 v[60:63], v[128:131], v[164:167], v[60:63]
global_load_dwordx4 v[128:131], v3, s[80:81] offset:-2048 sc1
v_fma_f32 v214, v247, v170, v194
v_fma_f32 v215, v247, v171, v195
v_mfma_f32_16x16x32_bf16 v[64:67], v[132:135], a[12:15], v[64:67]
v_fma_f32 v84, v246, v84, v212
v_fma_f32 v85, v246, v85, v213
v_fma_f32 v86, v246, v86, v214
v_mfma_f32_16x16x32_bf16 v[68:71], v[132:135], a[16:19], v[68:71]
v_fma_f32 v87, v246, v87, v215
v_exp_f32 v212, v84
v_mfma_f32_16x16x32_bf16 v[72:75], v[132:135], a[20:23], v[72:75]
s_waitcnt vmcnt(14) lgkmcnt(1)
v_exp_f32 v213, v85
v_mfma_f32_16x16x32_bf16 v[76:79], v[132:135], v[164:167], v[76:79]
global_load_dwordx4 v[132:135], v3, s[80:81] offset:-1024 sc1
v_exp_f32 v214, v86
v_mfma_f32_16x16x32_bf16 v[32:35], v[136:139], a[24:27], v[32:35]
ds_read_b64_tr_b16 v[164:165], v11 offset:12288
ds_read_b64_tr_b16 v[166:167], v11 offset:12800
v_exp_f32 v215, v87
v_mfma_f32_16x16x32_bf16 v[36:39], v[136:139], a[28:31], v[36:39]
v_fma_f32 v216, v212, 0.5, 1.0
v_fma_f32 v217, v213, 0.5, 1.0
v_fma_f32 v218, v214, 0.5, 1.0
v_mfma_f32_16x16x32_bf16 v[40:43], v[136:139], a[32:35], v[40:43]
v_fma_f32 v219, v215, 0.5, 1.0
v_fma_f32 v216, v212, v216, 1.0
v_mfma_f32_16x16x32_bf16 v[44:47], v[136:139], v[160:163], v[44:47]
global_load_dwordx4 v[136:139], v3, s[80:81] offset:0 sc1
v_fma_f32 v217, v213, v217, 1.0
v_fma_f32 v218, v214, v218, 1.0
v_mfma_f32_16x16x32_bf16 v[48:51], v[140:143], a[24:27], v[48:51]
v_fma_f32 v219, v215, v219, 1.0
v_rcp_f32 v216, v216
v_mfma_f32_16x16x32_bf16 v[52:55], v[140:143], a[28:31], v[52:55]
v_rcp_f32 v217, v217
v_mfma_f32_16x16x32_bf16 v[56:59], v[140:143], a[32:35], v[56:59]
v_rcp_f32 v218, v218
v_mfma_f32_16x16x32_bf16 v[60:63], v[140:143], v[160:163], v[60:63]
global_load_dwordx4 v[140:143], v3, s[80:81] offset:1024 sc1
v_rcp_f32 v219, v219
v_mfma_f32_16x16x32_bf16 v[64:67], v[144:147], a[24:27], v[64:67]
v_fma_f32 v84, -v84, v216, v84
v_fma_f32 v85, -v85, v217, v85
v_fma_f32 v86, -v86, v218, v86
v_mfma_f32_16x16x32_bf16 v[68:71], v[144:147], a[28:31], v[68:71]
v_fma_f32 v87, -v87, v219, v87
v_cvt_pk_bf16_f32 v234, v84, v85
v_cvt_pk_bf16_f32 v235, v86, v87
v_mfma_f32_16x16x32_bf16 v[72:75], v[144:147], a[32:35], v[72:75]
s_waitcnt vmcnt(14) lgkmcnt(0)
ds_write_b128 v21, v[232:235] offset:4096
v_fma_f32 v220, v249, v168, v192
v_mfma_f32_16x16x32_bf16 v[76:79], v[144:147], v[160:163], v[76:79]
global_load_dwordx4 v[144:147], v3, s[80:81] offset:2048 sc1
v_fma_f32 v221, v249, v169, v193
v_fma_f32 v222, v249, v170, v194
v_mfma_f32_16x16x32_bf16 v[32:35], v[148:151], a[36:39], v[32:35]
ds_read_b64_tr_b16 v[160:161], v11 offset:16384
ds_read_b64_tr_b16 v[162:163], v11 offset:16896
v_fma_f32 v223, v249, v171, v195
v_mfma_f32_16x16x32_bf16 v[36:39], v[148:151], a[40:43], v[36:39]
v_fma_f32 v88, v248, v88, v220
v_fma_f32 v89, v248, v89, v221
v_fma_f32 v90, v248, v90, v222
v_mfma_f32_16x16x32_bf16 v[40:43], v[148:151], a[44:47], v[40:43]
v_fma_f32 v91, v248, v91, v223
v_exp_f32 v220, v88
v_mfma_f32_16x16x32_bf16 v[44:47], v[148:151], v[164:167], v[44:47]
global_load_dwordx4 v[148:151], v3, s[80:81] offset:3072 sc1
s_add_u32 s80, s80, 8192
s_addc_u32 s81, s81, 0
v_exp_f32 v221, v89
v_mfma_f32_16x16x32_bf16 v[48:51], v[152:155], a[36:39], v[48:51]
v_exp_f32 v222, v90
v_mfma_f32_16x16x32_bf16 v[52:55], v[152:155], a[40:43], v[52:55]
v_exp_f32 v223, v91
v_fma_f32 v224, v220, 0.5, 1.0
v_mfma_f32_16x16x32_bf16 v[56:59], v[152:155], a[44:47], v[56:59]
v_fma_f32 v225, v221, 0.5, 1.0
v_fma_f32 v226, v222, 0.5, 1.0
v_fma_f32 v227, v223, 0.5, 1.0
v_mfma_f32_16x16x32_bf16 v[60:63], v[152:155], v[164:167], v[60:63]
global_load_dwordx4 v[152:155], v3, s[80:81] offset:-4096 sc1
v_fma_f32 v224, v220, v224, 1.0
v_fma_f32 v225, v221, v225, 1.0
v_mfma_f32_16x16x32_bf16 v[64:67], v[156:159], a[36:39], v[64:67]
v_fma_f32 v226, v222, v226, 1.0
v_fma_f32 v227, v223, v227, 1.0
v_mfma_f32_16x16x32_bf16 v[68:71], v[156:159], a[40:43], v[68:71]
v_rcp_f32 v224, v224
v_rcp_f32 v225, v225
v_mfma_f32_16x16x32_bf16 v[72:75], v[156:159], a[44:47], v[72:75]
s_waitcnt vmcnt(14) lgkmcnt(0)
v_rcp_f32 v226, v226
v_mfma_f32_16x16x32_bf16 v[76:79], v[156:159], v[164:167], v[76:79]
global_load_dwordx4 v[156:159], v3, s[80:81] offset:-3072 sc1
v_rcp_f32 v227, v227
v_mfma_f32_16x16x32_bf16 v[32:35], a[216:219], a[48:51], v[32:35]
ds_read_b64_tr_b16 v[164:165], v11 offset:20480
ds_read_b64_tr_b16 v[166:167], v11 offset:20992
v_fma_f32 v88, -v88, v224, v88
v_mfma_f32_16x16x32_bf16 v[36:39], a[216:219], a[52:55], v[36:39]
v_fma_f32 v89, -v89, v225, v89
v_fma_f32 v90, -v90, v226, v90
v_fma_f32 v91, -v91, v227, v91
v_mfma_f32_16x16x32_bf16 v[40:43], a[216:219], a[56:59], v[40:43]
v_cvt_pk_bf16_f32 v238, v88, v89
v_cvt_pk_bf16_f32 v239, v90, v91
v_mfma_f32_16x16x32_bf16 v[44:47], a[216:219], v[160:163], v[44:47]
global_load_dwordx4 a[216:219], v3, s[80:81] offset:-2048 sc1
ds_write_b128 v22, v[236:239] offset:4096
v_mfma_f32_16x16x32_bf16 v[48:51], a[220:223], a[48:51], v[48:51]
v_fma_f32 v204, v251, v168, v192
v_fma_f32 v205, v251, v169, v193
v_fma_f32 v206, v251, v170, v194
v_mfma_f32_16x16x32_bf16 v[52:55], a[220:223], a[52:55], v[52:55]
v_fma_f32 v207, v251, v171, v195
ds_read_b128 v[168:171], v4 offset:384
ds_read_b128 v[180:183], v4 offset:3456
v_mfma_f32_16x16x32_bf16 v[56:59], a[220:223], a[56:59], v[56:59]
ds_read_b128 v[192:195], v4 offset:6528
v_fma_f32 v92, v250, v92, v204
v_fma_f32 v93, v250, v93, v205
v_mfma_f32_16x16x32_bf16 v[60:63], a[220:223], v[160:163], v[60:63]
global_load_dwordx4 a[220:223], v3, s[80:81] offset:-1024 sc1
v_fma_f32 v94, v250, v94, v206
v_fma_f32 v95, v250, v95, v207
v_mfma_f32_16x16x32_bf16 v[64:67], a[224:227], a[48:51], v[64:67]
v_exp_f32 v204, v92
v_mfma_f32_16x16x32_bf16 v[68:71], a[224:227], a[52:55], v[68:71]
v_exp_f32 v205, v93
v_exp_f32 v206, v94
v_mfma_f32_16x16x32_bf16 v[72:75], a[224:227], a[56:59], v[72:75]
s_waitcnt vmcnt(14) lgkmcnt(4)
v_exp_f32 v207, v95
v_fma_f32 v208, v204, 0.5, 1.0
v_mfma_f32_16x16x32_bf16 v[76:79], a[224:227], v[160:163], v[76:79]
global_load_dwordx4 a[224:227], v3, s[80:81] offset:0 sc1
v_fma_f32 v209, v205, 0.5, 1.0
v_fma_f32 v210, v206, 0.5, 1.0
v_mfma_f32_16x16x32_bf16 v[32:35], a[228:231], a[60:63], v[32:35]
ds_read_b64_tr_b16 v[160:161], v11 offset:24576
ds_read_b64_tr_b16 v[162:163], v11 offset:25088
v_fma_f32 v211, v207, 0.5, 1.0
v_mfma_f32_16x16x32_bf16 v[36:39], a[228:231], a[64:67], v[36:39]
v_fma_f32 v208, v204, v208, 1.0
v_fma_f32 v209, v205, v209, 1.0
v_fma_f32 v210, v206, v210, 1.0
v_mfma_f32_16x16x32_bf16 v[40:43], a[228:231], a[68:71], v[40:43]
v_fma_f32 v211, v207, v211, 1.0
v_rcp_f32 v208, v208
v_mfma_f32_16x16x32_bf16 v[44:47], a[228:231], v[164:167], v[44:47]
global_load_dwordx4 a[228:231], v3, s[80:81] offset:1024 sc1
v_rcp_f32 v209, v209
v_mfma_f32_16x16x32_bf16 v[48:51], a[232:235], a[60:63], v[48:51]
v_rcp_f32 v210, v210
v_rcp_f32 v211, v211
v_mfma_f32_16x16x32_bf16 v[52:55], a[232:235], a[64:67], v[52:55]
v_fma_f32 v92, -v92, v208, v92
v_fma_f32 v93, -v93, v209, v93
v_fma_f32 v94, -v94, v210, v94
v_mfma_f32_16x16x32_bf16 v[56:59], a[232:235], a[68:71], v[56:59]
v_fma_f32 v95, -v95, v211, v95
v_cvt_pk_bf16_f32 v242, v92, v93
v_cvt_pk_bf16_f32 v243, v94, v95
v_mfma_f32_16x16x32_bf16 v[60:63], a[232:235], v[164:167], v[60:63]
global_load_dwordx4 a[232:235], v3, s[80:81] offset:2048 sc1
ds_write_b128 v23, v[240:243] offset:4096
v_mfma_f32_16x16x32_bf16 v[64:67], a[236:239], a[60:63], v[64:67]
s_waitcnt lgkmcnt(15)
v_add_f32 v172, v172, v184
v_add_f32 v173, v173, v185
v_add_f32 v174, v174, v186
v_mfma_f32_16x16x32_bf16 v[68:71], a[236:239], a[64:67], v[68:71]
v_add_f32 v175, v175, v187
v_fma_f32 v212, v245, v172, v196
v_fma_f32 v213, v245, v173, v197
v_mfma_f32_16x16x32_bf16 v[72:75], a[236:239], a[68:71], v[72:75]
s_waitcnt vmcnt(14) lgkmcnt(1)
v_fma_f32 v214, v245, v174, v198
v_fma_f32 v215, v245, v175, v199
v_fma_f32 v96, v244, v96, v212
v_mfma_f32_16x16x32_bf16 v[76:79], a[236:239], v[164:167], v[76:79]
global_load_dwordx4 a[236:239], v3, s[80:81] offset:3072 sc1
s_add_u32 s80, s80, 8192
s_addc_u32 s81, s81, 0
v_fma_f32 v97, v244, v97, v213
v_fma_f32 v98, v244, v98, v214
v_mfma_f32_16x16x32_bf16 v[32:35], a[240:243], a[72:75], v[32:35]
ds_read_b64_tr_b16 v[164:165], v11 offset:28672
ds_read_b64_tr_b16 v[166:167], v11 offset:29184
v_fma_f32 v99, v244, v99, v215
v_mfma_f32_16x16x32_bf16 v[36:39], a[240:243], a[76:79], v[36:39]
v_exp_f32 v212, v96
v_exp_f32 v213, v97
v_mfma_f32_16x16x32_bf16 v[40:43], a[240:243], a[80:83], v[40:43]
v_exp_f32 v214, v98
v_exp_f32 v215, v99
v_mfma_f32_16x16x32_bf16 v[44:47], a[240:243], v[160:163], v[44:47]
global_load_dwordx4 a[240:243], v3, s[80:81] offset:-4096 sc1
v_fma_f32 v216, v212, 0.5, 1.0
v_fma_f32 v217, v213, 0.5, 1.0
v_mfma_f32_16x16x32_bf16 v[48:51], a[244:247], a[72:75], v[48:51]
v_fma_f32 v218, v214, 0.5, 1.0
v_fma_f32 v219, v215, 0.5, 1.0
v_fma_f32 v216, v212, v216, 1.0
v_mfma_f32_16x16x32_bf16 v[52:55], a[244:247], a[76:79], v[52:55]
v_fma_f32 v217, v213, v217, 1.0
v_fma_f32 v218, v214, v218, 1.0
v_fma_f32 v219, v215, v219, 1.0
v_mfma_f32_16x16x32_bf16 v[56:59], a[244:247], a[80:83], v[56:59]
v_rcp_f32 v216, v216
v_rcp_f32 v217, v217
v_mfma_f32_16x16x32_bf16 v[60:63], a[244:247], v[160:163], v[60:63]
global_load_dwordx4 a[244:247], v3, s[80:81] offset:-3072 sc1
v_rcp_f32 v218, v218
v_mfma_f32_16x16x32_bf16 v[64:67], a[248:251], a[72:75], v[64:67]
v_rcp_f32 v219, v219
v_fma_f32 v96, -v96, v216, v96
v_mfma_f32_16x16x32_bf16 v[68:71], a[248:251], a[76:79], v[68:71]
v_fma_f32 v97, -v97, v217, v97
v_fma_f32 v98, -v98, v218, v98
v_fma_f32 v99, -v99, v219, v99
v_mfma_f32_16x16x32_bf16 v[72:75], a[248:251], a[80:83], v[72:75]
s_waitcnt vmcnt(14) lgkmcnt(0)
v_cvt_pk_bf16_f32 v228, v96, v97
v_cvt_pk_bf16_f32 v229, v98, v99
v_fma_f32 v220, v247, v172, v196
v_mfma_f32_16x16x32_bf16 v[76:79], a[248:251], v[160:163], v[76:79]
global_load_dwordx4 a[248:251], v3, s[80:81] offset:-2048 sc1
v_fma_f32 v221, v247, v173, v197
v_fma_f32 v222, v247, v174, v198
v_mfma_f32_16x16x32_bf16 v[32:35], a[252:255], a[84:87], v[32:35]
ds_read_b64_tr_b16 v[160:161], v11 offset:32768
ds_read_b64_tr_b16 v[162:163], v11 offset:33280
v_fma_f32 v223, v247, v175, v199
v_mfma_f32_16x16x32_bf16 v[36:39], a[252:255], a[88:91], v[36:39]
v_fma_f32 v100, v246, v100, v220
v_fma_f32 v101, v246, v101, v221
v_fma_f32 v102, v246, v102, v222
v_mfma_f32_16x16x32_bf16 v[40:43], a[252:255], a[92:95], v[40:43]
v_fma_f32 v103, v246, v103, v223
v_exp_f32 v220, v100
v_mfma_f32_16x16x32_bf16 v[44:47], a[252:255], v[164:167], v[44:47]
global_load_dwordx4 a[252:255], v3, s[80:81] offset:-1024 sc1
v_exp_f32 v221, v101
v_mfma_f32_16x16x32_bf16 v[48:51], v[128:131], a[84:87], v[48:51]
v_exp_f32 v222, v102
v_mfma_f32_16x16x32_bf16 v[52:55], v[128:131], a[88:91], v[52:55]
v_exp_f32 v223, v103
v_mfma_f32_16x16x32_bf16 v[56:59], v[128:131], a[92:95], v[56:59]
v_fma_f32 v224, v220, 0.5, 1.0
v_fma_f32 v225, v221, 0.5, 1.0
v_mfma_f32_16x16x32_bf16 v[60:63], v[128:131], v[164:167], v[60:63]
global_load_dwordx4 v[128:131], v3, s[80:81] offset:0 sc1
v_fma_f32 v226, v222, 0.5, 1.0
v_fma_f32 v227, v223, 0.5, 1.0
v_mfma_f32_16x16x32_bf16 v[64:67], v[132:135], a[84:87], v[64:67]
v_fma_f32 v224, v220, v224, 1.0
v_fma_f32 v225, v221, v225, 1.0
v_fma_f32 v226, v222, v226, 1.0
v_mfma_f32_16x16x32_bf16 v[68:71], v[132:135], a[88:91], v[68:71]
v_fma_f32 v227, v223, v227, 1.0
v_rcp_f32 v224, v224
v_mfma_f32_16x16x32_bf16 v[72:75], v[132:135], a[92:95], v[72:75]
s_waitcnt vmcnt(14) lgkmcnt(0)
v_rcp_f32 v225, v225
v_mfma_f32_16x16x32_bf16 v[76:79], v[132:135], v[164:167], v[76:79]
global_load_dwordx4 v[132:135], v3, s[80:81] offset:1024 sc1
v_rcp_f32 v226, v226
v_mfma_f32_16x16x32_bf16 v[32:35], v[136:139], a[96:99], v[32:35]
ds_read_b64_tr_b16 v[164:165], v11 offset:36864
ds_read_b64_tr_b16 v[166:167], v11 offset:37376
v_mfma_f32_16x16x32_bf16 v[36:39], v[136:139], a[100:103], v[36:39]
v_rcp_f32 v227, v227
v_mfma_f32_16x16x32_bf16 v[40:43], v[136:139], a[104:107], v[40:43]
v_fma_f32 v100, -v100, v224, v100
v_fma_f32 v101, -v101, v225, v101
v_fma_f32 v102, -v102, v226, v102
v_mfma_f32_16x16x32_bf16 v[44:47], v[136:139], v[160:163], v[44:47]
global_load_dwordx4 v[136:139], v3, s[80:81] offset:2048 sc1
v_fma_f32 v103, -v103, v227, v103
v_cvt_pk_bf16_f32 v232, v100, v101
v_mfma_f32_16x16x32_bf16 v[48:51], v[140:143], a[96:99], v[48:51]
v_cvt_pk_bf16_f32 v233, v102, v103
v_fma_f32 v204, v249, v172, v196
v_fma_f32 v205, v249, v173, v197
v_mfma_f32_16x16x32_bf16 v[52:55], v[140:143], a[100:103], v[52:55]
v_fma_f32 v206, v249, v174, v198
v_fma_f32 v207, v249, v175, v199
v_fma_f32 v104, v248, v104, v204
v_mfma_f32_16x16x32_bf16 v[56:59], v[140:143], a[104:107], v[56:59]
v_fma_f32 v105, v248, v105, v205
v_fma_f32 v106, v248, v106, v206
v_fma_f32 v107, v248, v107, v207
v_mfma_f32_16x16x32_bf16 v[60:63], v[140:143], v[160:163], v[60:63]
global_load_dwordx4 v[140:143], v3, s[80:81] offset:3072 sc1
s_add_u32 s80, s80, 8192
s_addc_u32 s81, s81, 0
v_exp_f32 v204, v104
v_mfma_f32_16x16x32_bf16 v[64:67], v[144:147], a[96:99], v[64:67]
v_exp_f32 v205, v105
v_mfma_f32_16x16x32_bf16 v[68:71], v[144:147], a[100:103], v[68:71]
v_exp_f32 v206, v106
v_mfma_f32_16x16x32_bf16 v[72:75], v[144:147], a[104:107], v[72:75]
s_waitcnt vmcnt(14) lgkmcnt(0)
v_exp_f32 v207, v107
v_fma_f32 v208, v204, 0.5, 1.0
v_mfma_f32_16x16x32_bf16 v[76:79], v[144:147], v[160:163], v[76:79]
global_load_dwordx4 v[144:147], v3, s[80:81] offset:-4096 sc1
v_fma_f32 v209, v205, 0.5, 1.0
v_fma_f32 v210, v206, 0.5, 1.0
v_mfma_f32_16x16x32_bf16 v[32:35], v[148:151], a[108:111], v[32:35]
ds_read_b64_tr_b16 v[160:161], v11 offset:40960
ds_read_b64_tr_b16 v[162:163], v11 offset:41472
v_fma_f32 v211, v207, 0.5, 1.0
v_mfma_f32_16x16x32_bf16 v[36:39], v[148:151], a[112:115], v[36:39]
v_fma_f32 v208, v204, v208, 1.0
v_fma_f32 v209, v205, v209, 1.0
v_fma_f32 v210, v206, v210, 1.0
v_mfma_f32_16x16x32_bf16 v[40:43], v[148:151], a[116:119], v[40:43]
v_fma_f32 v211, v207, v211, 1.0
v_rcp_f32 v208, v208
v_mfma_f32_16x16x32_bf16 v[44:47], v[148:151], v[164:167], v[44:47]
global_load_dwordx4 v[148:151], v3, s[80:81] offset:-3072 sc1
v_rcp_f32 v209, v209
v_mfma_f32_16x16x32_bf16 v[48:51], v[152:155], a[108:111], v[48:51]
v_rcp_f32 v210, v210
v_mfma_f32_16x16x32_bf16 v[52:55], v[152:155], a[112:115], v[52:55]
v_rcp_f32 v211, v211
v_mfma_f32_16x16x32_bf16 v[56:59], v[152:155], a[116:119], v[56:59]
v_fma_f32 v104, -v104, v208, v104
v_fma_f32 v105, -v105, v209, v105
v_mfma_f32_16x16x32_bf16 v[60:63], v[152:155], v[164:167], v[60:63]
global_load_dwordx4 v[152:155], v3, s[80:81] offset:-2048 sc1
v_fma_f32 v106, -v106, v210, v106
v_fma_f32 v107, -v107, v211, v107
v_mfma_f32_16x16x32_bf16 v[64:67], v[156:159], a[108:111], v[64:67]
v_cvt_pk_bf16_f32 v236, v104, v105
v_cvt_pk_bf16_f32 v237, v106, v107
v_fma_f32 v212, v251, v172, v196
v_mfma_f32_16x16x32_bf16 v[68:71], v[156:159], a[112:115], v[68:71]
v_fma_f32 v213, v251, v173, v197
v_fma_f32 v214, v251, v174, v198
v_fma_f32 v215, v251, v175, v199
v_mfma_f32_16x16x32_bf16 v[72:75], v[156:159], a[116:119], v[72:75]
s_waitcnt vmcnt(14) lgkmcnt(0)
ds_read_b128 v[172:175], v4 offset:448
ds_read_b128 v[184:187], v4 offset:3520
ds_read_b128 v[196:199], v4 offset:6592
v_mfma_f32_16x16x32_bf16 v[76:79], v[156:159], v[164:167], v[76:79]
global_load_dwordx4 v[156:159], v3, s[80:81] offset:-1024 sc1
v_fma_f32 v108, v250, v108, v212
v_fma_f32 v109, v250, v109, v213
v_mfma_f32_16x16x32_bf16 v[32:35], a[216:219], a[120:123], v[32:35]
ds_read_b64_tr_b16 v[164:165], v11 offset:45056
ds_read_b64_tr_b16 v[166:167], v11 offset:45568
v_fma_f32 v110, v250, v110, v214
v_mfma_f32_16x16x32_bf16 v[36:39], a[216:219], a[124:127], v[36:39]
v_fma_f32 v111, v250, v111, v215
v_exp_f32 v212, v108
v_mfma_f32_16x16x32_bf16 v[40:43], a[216:219], a[128:131], v[40:43]
v_exp_f32 v213, v109
v_mfma_f32_16x16x32_bf16 v[44:47], a[216:219], v[160:163], v[44:47]
global_load_dwordx4 a[216:219], v3, s[80:81] offset:0 sc1
v_exp_f32 v214, v110
v_mfma_f32_16x16x32_bf16 v[48:51], a[220:223], a[120:123], v[48:51]
v_exp_f32 v215, v111
v_mfma_f32_16x16x32_bf16 v[52:55], a[220:223], a[124:127], v[52:55]
v_fma_f32 v216, v212, 0.5, 1.0
v_fma_f32 v217, v213, 0.5, 1.0
v_mfma_f32_16x16x32_bf16 v[56:59], a[220:223], a[128:131], v[56:59]
v_fma_f32 v218, v214, 0.5, 1.0
v_fma_f32 v219, v215, 0.5, 1.0
v_fma_f32 v216, v212, v216, 1.0
v_mfma_f32_16x16x32_bf16 v[60:63], a[220:223], v[160:163], v[60:63]
global_load_dwordx4 a[220:223], v3, s[80:81] offset:1024 sc1
v_fma_f32 v217, v213, v217, 1.0
v_fma_f32 v218, v214, v218, 1.0
v_mfma_f32_16x16x32_bf16 v[64:67], a[224:227], a[120:123], v[64:67]
v_fma_f32 v219, v215, v219, 1.0
v_rcp_f32 v216, v216
v_mfma_f32_16x16x32_bf16 v[68:71], a[224:227], a[124:127], v[68:71]
v_rcp_f32 v217, v217
v_mfma_f32_16x16x32_bf16 v[72:75], a[224:227], a[128:131], v[72:75]
s_waitcnt vmcnt(14) lgkmcnt(0)
v_rcp_f32 v218, v218
v_mfma_f32_16x16x32_bf16 v[76:79], a[224:227], v[160:163], v[76:79]
global_load_dwordx4 a[224:227], v3, s[80:81] offset:2048 sc1
v_rcp_f32 v219, v219
v_mfma_f32_16x16x32_bf16 v[32:35], a[228:231], a[132:135], v[32:35]
ds_read_b64_tr_b16 v[160:161], v11 offset:49152
ds_read_b64_tr_b16 v[162:163], v11 offset:49664
v_fma_f32 v108, -v108, v216, v108
v_mfma_f32_16x16x32_bf16 v[36:39], a[228:231], a[136:139], v[36:39]
v_fma_f32 v109, -v109, v217, v109
v_fma_f32 v110, -v110, v218, v110
v_fma_f32 v111, -v111, v219, v111
v_mfma_f32_16x16x32_bf16 v[40:43], a[228:231], a[140:143], v[40:43]
v_cvt_pk_bf16_f32 v240, v108, v109
v_cvt_pk_bf16_f32 v241, v110, v111
s_waitcnt lgkmcnt(15)
v_add_f32 v176, v176, v188
v_mfma_f32_16x16x32_bf16 v[44:47], a[228:231], v[164:167], v[44:47]
global_load_dwordx4 a[228:231], v3, s[80:81] offset:3072 sc1
s_add_u32 s80, s80, 8192
s_addc_u32 s81, s81, 0
v_add_f32 v177, v177, v189
v_add_f32 v178, v178, v190
v_mfma_f32_16x16x32_bf16 v[48:51], a[232:235], a[132:135], v[48:51]
v_add_f32 v179, v179, v191
v_fma_f32 v220, v245, v176, v200
v_fma_f32 v221, v245, v177, v201
v_mfma_f32_16x16x32_bf16 v[52:55], a[232:235], a[136:139], v[52:55]
v_fma_f32 v222, v245, v178, v202
v_fma_f32 v223, v245, v179, v203
v_fma_f32 v112, v244, v112, v220
v_mfma_f32_16x16x32_bf16 v[56:59], a[232:235], a[140:143], v[56:59]
v_fma_f32 v113, v244, v113, v221
v_fma_f32 v114, v244, v114, v222
v_fma_f32 v115, v244, v115, v223
v_mfma_f32_16x16x32_bf16 v[60:63], a[232:235], v[164:167], v[60:63]
global_load_dwordx4 a[232:235], v3, s[80:81] offset:-4096 sc1
v_exp_f32 v220, v112
v_mfma_f32_16x16x32_bf16 v[64:67], a[236:239], a[132:135], v[64:67]
v_exp_f32 v221, v113
v_mfma_f32_16x16x32_bf16 v[68:71], a[236:239], a[136:139], v[68:71]
v_exp_f32 v222, v114
v_mfma_f32_16x16x32_bf16 v[72:75], a[236:239], a[140:143], v[72:75]
s_waitcnt vmcnt(14) lgkmcnt(0)
v_exp_f32 v223, v115
v_fma_f32 v224, v220, 0.5, 1.0
v_mfma_f32_16x16x32_bf16 v[76:79], a[236:239], v[164:167], v[76:79]
global_load_dwordx4 a[236:239], v3, s[80:81] offset:-3072 sc1
v_fma_f32 v225, v221, 0.5, 1.0
v_fma_f32 v226, v222, 0.5, 1.0
v_mfma_f32_16x16x32_bf16 v[32:35], a[240:243], a[144:147], v[32:35]
ds_read_b64_tr_b16 v[164:165], v11 offset:53248
ds_read_b64_tr_b16 v[166:167], v11 offset:53760
v_fma_f32 v227, v223, 0.5, 1.0
v_mfma_f32_16x16x32_bf16 v[36:39], a[240:243], a[148:151], v[36:39]
v_fma_f32 v224, v220, v224, 1.0
v_fma_f32 v225, v221, v225, 1.0
v_fma_f32 v226, v222, v226, 1.0
v_mfma_f32_16x16x32_bf16 v[40:43], a[240:243], a[152:155], v[40:43]
v_fma_f32 v227, v223, v227, 1.0
v_rcp_f32 v224, v224
v_mfma_f32_16x16x32_bf16 v[44:47], a[240:243], v[160:163], v[44:47]
global_load_dwordx4 a[240:243], v3, s[80:81] offset:-2048 sc1
v_rcp_f32 v225, v225
v_mfma_f32_16x16x32_bf16 v[48:51], a[244:247], a[144:147], v[48:51]
v_rcp_f32 v226, v226
v_mfma_f32_16x16x32_bf16 v[52:55], a[244:247], a[148:151], v[52:55]
v_rcp_f32 v227, v227
v_mfma_f32_16x16x32_bf16 v[56:59], a[244:247], a[152:155], v[56:59]
v_fma_f32 v112, -v112, v224, v112
v_fma_f32 v113, -v113, v225, v113
v_fma_f32 v114, -v114, v226, v114
v_mfma_f32_16x16x32_bf16 v[60:63], a[244:247], v[160:163], v[60:63]
global_load_dwordx4 a[244:247], v3, s[80:81] offset:-1024 sc1
v_fma_f32 v115, -v115, v227, v115
v_cvt_pk_bf16_f32 v230, v112, v113
v_mfma_f32_16x16x32_bf16 v[64:67], a[248:251], a[144:147], v[64:67]
v_cvt_pk_bf16_f32 v231, v114, v115
ds_write_b128 v20, v[228:231] offset:8192
v_mfma_f32_16x16x32_bf16 v[68:71], a[248:251], a[148:151], v[68:71]
v_fma_f32 v204, v247, v176, v200
v_fma_f32 v205, v247, v177, v201
v_mfma_f32_16x16x32_bf16 v[72:75], a[248:251], a[152:155], v[72:75]
s_waitcnt vmcnt(14) lgkmcnt(1)
v_fma_f32 v206, v247, v178, v202
v_fma_f32 v207, v247, v179, v203
v_fma_f32 v116, v246, v116, v204
v_mfma_f32_16x16x32_bf16 v[76:79], a[248:251], v[160:163], v[76:79]
global_load_dwordx4 a[248:251], v3, s[80:81] offset:0 sc1
v_fma_f32 v117, v246, v117, v205
v_fma_f32 v118, v246, v118, v206
v_mfma_f32_16x16x32_bf16 v[32:35], a[252:255], a[156:159], v[32:35]
ds_read_b64_tr_b16 v[160:161], v11 offset:57344
ds_read_b64_tr_b16 v[162:163], v11 offset:57856
v_fma_f32 v119, v246, v119, v207
v_mfma_f32_16x16x32_bf16 v[36:39], a[252:255], a[160:163], v[36:39]
v_exp_f32 v204, v116
v_mfma_f32_16x16x32_bf16 v[40:43], a[252:255], a[164:167], v[40:43]
v_exp_f32 v205, v117
v_mfma_f32_16x16x32_bf16 v[44:47], a[252:255], v[164:167], v[44:47]
global_load_dwordx4 a[252:255], v3, s[80:81] offset:1024 sc1
v_exp_f32 v206, v118
v_mfma_f32_16x16x32_bf16 v[48:51], v[128:131], a[156:159], v[48:51]
v_exp_f32 v207, v119
v_fma_f32 v208, v204, 0.5, 1.0
v_mfma_f32_16x16x32_bf16 v[52:55], v[128:131], a[160:163], v[52:55]
v_fma_f32 v209, v205, 0.5, 1.0
v_fma_f32 v210, v206, 0.5, 1.0
v_fma_f32 v211, v207, 0.5, 1.0
v_mfma_f32_16x16x32_bf16 v[56:59], v[128:131], a[164:167], v[56:59]
v_fma_f32 v208, v204, v208, 1.0
v_fma_f32 v209, v205, v209, 1.0
v_fma_f32 v210, v206, v210, 1.0
v_mfma_f32_16x16x32_bf16 v[60:63], v[128:131], v[164:167], v[60:63]
global_load_dwordx4 v[128:131], v3, s[80:81] offset:2048 sc1
v_fma_f32 v211, v207, v211, 1.0
v_mfma_f32_16x16x32_bf16 v[64:67], v[132:135], a[156:159], v[64:67]
v_rcp_f32 v208, v208
v_mfma_f32_16x16x32_bf16 v[68:71], v[132:135], a[160:163], v[68:71]
v_rcp_f32 v209, v209
v_mfma_f32_16x16x32_bf16 v[72:75], v[132:135], a[164:167], v[72:75]
s_waitcnt vmcnt(14) lgkmcnt(0)
v_rcp_f32 v210, v210
v_mfma_f32_16x16x32_bf16 v[76:79], v[132:135], v[164:167], v[76:79]
global_load_dwordx4 v[132:135], v3, s[80:81] offset:3072 sc1
s_add_u32 s80, s80, 8192
s_addc_u32 s81, s81, 0
v_rcp_f32 v211, v211
v_mfma_f32_16x16x32_bf16 v[32:35], v[136:139], a[168:171], v[32:35]
ds_read_b64_tr_b16 v[164:165], v11 offset:61440
ds_read_b64_tr_b16 v[166:167], v11 offset:61952
v_fma_f32 v116, -v116, v208, v116
v_mfma_f32_16x16x32_bf16 v[36:39], v[136:139], a[172:175], v[36:39]
v_fma_f32 v117, -v117, v209, v117
v_fma_f32 v118, -v118, v210, v118
v_fma_f32 v119, -v119, v211, v119
v_mfma_f32_16x16x32_bf16 v[40:43], v[136:139], a[176:179], v[40:43]
v_cvt_pk_bf16_f32 v234, v116, v117
v_cvt_pk_bf16_f32 v235, v118, v119
v_mfma_f32_16x16x32_bf16 v[44:47], v[136:139], v[160:163], v[44:47]
global_load_dwordx4 v[136:139], v3, s[80:81] offset:-4096 sc1
ds_write_b128 v21, v[232:235] offset:8192
v_mfma_f32_16x16x32_bf16 v[48:51], v[140:143], a[168:171], v[48:51]
v_fma_f32 v212, v249, v176, v200
v_fma_f32 v213, v249, v177, v201
v_fma_f32 v214, v249, v178, v202
v_mfma_f32_16x16x32_bf16 v[52:55], v[140:143], a[172:175], v[52:55]
v_fma_f32 v215, v249, v179, v203
v_fma_f32 v120, v248, v120, v212
v_fma_f32 v121, v248, v121, v213
v_mfma_f32_16x16x32_bf16 v[56:59], v[140:143], a[176:179], v[56:59]
v_fma_f32 v122, v248, v122, v214
v_fma_f32 v123, v248, v123, v215
v_mfma_f32_16x16x32_bf16 v[60:63], v[140:143], v[160:163], v[60:63]
global_load_dwordx4 v[140:143], v3, s[80:81] offset:-3072 sc1
v_exp_f32 v212, v120
v_mfma_f32_16x16x32_bf16 v[64:67], v[144:147], a[168:171], v[64:67]
v_exp_f32 v213, v121
v_mfma_f32_16x16x32_bf16 v[68:71], v[144:147], a[172:175], v[68:71]
v_exp_f32 v214, v122
v_mfma_f32_16x16x32_bf16 v[72:75], v[144:147], a[176:179], v[72:75]
s_waitcnt vmcnt(14) lgkmcnt(1)
v_exp_f32 v215, v123
v_fma_f32 v216, v212, 0.5, 1.0
v_mfma_f32_16x16x32_bf16 v[76:79], v[144:147], v[160:163], v[76:79]
global_load_dwordx4 v[144:147], v3, s[80:81] offset:-2048 sc1
v_fma_f32 v217, v213, 0.5, 1.0
v_fma_f32 v218, v214, 0.5, 1.0
v_mfma_f32_16x16x32_bf16 v[32:35], v[148:151], a[180:183], v[32:35]
ds_read_b64_tr_b16 v[160:161], v15 offset:0
ds_read_b64_tr_b16 v[162:163], v15 offset:512
v_fma_f32 v219, v215, 0.5, 1.0
v_mfma_f32_16x16x32_bf16 v[36:39], v[148:151], a[184:187], v[36:39]
v_fma_f32 v216, v212, v216, 1.0
v_fma_f32 v217, v213, v217, 1.0
v_fma_f32 v218, v214, v218, 1.0
v_mfma_f32_16x16x32_bf16 v[40:43], v[148:151], a[188:191], v[40:43]
v_fma_f32 v219, v215, v219, 1.0
v_rcp_f32 v216, v216
v_mfma_f32_16x16x32_bf16 v[44:47], v[148:151], v[164:167], v[44:47]
global_load_dwordx4 v[148:151], v3, s[80:81] offset:-1024 sc1
v_rcp_f32 v217, v217
v_mfma_f32_16x16x32_bf16 v[48:51], v[152:155], a[180:183], v[48:51]
v_rcp_f32 v218, v218
v_mfma_f32_16x16x32_bf16 v[52:55], v[152:155], a[184:187], v[52:55]
v_rcp_f32 v219, v219
v_fma_f32 v120, -v120, v216, v120
v_mfma_f32_16x16x32_bf16 v[56:59], v[152:155], a[188:191], v[56:59]
v_fma_f32 v121, -v121, v217, v121
v_fma_f32 v122, -v122, v218, v122
v_fma_f32 v123, -v123, v219, v123
v_mfma_f32_16x16x32_bf16 v[60:63], v[152:155], v[164:167], v[60:63]
global_load_dwordx4 v[152:155], v3, s[80:81] offset:0 sc1
v_cvt_pk_bf16_f32 v238, v120, v121
v_cvt_pk_bf16_f32 v239, v122, v123
v_mfma_f32_16x16x32_bf16 v[64:67], v[156:159], a[180:183], v[64:67]
ds_write_b128 v22, v[236:239] offset:8192
v_fma_f32 v220, v251, v176, v200
v_mfma_f32_16x16x32_bf16 v[68:71], v[156:159], a[184:187], v[68:71]
v_fma_f32 v221, v251, v177, v201
v_fma_f32 v222, v251, v178, v202
v_fma_f32 v223, v251, v179, v203
v_mfma_f32_16x16x32_bf16 v[72:75], v[156:159], a[188:191], v[72:75]
s_waitcnt vmcnt(14) lgkmcnt(1)
ds_read_b128 v[176:179], v4 offset:512
ds_read_b128 v[188:191], v4 offset:3584
ds_read_b128 v[200:203], v4 offset:6656
v_mfma_f32_16x16x32_bf16 v[76:79], v[156:159], v[164:167], v[76:79]
global_load_dwordx4 v[156:159], v3, s[80:81] offset:1024 sc1
v_fma_f32 v124, v250, v124, v220
v_fma_f32 v125, v250, v125, v221
v_mfma_f32_16x16x32_bf16 v[32:35], a[216:219], a[192:195], v[32:35]
ds_read_b64_tr_b16 v[164:165], v15 offset:4096
ds_read_b64_tr_b16 v[166:167], v15 offset:4608
v_fma_f32 v126, v250, v126, v222
v_mfma_f32_16x16x32_bf16 v[36:39], a[216:219], a[196:199], v[36:39]
v_fma_f32 v127, v250, v127, v223
v_exp_f32 v220, v124
v_mfma_f32_16x16x32_bf16 v[40:43], a[216:219], a[200:203], v[40:43]
v_exp_f32 v221, v125
v_exp_f32 v222, v126
v_mfma_f32_16x16x32_bf16 v[44:47], a[216:219], v[160:163], v[44:47]
global_load_dwordx4 a[216:219], v3, s[80:81] offset:2048 sc1
v_exp_f32 v223, v127
v_fma_f32 v224, v220, 0.5, 1.0
v_mfma_f32_16x16x32_bf16 v[48:51], a[220:223], a[192:195], v[48:51]
v_fma_f32 v225, v221, 0.5, 1.0
v_fma_f32 v226, v222, 0.5, 1.0
v_fma_f32 v227, v223, 0.5, 1.0
v_mfma_f32_16x16x32_bf16 v[52:55], a[220:223], a[196:199], v[52:55]
v_fma_f32 v224, v220, v224, 1.0
v_fma_f32 v225, v221, v225, 1.0
v_fma_f32 v226, v222, v226, 1.0
v_mfma_f32_16x16x32_bf16 v[56:59], a[220:223], a[200:203], v[56:59]
v_fma_f32 v227, v223, v227, 1.0
v_rcp_f32 v224, v224
v_mfma_f32_16x16x32_bf16 v[60:63], a[220:223], v[160:163], v[60:63]
global_load_dwordx4 a[220:223], v3, s[80:81] offset:3072 sc1
s_add_u32 s80, s80, 8192
s_addc_u32 s81, s81, 0
v_rcp_f32 v225, v225
v_mfma_f32_16x16x32_bf16 v[64:67], a[224:227], a[192:195], v[64:67]
v_rcp_f32 v226, v226
v_rcp_f32 v227, v227
v_mfma_f32_16x16x32_bf16 v[68:71], a[224:227], a[196:199], v[68:71]
v_fma_f32 v124, -v124, v224, v124
v_fma_f32 v125, -v125, v225, v125
v_fma_f32 v126, -v126, v226, v126
v_mfma_f32_16x16x32_bf16 v[72:75], a[224:227], a[200:203], v[72:75]
s_waitcnt vmcnt(14) lgkmcnt(0)
v_fma_f32 v127, -v127, v227, v127
v_cvt_pk_bf16_f32 v242, v124, v125
v_cvt_pk_bf16_f32 v243, v126, v127
v_mfma_f32_16x16x32_bf16 v[76:79], a[224:227], v[160:163], v[76:79]
global_load_dwordx4 a[224:227], v3, s[80:81] offset:-4096 sc1
ds_write_b128 v23, v[240:243] offset:8192
v_mfma_f32_16x16x32_bf16 v[32:35], a[228:231], a[204:207], v[32:35]
s_waitcnt lgkmcnt(0)
s_barrier
v_mfma_f32_16x16x32_bf16 v[36:39], a[228:231], a[208:211], v[36:39]
ds_read_b128 v[160:163], v19 offset:0
ds_read_b128 a[0:3], v16 offset:0
v_mfma_f32_16x16x32_bf16 v[40:43], a[228:231], a[212:215], v[40:43]
ds_read_b128 a[4:7], v17 offset:0
ds_read_b128 a[8:11], v18 offset:0
v_mfma_f32_16x16x32_bf16 v[44:47], a[228:231], v[164:167], v[44:47]
global_load_dwordx4 a[228:231], v3, s[80:81] offset:-3072 sc1
v_mfma_f32_16x16x32_bf16 v[48:51], a[232:235], a[204:207], v[48:51]
v_mfma_f32_16x16x32_bf16 v[52:55], a[232:235], a[208:211], v[52:55]
v_mfma_f32_16x16x32_bf16 v[56:59], a[232:235], a[212:215], v[56:59]
v_mfma_f32_16x16x32_bf16 v[60:63], a[232:235], v[164:167], v[60:63]
global_load_dwordx4 a[232:235], v3, s[80:81] offset:-2048 sc1
v_mfma_f32_16x16x32_bf16 v[64:67], a[236:239], a[204:207], v[64:67]
v_mfma_f32_16x16x32_bf16 v[68:71], a[236:239], a[208:211], v[68:71]
v_mfma_f32_16x16x32_bf16 v[72:75], a[236:239], a[212:215], v[72:75]
s_waitcnt vmcnt(14) lgkmcnt(0)
v_mfma_f32_16x16x32_bf16 v[76:79], a[236:239], v[164:167], v[76:79]
global_load_dwordx4 a[236:239], v3, s[80:81] offset:-1024 sc1
v_mfma_f32_16x16x32_bf16 a[144:147], a[240:243], a[0:3], 0
ds_read_b128 v[164:167], v19 offset:1024
ds_read_b128 a[12:15], v16 offset:1024
s_waitcnt lgkmcnt(15)
v_add_f32 v168, v168, v180
v_mfma_f32_16x16x32_bf16 a[148:151], a[240:243], a[4:7], 0
ds_read_b128 a[16:19], v17 offset:1024
ds_read_b128 a[20:23], v18 offset:1024
v_add_f32 v169, v169, v181
v_mfma_f32_16x16x32_bf16 a[152:155], a[240:243], a[8:11], 0
v_add_f32 v170, v170, v182
v_add_f32 v171, v171, v183
v_fma_f32 v204, v245, v168, v192
v_mfma_f32_16x16x32_bf16 a[156:159], a[240:243], v[160:163], 0
global_load_dwordx4 a[240:243], v3, s[80:81] offset:0 sc1
v_fma_f32 v205, v245, v169, v193
v_mfma_f32_16x16x32_bf16 a[160:163], a[244:247], a[0:3], 0
v_fma_f32 v206, v245, v170, v194
v_fma_f32 v207, v245, v171, v195
v_mfma_f32_16x16x32_bf16 a[164:167], a[244:247], a[4:7], 0
v_fma_f32 v32, v244, v32, v204
v_fma_f32 v33, v244, v33, v205
v_mfma_f32_16x16x32_bf16 a[168:171], a[244:247], a[8:11], 0
v_fma_f32 v34, v244, v34, v206
v_fma_f32 v35, v244, v35, v207
v_mfma_f32_16x16x32_bf16 a[172:175], a[244:247], v[160:163], 0
global_load_dwordx4 a[244:247], v3, s[80:81] offset:1024 sc1
v_exp_f32 v204, v32
v_mfma_f32_16x16x32_bf16 a[176:179], a[248:251], a[0:3], 0
v_exp_f32 v205, v33
v_mfma_f32_16x16x32_bf16 a[180:183], a[248:251], a[4:7], 0
v_exp_f32 v206, v34
v_mfma_f32_16x16x32_bf16 a[184:187], a[248:251], a[8:11], 0
s_waitcnt vmcnt(14) lgkmcnt(0)
v_exp_f32 v207, v35
v_mfma_f32_16x16x32_bf16 a[188:191], a[248:251], v[160:163], 0
global_load_dwordx4 a[248:251], v3, s[80:81] offset:2048 sc1
v_fma_f32 v208, v204, 0.5, 1.0
v_fma_f32 v209, v205, 0.5, 1.0
v_mfma_f32_16x16x32_bf16 a[144:147], a[252:255], a[12:15], a[144:147]
ds_read_b128 v[160:163], v19 offset:2048
ds_read_b128 a[24:27], v16 offset:2048
v_fma_f32 v210, v206, 0.5, 1.0
v_mfma_f32_16x16x32_bf16 a[148:151], a[252:255], a[16:19], a[148:151]
ds_read_b128 a[28:31], v17 offset:2048
ds_read_b128 a[32:35], v18 offset:2048
v_fma_f32 v211, v207, 0.5, 1.0
v_mfma_f32_16x16x32_bf16 a[152:155], a[252:255], a[20:23], a[152:155]
v_fma_f32 v208, v204, v208, 1.0
v_fma_f32 v209, v205, v209, 1.0
v_mfma_f32_16x16x32_bf16 a[156:159], a[252:255], v[164:167], a[156:159]
global_load_dwordx4 a[252:255], v3, s[80:81] offset:3072 sc1
s_add_u32 s80, s80, 8192
s_addc_u32 s81, s81, 0
v_fma_f32 v210, v206, v210, 1.0
v_fma_f32 v211, v207, v211, 1.0
v_mfma_f32_16x16x32_bf16 a[160:163], v[128:131], a[12:15], a[160:163]
v_rcp_f32 v208, v208
v_mfma_f32_16x16x32_bf16 a[164:167], v[128:131], a[16:19], a[164:167]
v_rcp_f32 v209, v209
v_mfma_f32_16x16x32_bf16 a[168:171], v[128:131], a[20:23], a[168:171]
v_rcp_f32 v210, v210
v_mfma_f32_16x16x32_bf16 a[172:175], v[128:131], v[164:167], a[172:175]
global_load_dwordx4 v[128:131], v3, s[80:81] offset:-4096 sc1
v_rcp_f32 v211, v211
v_mfma_f32_16x16x32_bf16 a[176:179], v[132:135], a[12:15], a[176:179]
v_fma_f32 v32, -v32, v208, v32
v_fma_f32 v33, -v33, v209, v33
v_mfma_f32_16x16x32_bf16 a[180:183], v[132:135], a[16:19], a[180:183]
v_fma_f32 v34, -v34, v210, v34
v_fma_f32 v35, -v35, v211, v35
v_mfma_f32_16x16x32_bf16 a[184:187], v[132:135], a[20:23], a[184:187]
s_waitcnt vmcnt(14) lgkmcnt(0)
v_cvt_pk_bf16_f32 v228, v32, v33
v_cvt_pk_bf16_f32 v229, v34, v35
v_mfma_f32_16x16x32_bf16 a[188:191], v[132:135], v[164:167], a[188:191]
global_load_dwordx4 v[132:135], v3, s[80:81] offset:-3072 sc1
v_fma_f32 v212, v247, v168, v192
v_mfma_f32_16x16x32_bf16 a[144:147], v[136:139], a[24:27], a[144:147]
ds_read_b128 v[164:167], v19 offset:3072
ds_read_b128 a[36:39], v16 offset:3072
v_fma_f32 v213, v247, v169, v193
v_mfma_f32_16x16x32_bf16 a[148:151], v[136:139], a[28:31], a[148:151]
ds_read_b128 a[40:43], v17 offset:3072
ds_read_b128 a[44:47], v18 offset:3072
v_fma_f32 v214, v247, v170, v194
v_mfma_f32_16x16x32_bf16 a[152:155], v[136:139], a[32:35], a[152:155]
v_fma_f32 v215, v247, v171, v195
v_fma_f32 v36, v246, v36, v212
v_mfma_f32_16x16x32_bf16 a[156:159], v[136:139], v[160:163], a[156:159]
global_load_dwordx4 v[136:139], v3, s[80:81] offset:-2048 sc1
v_fma_f32 v37, v246, v37, v213
v_mfma_f32_16x16x32_bf16 a[160:163], v[140:143], a[24:27], a[160:163]
v_fma_f32 v38, v246, v38, v214
v_fma_f32 v39, v246, v39, v215
v_mfma_f32_16x16x32_bf16 a[164:167], v[140:143], a[28:31], a[164:167]
v_exp_f32 v212, v36
v_mfma_f32_16x16x32_bf16 a[168:171], v[140:143], a[32:35], a[168:171]
v_exp_f32 v213, v37
v_mfma_f32_16x16x32_bf16 a[172:175], v[140:143], v[160:163], a[172:175]
global_load_dwordx4 v[140:143], v3, s[80:81] offset:-1024 sc1
v_exp_f32 v214, v38
v_mfma_f32_16x16x32_bf16 a[176:179], v[144:147], a[24:27], a[176:179]
v_exp_f32 v215, v39
v_mfma_f32_16x16x32_bf16 a[180:183], v[144:147], a[28:31], a[180:183]
v_fma_f32 v216, v212, 0.5, 1.0
v_fma_f32 v217, v213, 0.5, 1.0
v_mfma_f32_16x16x32_bf16 a[184:187], v[144:147], a[32:35], a[184:187]
s_waitcnt vmcnt(14) lgkmcnt(0)
v_fma_f32 v218, v214, 0.5, 1.0
v_fma_f32 v219, v215, 0.5, 1.0
v_mfma_f32_16x16x32_bf16 a[188:191], v[144:147], v[160:163], a[188:191]
global_load_dwordx4 v[144:147], v3, s[80:81] offset:0 sc1
v_fma_f32 v216, v212, v216, 1.0
v_fma_f32 v217, v213, v217, 1.0
v_mfma_f32_16x16x32_bf16 a[144:147], v[148:151], a[36:39], a[144:147]
ds_read_b128 v[160:163], v19 offset:4096
ds_read_b128 a[48:51], v16 offset:4096
v_fma_f32 v218, v214, v218, 1.0
v_mfma_f32_16x16x32_bf16 a[148:151], v[148:151], a[40:43], a[148:151]
ds_read_b128 a[52:55], v17 offset:4096
ds_read_b128 a[56:59], v18 offset:4096
v_fma_f32 v219, v215, v219, 1.0
v_mfma_f32_16x16x32_bf16 a[152:155], v[148:151], a[44:47], a[152:155]
v_rcp_f32 v216, v216
v_mfma_f32_16x16x32_bf16 a[156:159], v[148:151], v[164:167], a[156:159]
global_load_dwordx4 v[148:151], v3, s[80:81] offset:1024 sc1
v_rcp_f32 v217, v217
v_mfma_f32_16x16x32_bf16 a[160:163], v[152:155], a[36:39], a[160:163]
v_rcp_f32 v218, v218
v_mfma_f32_16x16x32_bf16 a[164:167], v[152:155], a[40:43], a[164:167]
v_rcp_f32 v219, v219
v_mfma_f32_16x16x32_bf16 a[168:171], v[152:155], a[44:47], a[168:171]
v_fma_f32 v36, -v36, v216, v36
v_fma_f32 v37, -v37, v217, v37
v_mfma_f32_16x16x32_bf16 a[172:175], v[152:155], v[164:167], a[172:175]
global_load_dwordx4 v[152:155], v3, s[80:81] offset:2048 sc1
v_fma_f32 v38, -v38, v218, v38
v_mfma_f32_16x16x32_bf16 a[176:179], v[156:159], a[36:39], a[176:179]
v_fma_f32 v39, -v39, v219, v39
v_cvt_pk_bf16_f32 v232, v36, v37
v_mfma_f32_16x16x32_bf16 a[180:183], v[156:159], a[40:43], a[180:183]
v_cvt_pk_bf16_f32 v233, v38, v39
v_fma_f32 v220, v249, v168, v192
v_mfma_f32_16x16x32_bf16 a[184:187], v[156:159], a[44:47], a[184:187]
s_waitcnt vmcnt(14) lgkmcnt(0)
v_fma_f32 v221, v249, v169, v193
v_fma_f32 v222, v249, v170, v194
v_mfma_f32_16x16x32_bf16 a[188:191], v[156:159], v[164:167], a[188:191]
global_load_dwordx4 v[156:159], v3, s[80:81] offset:3072 sc1
s_add_u32 s80, s80, 8192
s_addc_u32 s81, s81, 0
v_fma_f32 v223, v249, v171, v195
v_fma_f32 v40, v248, v40, v220
v_mfma_f32_16x16x32_bf16 a[144:147], a[216:219], a[48:51], a[144:147]
ds_read_b128 v[164:167], v19 offset:5120
ds_read_b128 a[60:63], v16 offset:5120
v_fma_f32 v41, v248, v41, v221
v_mfma_f32_16x16x32_bf16 a[148:151], a[216:219], a[52:55], a[148:151]
ds_read_b128 a[64:67], v17 offset:5120
ds_read_b128 a[68:71], v18 offset:5120
v_mfma_f32_16x16x32_bf16 a[152:155], a[216:219], a[56:59], a[152:155]
v_fma_f32 v42, v248, v42, v222
v_fma_f32 v43, v248, v43, v223
v_mfma_f32_16x16x32_bf16 a[156:159], a[216:219], v[160:163], a[156:159]
global_load_dwordx4 a[216:219], v3, s[80:81] offset:-4096 sc1
v_exp_f32 v220, v40
v_mfma_f32_16x16x32_bf16 a[160:163], a[220:223], a[48:51], a[160:163]
v_exp_f32 v221, v41
v_mfma_f32_16x16x32_bf16 a[164:167], a[220:223], a[52:55], a[164:167]
v_exp_f32 v222, v42
v_mfma_f32_16x16x32_bf16 a[168:171], a[220:223], a[56:59], a[168:171]
v_exp_f32 v223, v43
v_mfma_f32_16x16x32_bf16 a[172:175], a[220:223], v[160:163], a[172:175]
global_load_dwordx4 a[220:223], v3, s[80:81] offset:-3072 sc1
v_fma_f32 v224, v220, 0.5, 1.0
v_fma_f32 v225, v221, 0.5, 1.0
v_mfma_f32_16x16x32_bf16 a[176:179], a[224:227], a[48:51], a[176:179]
v_fma_f32 v226, v222, 0.5, 1.0
v_fma_f32 v227, v223, 0.5, 1.0
v_mfma_f32_16x16x32_bf16 a[180:183], a[224:227], a[52:55], a[180:183]
v_fma_f32 v224, v220, v224, 1.0
v_fma_f32 v225, v221, v225, 1.0
v_mfma_f32_16x16x32_bf16 a[184:187], a[224:227], a[56:59], a[184:187]
s_waitcnt vmcnt(14) lgkmcnt(0)
v_fma_f32 v226, v222, v226, 1.0
v_fma_f32 v227, v223, v227, 1.0
v_mfma_f32_16x16x32_bf16 a[188:191], a[224:227], v[160:163], a[188:191]
global_load_dwordx4 a[224:227], v3, s[80:81] offset:-2048 sc1
v_rcp_f32 v224, v224
v_mfma_f32_16x16x32_bf16 a[144:147], a[228:231], a[60:63], a[144:147]
ds_read_b128 v[160:163], v19 offset:6144
ds_read_b128 a[72:75], v16 offset:6144
v_mfma_f32_16x16x32_bf16 a[148:151], a[228:231], a[64:67], a[148:151]
ds_read_b128 a[76:79], v17 offset:6144
ds_read_b128 a[80:83], v18 offset:6144
v_mfma_f32_16x16x32_bf16 a[152:155], a[228:231], a[68:71], a[152:155]
v_rcp_f32 v225, v225
v_mfma_f32_16x16x32_bf16 a[156:159], a[228:231], v[164:167], a[156:159]
global_load_dwordx4 a[228:231], v3, s[80:81] offset:-1024 sc1
v_rcp_f32 v226, v226
v_mfma_f32_16x16x32_bf16 a[160:163], a[232:235], a[60:63], a[160:163]
v_rcp_f32 v227, v227
v_mfma_f32_16x16x32_bf16 a[164:167], a[232:235], a[64:67], a[164:167]
v_fma_f32 v40, -v40, v224, v40
v_fma_f32 v41, -v41, v225, v41
v_mfma_f32_16x16x32_bf16 a[168:171], a[232:235], a[68:71], a[168:171]
v_fma_f32 v42, -v42, v226, v42
v_fma_f32 v43, -v43, v227, v43
v_mfma_f32_16x16x32_bf16 a[172:175], a[232:235], v[164:167], a[172:175]
global_load_dwordx4 a[232:235], v3, s[80:81] offset:0 sc1
v_cvt_pk_bf16_f32 v236, v40, v41
v_mfma_f32_16x16x32_bf16 a[176:179], a[236:239], a[60:63], a[176:179]
v_cvt_pk_bf16_f32 v237, v42, v43
v_fma_f32 v204, v251, v168, v192
v_mfma_f32_16x16x32_bf16 a[180:183], a[236:239], a[64:67], a[180:183]
v_fma_f32 v205, v251, v169, v193
v_fma_f32 v206, v251, v170, v194
v_mfma_f32_16x16x32_bf16 a[184:187], a[236:239], a[68:71], a[184:187]
s_waitcnt vmcnt(14) lgkmcnt(0)
v_fma_f32 v207, v251, v171, v195
v_fma_f32 v44, v250, v44, v204
v_mfma_f32_16x16x32_bf16 a[188:191], a[236:239], v[164:167], a[188:191]
global_load_dwordx4 a[236:239], v3, s[80:81] offset:1024 sc1
v_fma_f32 v45, v250, v45, v205
v_mfma_f32_16x16x32_bf16 a[144:147], a[240:243], a[72:75], a[144:147]
ds_read_b128 v[164:167], v19 offset:7168
ds_read_b128 a[84:87], v16 offset:7168
v_mfma_f32_16x16x32_bf16 a[148:151], a[240:243], a[76:79], a[148:151]
ds_read_b128 a[88:91], v17 offset:7168
ds_read_b128 a[92:95], v18 offset:7168
v_mfma_f32_16x16x32_bf16 a[152:155], a[240:243], a[80:83], a[152:155]
v_fma_f32 v46, v250, v46, v206
v_fma_f32 v47, v250, v47, v207
v_mfma_f32_16x16x32_bf16 a[156:159], a[240:243], v[160:163], a[156:159]
global_load_dwordx4 a[240:243], v3, s[80:81] offset:2048 sc1
v_exp_f32 v204, v44
v_mfma_f32_16x16x32_bf16 a[160:163], a[244:247], a[72:75], a[160:163]
v_exp_f32 v205, v45
v_mfma_f32_16x16x32_bf16 a[164:167], a[244:247], a[76:79], a[164:167]
v_exp_f32 v206, v46
v_mfma_f32_16x16x32_bf16 a[168:171], a[244:247], a[80:83], a[168:171]
v_exp_f32 v207, v47
v_fma_f32 v208, v204, 0.5, 1.0
v_mfma_f32_16x16x32_bf16 a[172:175], a[244:247], v[160:163], a[172:175]
global_load_dwordx4 a[244:247], v3, s[80:81] offset:3072 sc1
s_add_u32 s80, s80, 8192
s_addc_u32 s81, s81, 0
v_fma_f32 v209, v205, 0.5, 1.0
v_mfma_f32_16x16x32_bf16 a[176:179], a[248:251], a[72:75], a[176:179]
v_fma_f32 v210, v206, 0.5, 1.0
v_fma_f32 v211, v207, 0.5, 1.0
v_mfma_f32_16x16x32_bf16 a[180:183], a[248:251], a[76:79], a[180:183]
v_fma_f32 v208, v204, v208, 1.0
v_fma_f32 v209, v205, v209, 1.0
v_mfma_f32_16x16x32_bf16 a[184:187], a[248:251], a[80:83], a[184:187]
s_waitcnt vmcnt(14) lgkmcnt(0)
v_fma_f32 v210, v206, v210, 1.0
v_fma_f32 v211, v207, v211, 1.0
v_mfma_f32_16x16x32_bf16 a[188:191], a[248:251], v[160:163], a[188:191]
global_load_dwordx4 a[248:251], v3, s[80:81] offset:-4096 sc1
v_rcp_f32 v208, v208
v_mfma_f32_16x16x32_bf16 a[144:147], a[252:255], a[84:87], a[144:147]
ds_read_b128 v[160:163], v19 offset:8192
ds_read_b128 a[96:99], v16 offset:8192
v_mfma_f32_16x16x32_bf16 a[148:151], a[252:255], a[88:91], a[148:151]
ds_read_b128 a[100:103], v17 offset:8192
ds_read_b128 a[104:107], v18 offset:8192
v_mfma_f32_16x16x32_bf16 a[152:155], a[252:255], a[92:95], a[152:155]
v_rcp_f32 v209, v209
v_mfma_f32_16x16x32_bf16 a[156:159], a[252:255], v[164:167], a[156:159]
global_load_dwordx4 a[252:255], v3, s[80:81] offset:-3072 sc1
v_rcp_f32 v210, v210
v_mfma_f32_16x16x32_bf16 a[160:163], v[128:131], a[84:87], a[160:163]
v_rcp_f32 v211, v211
v_fma_f32 v44, -v44, v208, v44
v_mfma_f32_16x16x32_bf16 a[164:167], v[128:131], a[88:91], a[164:167]
v_fma_f32 v45, -v45, v209, v45
v_fma_f32 v46, -v46, v210, v46
v_mfma_f32_16x16x32_bf16 a[168:171], v[128:131], a[92:95], a[168:171]
v_fma_f32 v47, -v47, v211, v47
v_cvt_pk_bf16_f32 v240, v44, v45
v_mfma_f32_16x16x32_bf16 a[172:175], v[128:131], v[164:167], a[172:175]
global_load_dwordx4 v[128:131], v3, s[80:81] offset:-2048 sc1
v_cvt_pk_bf16_f32 v241, v46, v47
v_mfma_f32_16x16x32_bf16 a[176:179], v[132:135], a[84:87], a[176:179]
s_waitcnt lgkmcnt(15)
v_add_f32 v172, v172, v184
v_add_f32 v173, v173, v185
v_mfma_f32_16x16x32_bf16 a[180:183], v[132:135], a[88:91], a[180:183]
v_add_f32 v174, v174, v186
v_add_f32 v175, v175, v187
v_mfma_f32_16x16x32_bf16 a[184:187], v[132:135], a[92:95], a[184:187]
s_waitcnt vmcnt(14) lgkmcnt(0)
v_fma_f32 v212, v245, v172, v196
v_fma_f32 v213, v245, v173, v197
v_mfma_f32_16x16x32_bf16 a[188:191], v[132:135], v[164:167], a[188:191]
global_load_dwordx4 v[132:135], v3, s[80:81] offset:-1024 sc1
v_fma_f32 v214, v245, v174, v198
v_mfma_f32_16x16x32_bf16 a[144:147], v[136:139], a[96:99], a[144:147]
ds_read_b128 v[164:167], v19 offset:9216
ds_read_b128 a[108:111], v16 offset:9216
v_mfma_f32_16x16x32_bf16 a[148:151], v[136:139], a[100:103], a[148:151]
ds_read_b128 a[112:115], v17 offset:9216
ds_read_b128 a[116:119], v18 offset:9216
v_mfma_f32_16x16x32_bf16 a[152:155], v[136:139], a[104:107], a[152:155]
v_fma_f32 v215, v245, v175, v199
v_fma_f32 v48, v244, v48, v212
v_mfma_f32_16x16x32_bf16 a[156:159], v[136:139], v[160:163], a[156:159]
global_load_dwordx4 v[136:139], v3, s[80:81] offset:0 sc1
v_fma_f32 v49, v244, v49, v213
v_mfma_f32_16x16x32_bf16 a[160:163], v[140:143], a[96:99], a[160:163]
v_fma_f32 v50, v244, v50, v214
v_fma_f32 v51, v244, v51, v215
v_mfma_f32_16x16x32_bf16 a[164:167], v[140:143], a[100:103], a[164:167]
v_exp_f32 v212, v48
v_mfma_f32_16x16x32_bf16 a[168:171], v[140:143], a[104:107], a[168:171]
v_exp_f32 v213, v49
v_mfma_f32_16x16x32_bf16 a[172:175], v[140:143], v[160:163], a[172:175]
global_load_dwordx4 v[140:143], v3, s[80:81] offset:1024 sc1
v_exp_f32 v214, v50
v_mfma_f32_16x16x32_bf16 a[176:179], v[144:147], a[96:99], a[176:179]
v_exp_f32 v215, v51
v_fma_f32 v216, v212, 0.5, 1.0
v_mfma_f32_16x16x32_bf16 a[180:183], v[144:147], a[100:103], a[180:183]
v_fma_f32 v217, v213, 0.5, 1.0
v_fma_f32 v218, v214, 0.5, 1.0
v_mfma_f32_16x16x32_bf16 a[184:187], v[144:147], a[104:107], a[184:187]
s_waitcnt vmcnt(14) lgkmcnt(0)
v_fma_f32 v219, v215, 0.5, 1.0
v_fma_f32 v216, v212, v216, 1.0
v_mfma_f32_16x16x32_bf16 a[188:191], v[144:147], v[160:163], a[188:191]
global_load_dwordx4 v[144:147], v3, s[80:81] offset:2048 sc1
v_fma_f32 v217, v213, v217, 1.0
v_mfma_f32_16x16x32_bf16 a[144:147], v[148:151], a[108:111], a[144:147]
ds_read_b128 v[160:163], v19 offset:10240
ds_read_b128 a[120:123], v16 offset:10240
v_mfma_f32_16x16x32_bf16 a[148:151], v[148:151], a[112:115], a[148:151]
ds_read_b128 a[124:127], v17 offset:10240
ds_read_b128 a[128:131], v18 offset:10240
v_mfma_f32_16x16x32_bf16 a[152:155], v[148:151], a[116:119], a[152:155]
v_fma_f32 v218, v214, v218, 1.0
v_fma_f32 v219, v215, v219, 1.0
v_mfma_f32_16x16x32_bf16 a[156:159], v[148:151], v[164:167], a[156:159]
global_load_dwordx4 v[148:151], v3, s[80:81] offset:3072 sc1
s_add_u32 s80, s80, 8192
s_addc_u32 s81, s81, 0
v_rcp_f32 v216, v216
v_mfma_f32_16x16x32_bf16 a[160:163], v[152:155], a[108:111], a[160:163]
v_rcp_f32 v217, v217
v_mfma_f32_16x16x32_bf16 a[164:167], v[152:155], a[112:115], a[164:167]
v_rcp_f32 v218, v218
v_mfma_f32_16x16x32_bf16 a[168:171], v[152:155], a[116:119], a[168:171]
v_rcp_f32 v219, v219
v_fma_f32 v48, -v48, v216, v48
v_mfma_f32_16x16x32_bf16 a[172:175], v[152:155], v[164:167], a[172:175]
global_load_dwordx4 v[152:155], v3, s[80:81] offset:-4096 sc1
v_fma_f32 v49, -v49, v217, v49
v_mfma_f32_16x16x32_bf16 a[176:179], v[156:159], a[108:111], a[176:179]
v_fma_f32 v50, -v50, v218, v50
v_fma_f32 v51, -v51, v219, v51
v_mfma_f32_16x16x32_bf16 a[180:183], v[156:159], a[112:115], a[180:183]
v_cvt_pk_bf16_f32 v230, v48, v49
v_cvt_pk_bf16_f32 v231, v50, v51
v_mfma_f32_16x16x32_bf16 a[184:187], v[156:159], a[116:119], a[184:187]
s_waitcnt vmcnt(14) lgkmcnt(0)
ds_write_b128 v20, v[228:231] offset:12288
v_mfma_f32_16x16x32_bf16 a[188:191], v[156:159], v[164:167], a[188:191]
global_load_dwordx4 v[156:159], v3, s[80:81] offset:-3072 sc1
v_fma_f32 v220, v247, v172, v196
v_mfma_f32_16x16x32_bf16 a[144:147], a[216:219], a[120:123], a[144:147]
ds_read_b128 v[164:167], v19 offset:11264
ds_read_b128 a[132:135], v16 offset:11264
v_mfma_f32_16x16x32_bf16 a[148:151], a[216:219], a[124:127], a[148:151]
ds_read_b128 a[136:139], v17 offset:11264
ds_read_b128 a[140:143], v18 offset:11264
v_mfma_f32_16x16x32_bf16 a[152:155], a[216:219], a[128:131], a[152:155]
v_fma_f32 v221, v247, v173, v197
v_fma_f32 v222, v247, v174, v198
v_mfma_f32_16x16x32_bf16 a[156:159], a[216:219], v[160:163], a[156:159]
global_load_dwordx4 a[216:219], v3, s[80:81] offset:-2048 sc1
v_fma_f32 v223, v247, v175, v199
v_mfma_f32_16x16x32_bf16 a[160:163], a[220:223], a[120:123], a[160:163]
v_fma_f32 v52, v246, v52, v220
v_fma_f32 v53, v246, v53, v221
v_mfma_f32_16x16x32_bf16 a[164:167], a[220:223], a[124:127], a[164:167]
v_fma_f32 v54, v246, v54, v222
v_fma_f32 v55, v246, v55, v223
v_mfma_f32_16x16x32_bf16 a[168:171], a[220:223], a[128:131], a[168:171]
v_exp_f32 v220, v52
v_mfma_f32_16x16x32_bf16 a[172:175], a[220:223], v[160:163], a[172:175]
global_load_dwordx4 a[220:223], v3, s[80:81] offset:-1024 sc1
v_exp_f32 v221, v53
v_mfma_f32_16x16x32_bf16 a[176:179], a[224:227], a[120:123], a[176:179]
v_exp_f32 v222, v54
v_mfma_f32_16x16x32_bf16 a[180:183], a[224:227], a[124:127], a[180:183]
v_exp_f32 v223, v55
v_mfma_f32_16x16x32_bf16 a[184:187], a[224:227], a[128:131], a[184:187]
s_waitcnt vmcnt(14) lgkmcnt(0)
v_fma_f32 v224, v220, 0.5, 1.0
v_fma_f32 v225, v221, 0.5, 1.0
v_mfma_f32_16x16x32_bf16 a[188:191], a[224:227], v[160:163], a[188:191]
global_load_dwordx4 a[224:227], v3, s[80:81] offset:0 sc1
v_fma_f32 v226, v222, 0.5, 1.0
v_mfma_f32_16x16x32_bf16 a[144:147], a[228:231], a[132:135], a[144:147]
ds_read_b128 v[160:163], v19 offset:0
v_fma_f32 v227, v223, 0.5, 1.0
v_mfma_f32_16x16x32_bf16 a[148:151], a[228:231], a[136:139], a[148:151]
v_fma_f32 v224, v220, v224, 1.0
v_fma_f32 v225, v221, v225, 1.0
v_mfma_f32_16x16x32_bf16 a[152:155], a[228:231], a[140:143], a[152:155]
v_fma_f32 v226, v222, v226, 1.0
v_fma_f32 v227, v223, v227, 1.0
v_mfma_f32_16x16x32_bf16 a[156:159], a[228:231], v[164:167], a[156:159]
global_load_dwordx4 a[228:231], v3, s[80:81] offset:1024 sc1
v_rcp_f32 v224, v224
v_mfma_f32_16x16x32_bf16 a[160:163], a[232:235], a[132:135], a[160:163]
v_rcp_f32 v225, v225
v_mfma_f32_16x16x32_bf16 a[164:167], a[232:235], a[136:139], a[164:167]
v_rcp_f32 v226, v226
v_mfma_f32_16x16x32_bf16 a[168:171], a[232:235], a[140:143], a[168:171]
v_rcp_f32 v227, v227
v_fma_f32 v52, -v52, v224, v52
v_mfma_f32_16x16x32_bf16 a[172:175], a[232:235], v[164:167], a[172:175]
global_load_dwordx4 a[232:235], v3, s[80:81] offset:2048 sc1
v_fma_f32 v53, -v53, v225, v53
v_mfma_f32_16x16x32_bf16 a[176:179], a[236:239], a[132:135], a[176:179]
v_fma_f32 v54, -v54, v226, v54
v_fma_f32 v55, -v55, v227, v55
v_mfma_f32_16x16x32_bf16 a[180:183], a[236:239], a[136:139], a[180:183]
v_cvt_pk_bf16_f32 v234, v52, v53
v_cvt_pk_bf16_f32 v235, v54, v55
v_mfma_f32_16x16x32_bf16 a[184:187], a[236:239], a[140:143], a[184:187]
s_waitcnt vmcnt(14) lgkmcnt(0)
ds_write_b128 v21, v[232:235] offset:12288
v_fma_f32 v204, v249, v172, v196
v_mfma_f32_16x16x32_bf16 a[188:191], a[236:239], v[164:167], a[188:191]
global_load_dwordx4 a[236:239], v3, s[80:81] offset:3072 sc1
s_add_u32 s80, s80, 8192
s_addc_u32 s81, s81, 0
v_fma_f32 v205, v249, v173, v197
v_mfma_f32_16x16x32_bf16 v[80:83], a[240:243], a[0:3], 0
ds_read_b128 v[164:167], v19 offset:1024
v_fma_f32 v206, v249, v174, v198
v_mfma_f32_16x16x32_bf16 v[84:87], a[240:243], a[4:7], 0
v_fma_f32 v207, v249, v175, v199
v_fma_f32 v56, v248, v56, v204
v_mfma_f32_16x16x32_bf16 v[88:91], a[240:243], a[8:11], 0
v_fma_f32 v57, v248, v57, v205
v_fma_f32 v58, v248, v58, v206
v_mfma_f32_16x16x32_bf16 v[92:95], a[240:243], v[160:163], 0
global_load_dwordx4 a[240:243], v3, s[80:81] offset:-4096 sc1
v_fma_f32 v59, v248, v59, v207
v_mfma_f32_16x16x32_bf16 v[96:99], a[244:247], a[0:3], 0
v_exp_f32 v204, v56
v_mfma_f32_16x16x32_bf16 v[100:103], a[244:247], a[4:7], 0
v_exp_f32 v205, v57
v_mfma_f32_16x16x32_bf16 v[104:107], a[244:247], a[8:11], 0
v_exp_f32 v206, v58
v_mfma_f32_16x16x32_bf16 v[108:111], a[244:247], v[160:163], 0
global_load_dwordx4 a[244:247], v3, s[80:81] offset:-3072 sc1
v_exp_f32 v207, v59
v_mfma_f32_16x16x32_bf16 v[112:115], a[248:251], a[0:3], 0
v_fma_f32 v208, v204, 0.5, 1.0
v_fma_f32 v209, v205, 0.5, 1.0
v_mfma_f32_16x16x32_bf16 v[116:119], a[248:251], a[4:7], 0
v_fma_f32 v210, v206, 0.5, 1.0
v_fma_f32 v211, v207, 0.5, 1.0
v_mfma_f32_16x16x32_bf16 v[120:123], a[248:251], a[8:11], 0
s_waitcnt vmcnt(14) lgkmcnt(0)
v_fma_f32 v208, v204, v208, 1.0
v_fma_f32 v209, v205, v209, 1.0
v_mfma_f32_16x16x32_bf16 v[124:127], a[248:251], v[160:163], 0
global_load_dwordx4 a[248:251], v3, s[80:81] offset:-2048 sc1
v_fma_f32 v210, v206, v210, 1.0
v_mfma_f32_16x16x32_bf16 v[80:83], a[252:255], a[12:15], v[80:83]
ds_read_b128 v[160:163], v19 offset:2048
v_fma_f32 v211, v207, v211, 1.0
v_mfma_f32_16x16x32_bf16 v[84:87], a[252:255], a[16:19], v[84:87]
v_rcp_f32 v208, v208
v_mfma_f32_16x16x32_bf16 v[88:91], a[252:255], a[20:23], v[88:91]
v_rcp_f32 v209, v209
v_mfma_f32_16x16x32_bf16 v[92:95], a[252:255], v[164:167], v[92:95]
global_load_dwordx4 a[252:255], v3, s[80:81] offset:-1024 sc1
v_rcp_f32 v210, v210
v_mfma_f32_16x16x32_bf16 v[96:99], v[128:131], a[12:15], v[96:99]
v_rcp_f32 v211, v211
v_fma_f32 v56, -v56, v208, v56
v_mfma_f32_16x16x32_bf16 v[100:103], v[128:131], a[16:19], v[100:103]
v_fma_f32 v57, -v57, v209, v57
v_fma_f32 v58, -v58, v210, v58
v_mfma_f32_16x16x32_bf16 v[104:107], v[128:131], a[20:23], v[104:107]
v_fma_f32 v59, -v59, v211, v59
v_cvt_pk_bf16_f32 v238, v56, v57
v_mfma_f32_16x16x32_bf16 v[108:111], v[128:131], v[164:167], v[108:111]
global_load_dwordx4 v[128:131], v3, s[80:81] offset:0 sc1
v_cvt_pk_bf16_f32 v239, v58, v59
v_mfma_f32_16x16x32_bf16 v[112:115], v[132:135], a[12:15], v[112:115]
ds_write_b128 v22, v[236:239] offset:12288
v_mfma_f32_16x16x32_bf16 v[116:119], v[132:135], a[16:19], v[116:119]
v_fma_f32 v212, v251, v172, v196
v_fma_f32 v213, v251, v173, v197
v_mfma_f32_16x16x32_bf16 v[120:123], v[132:135], a[20:23], v[120:123]
s_waitcnt vmcnt(14) lgkmcnt(1)
v_fma_f32 v214, v251, v174, v198
v_fma_f32 v215, v251, v175, v199
v_mfma_f32_16x16x32_bf16 v[124:127], v[132:135], v[164:167], v[124:127]
global_load_dwordx4 v[132:135], v3, s[80:81] offset:1024 sc1
v_fma_f32 v60, v250, v60, v212
v_mfma_f32_16x16x32_bf16 v[80:83], v[136:139], a[24:27], v[80:83]
ds_read_b128 v[164:167], v19 offset:3072
v_fma_f32 v61, v250, v61, v213
v_mfma_f32_16x16x32_bf16 v[84:87], v[136:139], a[28:31], v[84:87]
v_fma_f32 v62, v250, v62, v214
v_fma_f32 v63, v250, v63, v215
v_mfma_f32_16x16x32_bf16 v[88:91], v[136:139], a[32:35], v[88:91]
v_exp_f32 v212, v60
v_mfma_f32_16x16x32_bf16 v[92:95], v[136:139], v[160:163], v[92:95]
global_load_dwordx4 v[136:139], v3, s[80:81] offset:2048 sc1
v_exp_f32 v213, v61
v_mfma_f32_16x16x32_bf16 v[96:99], v[140:143], a[24:27], v[96:99]
v_exp_f32 v214, v62
v_mfma_f32_16x16x32_bf16 v[100:103], v[140:143], a[28:31], v[100:103]
v_exp_f32 v215, v63
v_fma_f32 v216, v212, 0.5, 1.0
v_mfma_f32_16x16x32_bf16 v[104:107], v[140:143], a[32:35], v[104:107]
v_fma_f32 v217, v213, 0.5, 1.0
v_fma_f32 v218, v214, 0.5, 1.0
v_mfma_f32_16x16x32_bf16 v[108:111], v[140:143], v[160:163], v[108:111]
global_load_dwordx4 v[140:143], v3, s[80:81] offset:3072 sc1
s_add_u32 s80, s80, 8192
s_addc_u32 s81, s81, 0
v_fma_f32 v219, v215, 0.5, 1.0
v_mfma_f32_16x16x32_bf16 v[112:115], v[144:147], a[24:27], v[112:115]
v_fma_f32 v216, v212, v216, 1.0
v_fma_f32 v217, v213, v217, 1.0
v_mfma_f32_16x16x32_bf16 v[116:119], v[144:147], a[28:31], v[116:119]
v_fma_f32 v218, v214, v218, 1.0
v_fma_f32 v219, v215, v219, 1.0
v_mfma_f32_16x16x32_bf16 v[120:123], v[144:147], a[32:35], v[120:123]
s_waitcnt vmcnt(14) lgkmcnt(0)
v_rcp_f32 v216, v216
v_mfma_f32_16x16x32_bf16 v[124:127], v[144:147], v[160:163], v[124:127]
global_load_dwordx4 v[144:147], v3, s[80:81] offset:-4096 sc1
v_rcp_f32 v217, v217
v_mfma_f32_16x16x32_bf16 v[80:83], v[148:151], a[36:39], v[80:83]
ds_read_b128 v[160:163], v19 offset:4096
v_rcp_f32 v218, v218
v_mfma_f32_16x16x32_bf16 v[84:87], v[148:151], a[40:43], v[84:87]
v_rcp_f32 v219, v219
v_fma_f32 v60, -v60, v216, v60
v_mfma_f32_16x16x32_bf16 v[88:91], v[148:151], a[44:47], v[88:91]
v_fma_f32 v61, -v61, v217, v61
v_fma_f32 v62, -v62, v218, v62
v_mfma_f32_16x16x32_bf16 v[92:95], v[148:151], v[164:167], v[92:95]
global_load_dwordx4 v[148:151], v3, s[80:81] offset:-3072 sc1
v_fma_f32 v63, -v63, v219, v63
v_mfma_f32_16x16x32_bf16 v[96:99], v[152:155], a[36:39], v[96:99]
v_cvt_pk_bf16_f32 v242, v60, v61
v_cvt_pk_bf16_f32 v243, v62, v63
v_mfma_f32_16x16x32_bf16 v[100:103], v[152:155], a[40:43], v[100:103]
ds_write_b128 v23, v[240:243] offset:12288
s_waitcnt lgkmcnt(15)
v_add_f32 v176, v176, v188
v_mfma_f32_16x16x32_bf16 v[104:107], v[152:155], a[44:47], v[104:107]
v_add_f32 v177, v177, v189
v_add_f32 v178, v178, v190
v_mfma_f32_16x16x32_bf16 v[108:111], v[152:155], v[164:167], v[108:111]
global_load_dwordx4 v[152:155], v3, s[80:81] offset:-2048 sc1
v_add_f32 v179, v179, v191
v_mfma_f32_16x16x32_bf16 v[112:115], v[156:159], a[36:39], v[112:115]
v_fma_f32 v220, v245, v176, v200
v_fma_f32 v221, v245, v177, v201
v_mfma_f32_16x16x32_bf16 v[116:119], v[156:159], a[40:43], v[116:119]
v_fma_f32 v222, v245, v178, v202
v_fma_f32 v223, v245, v179, v203
v_mfma_f32_16x16x32_bf16 v[120:123], v[156:159], a[44:47], v[120:123]
s_waitcnt vmcnt(14) lgkmcnt(1)
v_fma_f32 v64, v244, v64, v220
v_fma_f32 v65, v244, v65, v221
v_mfma_f32_16x16x32_bf16 v[124:127], v[156:159], v[164:167], v[124:127]
global_load_dwordx4 v[156:159], v3, s[80:81] offset:-1024 sc1
v_fma_f32 v66, v244, v66, v222
v_mfma_f32_16x16x32_bf16 v[80:83], a[216:219], a[48:51], v[80:83]
ds_read_b128 v[164:167], v19 offset:5120
v_fma_f32 v67, v244, v67, v223
v_mfma_f32_16x16x32_bf16 v[84:87], a[216:219], a[52:55], v[84:87]
v_exp_f32 v220, v64
v_mfma_f32_16x16x32_bf16 v[88:91], a[216:219], a[56:59], v[88:91]
v_exp_f32 v221, v65
v_mfma_f32_16x16x32_bf16 v[92:95], a[216:219], v[160:163], v[92:95]
global_load_dwordx4 a[216:219], v3, s[80:81] offset:0 sc1
v_exp_f32 v222, v66
v_mfma_f32_16x16x32_bf16 v[96:99], a[220:223], a[48:51], v[96:99]
v_exp_f32 v223, v67
v_fma_f32 v224, v220, 0.5, 1.0
v_mfma_f32_16x16x32_bf16 v[100:103], a[220:223], a[52:55], v[100:103]
v_fma_f32 v225, v221, 0.5, 1.0
v_fma_f32 v226, v222, 0.5, 1.0
v_mfma_f32_16x16x32_bf16 v[104:107], a[220:223], a[56:59], v[104:107]
v_fma_f32 v227, v223, 0.5, 1.0
v_fma_f32 v224, v220, v224, 1.0
v_mfma_f32_16x16x32_bf16 v[108:111], a[220:223], v[160:163], v[108:111]
global_load_dwordx4 a[220:223], v3, s[80:81] offset:1024 sc1
v_fma_f32 v225, v221, v225, 1.0
v_mfma_f32_16x16x32_bf16 v[112:115], a[224:227], a[48:51], v[112:115]
v_fma_f32 v226, v222, v226, 1.0
v_fma_f32 v227, v223, v227, 1.0
v_mfma_f32_16x16x32_bf16 v[116:119], a[224:227], a[52:55], v[116:119]
v_rcp_f32 v224, v224
v_mfma_f32_16x16x32_bf16 v[120:123], a[224:227], a[56:59], v[120:123]
s_waitcnt vmcnt(14) lgkmcnt(0)
v_rcp_f32 v225, v225
v_mfma_f32_16x16x32_bf16 v[124:127], a[224:227], v[160:163], v[124:127]
global_load_dwordx4 a[224:227], v3, s[80:81] offset:2048 sc1
v_rcp_f32 v226, v226
v_mfma_f32_16x16x32_bf16 v[80:83], a[228:231], a[60:63], v[80:83]
ds_read_b128 v[160:163], v19 offset:6144
v_rcp_f32 v227, v227
v_mfma_f32_16x16x32_bf16 v[84:87], a[228:231], a[64:67], v[84:87]
v_fma_f32 v64, -v64, v224, v64
v_fma_f32 v65, -v65, v225, v65
v_mfma_f32_16x16x32_bf16 v[88:91], a[228:231], a[68:71], v[88:91]
v_fma_f32 v66, -v66, v226, v66
v_fma_f32 v67, -v67, v227, v67
v_mfma_f32_16x16x32_bf16 v[92:95], a[228:231], v[164:167], v[92:95]
global_load_dwordx4 a[228:231], v3, s[80:81] offset:3072 sc1
s_add_u32 s80, s80, 8192
s_addc_u32 s81, s81, 0
v_cvt_pk_bf16_f32 v228, v64, v65
v_mfma_f32_16x16x32_bf16 v[96:99], a[232:235], a[60:63], v[96:99]
v_cvt_pk_bf16_f32 v229, v66, v67
v_add_u32 v20, s41, v20
v_mfma_f32_16x16x32_bf16 v[100:103], a[232:235], a[64:67], v[100:103]
ds_write_b64 v20, v[228:229]
v_fma_f32 v204, v247, v176, v200
v_mfma_f32_16x16x32_bf16 v[104:107], a[232:235], a[68:71], v[104:107]
v_fma_f32 v205, v247, v177, v201
v_fma_f32 v206, v247, v178, v202
v_mfma_f32_16x16x32_bf16 v[108:111], a[232:235], v[164:167], v[108:111]
global_load_dwordx4 a[232:235], v3, s[80:81] offset:-4096 sc1
v_fma_f32 v207, v247, v179, v203
v_mfma_f32_16x16x32_bf16 v[112:115], a[236:239], a[60:63], v[112:115]
v_fma_f32 v68, v246, v68, v204
v_fma_f32 v69, v246, v69, v205
v_mfma_f32_16x16x32_bf16 v[116:119], a[236:239], a[64:67], v[116:119]
v_fma_f32 v70, v246, v70, v206
v_fma_f32 v71, v246, v71, v207
v_mfma_f32_16x16x32_bf16 v[120:123], a[236:239], a[68:71], v[120:123]
s_waitcnt vmcnt(14) lgkmcnt(1)
v_exp_f32 v204, v68
v_mfma_f32_16x16x32_bf16 v[124:127], a[236:239], v[164:167], v[124:127]
global_load_dwordx4 a[236:239], v3, s[80:81] offset:-3072 sc1
v_exp_f32 v205, v69
v_mfma_f32_16x16x32_bf16 v[80:83], a[240:243], a[72:75], v[80:83]
ds_read_b128 v[164:167], v19 offset:7168
v_exp_f32 v206, v70
v_mfma_f32_16x16x32_bf16 v[84:87], a[240:243], a[76:79], v[84:87]
v_exp_f32 v207, v71
v_fma_f32 v208, v204, 0.5, 1.0
v_mfma_f32_16x16x32_bf16 v[88:91], a[240:243], a[80:83], v[88:91]
v_fma_f32 v209, v205, 0.5, 1.0
v_fma_f32 v210, v206, 0.5, 1.0
v_mfma_f32_16x16x32_bf16 v[92:95], a[240:243], v[160:163], v[92:95]
global_load_dwordx4 a[240:243], v3, s[80:81] offset:-2048 sc1
v_fma_f32 v211, v207, 0.5, 1.0
v_mfma_f32_16x16x32_bf16 v[96:99], a[244:247], a[72:75], v[96:99]
v_fma_f32 v208, v204, v208, 1.0
v_fma_f32 v209, v205, v209, 1.0
v_mfma_f32_16x16x32_bf16 v[100:103], a[244:247], a[76:79], v[100:103]
v_fma_f32 v210, v206, v210, 1.0
v_fma_f32 v211, v207, v211, 1.0
v_mfma_f32_16x16x32_bf16 v[104:107], a[244:247], a[80:83], v[104:107]
v_rcp_f32 v208, v208
v_mfma_f32_16x16x32_bf16 v[108:111], a[244:247], v[160:163], v[108:111]
global_load_dwordx4 a[244:247], v3, s[80:81] offset:-1024 sc1
v_rcp_f32 v209, v209
v_mfma_f32_16x16x32_bf16 v[112:115], a[248:251], a[72:75], v[112:115]
v_rcp_f32 v210, v210
v_mfma_f32_16x16x32_bf16 v[116:119], a[248:251], a[76:79], v[116:119]
v_rcp_f32 v211, v211
v_mfma_f32_16x16x32_bf16 v[120:123], a[248:251], a[80:83], v[120:123]
s_waitcnt vmcnt(14) lgkmcnt(0)
v_fma_f32 v68, -v68, v208, v68
v_fma_f32 v69, -v69, v209, v69
v_mfma_f32_16x16x32_bf16 v[124:127], a[248:251], v[160:163], v[124:127]
global_load_dwordx4 a[248:251], v3, s[80:81] offset:0 sc1
v_fma_f32 v70, -v70, v210, v70
v_mfma_f32_16x16x32_bf16 v[80:83], a[252:255], a[84:87], v[80:83]
ds_read_b128 v[160:163], v19 offset:8192
v_fma_f32 v71, -v71, v211, v71
v_mfma_f32_16x16x32_bf16 v[84:87], a[252:255], a[88:91], v[84:87]
v_cvt_pk_bf16_f32 v232, v68, v69
v_cvt_pk_bf16_f32 v233, v70, v71
v_mfma_f32_16x16x32_bf16 v[88:91], a[252:255], a[92:95], v[88:91]
v_add_u32 v21, s41, v21
ds_write_b64 v21, v[232:233]
v_mfma_f32_16x16x32_bf16 v[92:95], a[252:255], v[164:167], v[92:95]
global_load_dwordx4 a[252:255], v3, s[80:81] offset:1024 sc1
v_fma_f32 v212, v249, v176, v200
v_mfma_f32_16x16x32_bf16 v[96:99], v[128:131], a[84:87], v[96:99]
v_fma_f32 v213, v249, v177, v201
v_fma_f32 v214, v249, v178, v202
v_mfma_f32_16x16x32_bf16 v[100:103], v[128:131], a[88:91], v[100:103]
v_fma_f32 v215, v249, v179, v203
v_fma_f32 v72, v248, v72, v212
v_mfma_f32_16x16x32_bf16 v[104:107], v[128:131], a[92:95], v[104:107]
v_fma_f32 v73, v248, v73, v213
v_fma_f32 v74, v248, v74, v214
v_mfma_f32_16x16x32_bf16 v[108:111], v[128:131], v[164:167], v[108:111]
global_load_dwordx4 v[128:131], v3, s[80:81] offset:2048 sc1
v_fma_f32 v75, v248, v75, v215
v_mfma_f32_16x16x32_bf16 v[112:115], v[132:135], a[84:87], v[112:115]
v_exp_f32 v212, v72
v_mfma_f32_16x16x32_bf16 v[116:119], v[132:135], a[88:91], v[116:119]
v_exp_f32 v213, v73
v_mfma_f32_16x16x32_bf16 v[120:123], v[132:135], a[92:95], v[120:123]
s_waitcnt vmcnt(14) lgkmcnt(1)
v_exp_f32 v214, v74
v_mfma_f32_16x16x32_bf16 v[124:127], v[132:135], v[164:167], v[124:127]
global_load_dwordx4 v[132:135], v3, s[80:81] offset:3072 sc1
s_add_u32 s80, s80, 8192
s_addc_u32 s81, s81, 0
v_exp_f32 v215, v75
v_mfma_f32_16x16x32_bf16 v[80:83], v[136:139], a[96:99], v[80:83]
ds_read_b128 v[164:167], v19 offset:9216
v_fma_f32 v216, v212, 0.5, 1.0
v_mfma_f32_16x16x32_bf16 v[84:87], v[136:139], a[100:103], v[84:87]
v_fma_f32 v217, v213, 0.5, 1.0
v_fma_f32 v218, v214, 0.5, 1.0
v_mfma_f32_16x16x32_bf16 v[88:91], v[136:139], a[104:107], v[88:91]
v_fma_f32 v219, v215, 0.5, 1.0
v_fma_f32 v216, v212, v216, 1.0
v_mfma_f32_16x16x32_bf16 v[92:95], v[136:139], v[160:163], v[92:95]
global_load_dwordx4 v[136:139], v3, s[80:81] offset:-4096 sc1
v_fma_f32 v217, v213, v217, 1.0
v_mfma_f32_16x16x32_bf16 v[96:99], v[140:143], a[96:99], v[96:99]
v_fma_f32 v218, v214, v218, 1.0
v_fma_f32 v219, v215, v219, 1.0
v_mfma_f32_16x16x32_bf16 v[100:103], v[140:143], a[100:103], v[100:103]
v_rcp_f32 v216, v216
v_mfma_f32_16x16x32_bf16 v[104:107], v[140:143], a[104:107], v[104:107]
v_rcp_f32 v217, v217
v_mfma_f32_16x16x32_bf16 v[108:111], v[140:143], v[160:163], v[108:111]
global_load_dwordx4 v[140:143], v3, s[80:81] offset:-3072 sc1
v_rcp_f32 v218, v218
v_mfma_f32_16x16x32_bf16 v[112:115], v[144:147], a[96:99], v[112:115]
v_rcp_f32 v219, v219
v_mfma_f32_16x16x32_bf16 v[116:119], v[144:147], a[100:103], v[116:119]
v_fma_f32 v72, -v72, v216, v72
v_fma_f32 v73, -v73, v217, v73
v_mfma_f32_16x16x32_bf16 v[120:123], v[144:147], a[104:107], v[120:123]
s_waitcnt vmcnt(14) lgkmcnt(0)
v_fma_f32 v74, -v74, v218, v74
v_fma_f32 v75, -v75, v219, v75
v_mfma_f32_16x16x32_bf16 v[124:127], v[144:147], v[160:163], v[124:127]
global_load_dwordx4 v[144:147], v3, s[80:81] offset:-2048 sc1
v_cvt_pk_bf16_f32 v236, v72, v73
v_cvt_pk_bf16_f32 v237, v74, v75
v_mfma_f32_16x16x32_bf16 v[80:83], v[148:151], a[108:111], v[80:83]
ds_read_b128 v[160:163], v19 offset:10240
v_add_u32 v22, s41, v22
v_mfma_f32_16x16x32_bf16 v[84:87], v[148:151], a[112:115], v[84:87]
ds_write_b64 v22, v[236:237]
v_fma_f32 v220, v251, v176, v200
v_mfma_f32_16x16x32_bf16 v[88:91], v[148:151], a[116:119], v[88:91]
v_fma_f32 v221, v251, v177, v201
v_fma_f32 v222, v251, v178, v202
v_mfma_f32_16x16x32_bf16 v[92:95], v[148:151], v[164:167], v[92:95]
global_load_dwordx4 v[148:151], v3, s[80:81] offset:-1024 sc1
v_fma_f32 v223, v251, v179, v203
v_mfma_f32_16x16x32_bf16 v[96:99], v[152:155], a[108:111], v[96:99]
v_fma_f32 v76, v250, v76, v220
v_fma_f32 v77, v250, v77, v221
v_mfma_f32_16x16x32_bf16 v[100:103], v[152:155], a[112:115], v[100:103]
v_fma_f32 v78, v250, v78, v222
v_fma_f32 v79, v250, v79, v223
v_mfma_f32_16x16x32_bf16 v[104:107], v[152:155], a[116:119], v[104:107]
v_exp_f32 v220, v76
v_mfma_f32_16x16x32_bf16 v[108:111], v[152:155], v[164:167], v[108:111]
global_load_dwordx4 v[152:155], v3, s[80:81] offset:0 sc1
v_exp_f32 v221, v77
v_mfma_f32_16x16x32_bf16 v[112:115], v[156:159], a[108:111], v[112:115]
v_exp_f32 v222, v78
v_mfma_f32_16x16x32_bf16 v[116:119], v[156:159], a[112:115], v[116:119]
v_exp_f32 v223, v79
v_mfma_f32_16x16x32_bf16 v[120:123], v[156:159], a[116:119], v[120:123]
s_waitcnt vmcnt(14) lgkmcnt(1)
v_fma_f32 v224, v220, 0.5, 1.0
v_fma_f32 v225, v221, 0.5, 1.0
v_mfma_f32_16x16x32_bf16 v[124:127], v[156:159], v[164:167], v[124:127]
global_load_dwordx4 v[156:159], v3, s[80:81] offset:1024 sc1
v_fma_f32 v226, v222, 0.5, 1.0
v_mfma_f32_16x16x32_bf16 v[80:83], a[216:219], a[120:123], v[80:83]
ds_read_b128 v[164:167], v19 offset:11264
v_fma_f32 v227, v223, 0.5, 1.0
v_mfma_f32_16x16x32_bf16 v[84:87], a[216:219], a[124:127], v[84:87]
v_fma_f32 v224, v220, v224, 1.0
v_fma_f32 v225, v221, v225, 1.0
v_mfma_f32_16x16x32_bf16 v[88:91], a[216:219], a[128:131], v[88:91]
v_fma_f32 v226, v222, v226, 1.0
v_fma_f32 v227, v223, v227, 1.0
v_mfma_f32_16x16x32_bf16 v[92:95], a[216:219], v[160:163], v[92:95]
global_load_dwordx4 a[216:219], v3, s[80:81] offset:2048 sc1
v_rcp_f32 v224, v224
v_mfma_f32_16x16x32_bf16 v[96:99], a[220:223], a[120:123], v[96:99]
v_rcp_f32 v225, v225
v_mfma_f32_16x16x32_bf16 v[100:103], a[220:223], a[124:127], v[100:103]
v_rcp_f32 v226, v226
v_mfma_f32_16x16x32_bf16 v[104:107], a[220:223], a[128:131], v[104:107]
v_rcp_f32 v227, v227
v_mfma_f32_16x16x32_bf16 v[108:111], a[220:223], v[160:163], v[108:111]
global_load_dwordx4 a[220:223], v3, s[80:81] offset:3072 sc1
s_add_u32 s80, s80, 8192
s_addc_u32 s81, s81, 0
v_fma_f32 v76, -v76, v224, v76
v_mfma_f32_16x16x32_bf16 v[112:115], a[224:227], a[120:123], v[112:115]
v_fma_f32 v77, -v77, v225, v77
v_fma_f32 v78, -v78, v226, v78
v_mfma_f32_16x16x32_bf16 v[116:119], a[224:227], a[124:127], v[116:119]
v_fma_f32 v79, -v79, v227, v79
v_cvt_pk_bf16_f32 v240, v76, v77
v_mfma_f32_16x16x32_bf16 v[120:123], a[224:227], a[128:131], v[120:123]
s_waitcnt vmcnt(14) lgkmcnt(0)
v_cvt_pk_bf16_f32 v241, v78, v79
v_add_u32 v23, s41, v23
v_mfma_f32_16x16x32_bf16 v[124:127], a[224:227], v[160:163], v[124:127]
global_load_dwordx4 a[224:227], v3, s[80:81] offset:-4096 sc1
ds_write_b64 v23, v[240:241]
v_mfma_f32_16x16x32_bf16 v[80:83], a[228:231], a[132:135], v[80:83]
s_waitcnt lgkmcnt(0)
s_barrier
v_mfma_f32_16x16x32_bf16 v[84:87], a[228:231], a[136:139], v[84:87]
ds_read_b128 v[160:163], v19 offset:12288
ds_read_b128 a[192:195], v16 offset:12288
v_mfma_f32_16x16x32_bf16 v[88:91], a[228:231], a[140:143], v[88:91]
ds_read_b128 a[196:199], v17 offset:12288
ds_read_b128 a[200:203], v18 offset:12288
v_mfma_f32_16x16x32_bf16 v[92:95], a[228:231], v[164:167], v[92:95]
global_load_dwordx4 a[228:231], v3, s[80:81] offset:-3072 sc1
v_mfma_f32_16x16x32_bf16 v[96:99], a[232:235], a[132:135], v[96:99]
v_mfma_f32_16x16x32_bf16 v[100:103], a[232:235], a[136:139], v[100:103]
v_mfma_f32_16x16x32_bf16 v[104:107], a[232:235], a[140:143], v[104:107]
v_mfma_f32_16x16x32_bf16 v[108:111], a[232:235], v[164:167], v[108:111]
global_load_dwordx4 a[232:235], v3, s[80:81] offset:-2048 sc1
v_mfma_f32_16x16x32_bf16 v[112:115], a[236:239], a[132:135], v[112:115]
v_mfma_f32_16x16x32_bf16 v[116:119], a[236:239], a[136:139], v[116:119]
v_mfma_f32_16x16x32_bf16 v[120:123], a[236:239], a[140:143], v[120:123]
s_waitcnt vmcnt(14) lgkmcnt(0)
v_mfma_f32_16x16x32_bf16 v[124:127], a[236:239], v[164:167], v[124:127]
global_load_dwordx4 a[236:239], v3, s[80:81] offset:-1024 sc1
v_mfma_f32_16x16x32_bf16 a[144:147], a[240:243], a[192:195], a[144:147]
ds_read_b128 v[164:167], v19 offset:13312
ds_read_b128 a[204:207], v16 offset:13312
v_mfma_f32_16x16x32_bf16 a[148:151], a[240:243], a[196:199], a[148:151]
ds_read_b128 a[208:211], v17 offset:13312
ds_read_b128 a[212:215], v18 offset:13312
v_mfma_f32_16x16x32_bf16 a[152:155], a[240:243], a[200:203], a[152:155]
v_mfma_f32_16x16x32_bf16 a[156:159], a[240:243], v[160:163], a[156:159]
global_load_dwordx4 a[240:243], v3, s[80:81] offset:0 sc1
v_mfma_f32_16x16x32_bf16 a[160:163], a[244:247], a[192:195], a[160:163]
v_mfma_f32_16x16x32_bf16 a[164:167], a[244:247], a[196:199], a[164:167]
v_mfma_f32_16x16x32_bf16 a[168:171], a[244:247], a[200:203], a[168:171]
v_mfma_f32_16x16x32_bf16 a[172:175], a[244:247], v[160:163], a[172:175]
global_load_dwordx4 a[244:247], v3, s[80:81] offset:1024 sc1
v_mfma_f32_16x16x32_bf16 a[176:179], a[248:251], a[192:195], a[176:179]
v_mfma_f32_16x16x32_bf16 a[180:183], a[248:251], a[196:199], a[180:183]
v_mfma_f32_16x16x32_bf16 a[184:187], a[248:251], a[200:203], a[184:187]
s_waitcnt vmcnt(14) lgkmcnt(0)
v_mfma_f32_16x16x32_bf16 a[188:191], a[248:251], v[160:163], a[188:191]
global_load_dwordx4 a[248:251], v3, s[80:81] offset:2048 sc1
v_mfma_f32_16x16x32_bf16 a[144:147], a[252:255], a[204:207], a[144:147]
ds_read_b128 v[160:163], v19 offset:14336
ds_read_b128 a[192:195], v16 offset:14336
v_mfma_f32_16x16x32_bf16 a[148:151], a[252:255], a[208:211], a[148:151]
ds_read_b128 a[196:199], v17 offset:14336
ds_read_b128 a[200:203], v18 offset:14336
v_mfma_f32_16x16x32_bf16 a[152:155], a[252:255], a[212:215], a[152:155]
v_mfma_f32_16x16x32_bf16 a[156:159], a[252:255], v[164:167], a[156:159]
global_load_dwordx4 a[252:255], v3, s[80:81] offset:3072 sc1
s_add_u32 s80, s80, 8192
s_addc_u32 s81, s81, 0
v_mfma_f32_16x16x32_bf16 a[160:163], v[128:131], a[204:207], a[160:163]
v_mfma_f32_16x16x32_bf16 a[164:167], v[128:131], a[208:211], a[164:167]
v_mfma_f32_16x16x32_bf16 a[168:171], v[128:131], a[212:215], a[168:171]
v_mfma_f32_16x16x32_bf16 a[172:175], v[128:131], v[164:167], a[172:175]
global_load_dwordx4 v[128:131], v3, s[80:81] offset:-4096 sc1
v_mfma_f32_16x16x32_bf16 a[176:179], v[132:135], a[204:207], a[176:179]
v_mfma_f32_16x16x32_bf16 a[180:183], v[132:135], a[208:211], a[180:183]
v_mfma_f32_16x16x32_bf16 a[184:187], v[132:135], a[212:215], a[184:187]
s_waitcnt vmcnt(14) lgkmcnt(0)
v_mfma_f32_16x16x32_bf16 a[188:191], v[132:135], v[164:167], a[188:191]
global_load_dwordx4 v[132:135], v3, s[80:81] offset:-3072 sc1
v_mfma_f32_16x16x32_bf16 a[144:147], v[136:139], a[192:195], a[144:147]
ds_read_b128 v[164:167], v19 offset:15360
ds_read_b128 a[204:207], v16 offset:15360
v_mfma_f32_16x16x32_bf16 a[148:151], v[136:139], a[196:199], a[148:151]
ds_read_b128 a[208:211], v17 offset:15360
ds_read_b128 a[212:215], v18 offset:15360
v_mfma_f32_16x16x32_bf16 a[152:155], v[136:139], a[200:203], a[152:155]
v_mfma_f32_16x16x32_bf16 a[156:159], v[136:139], v[160:163], a[156:159]
global_load_dwordx4 v[136:139], v3, s[80:81] offset:-2048 sc1
v_mfma_f32_16x16x32_bf16 a[160:163], v[140:143], a[192:195], a[160:163]
v_mfma_f32_16x16x32_bf16 a[164:167], v[140:143], a[196:199], a[164:167]
v_mfma_f32_16x16x32_bf16 a[168:171], v[140:143], a[200:203], a[168:171]
v_mfma_f32_16x16x32_bf16 a[172:175], v[140:143], v[160:163], a[172:175]
global_load_dwordx4 v[140:143], v3, s[80:81] offset:-1024 sc1
v_mfma_f32_16x16x32_bf16 a[176:179], v[144:147], a[192:195], a[176:179]
v_mfma_f32_16x16x32_bf16 a[180:183], v[144:147], a[196:199], a[180:183]
v_mfma_f32_16x16x32_bf16 a[184:187], v[144:147], a[200:203], a[184:187]
s_waitcnt vmcnt(14) lgkmcnt(0)
v_mfma_f32_16x16x32_bf16 a[188:191], v[144:147], v[160:163], a[188:191]
global_load_dwordx4 v[144:147], v3, s[80:81] offset:0 sc1
v_mfma_f32_16x16x32_bf16 a[144:147], v[148:151], a[204:207], a[144:147]
ds_read_b128 v[160:163], v19 offset:16384
ds_read_b128 a[192:195], v16 offset:16384
v_mfma_f32_16x16x32_bf16 a[148:151], v[148:151], a[208:211], a[148:151]
ds_read_b128 a[196:199], v17 offset:16384
ds_read_b128 a[200:203], v18 offset:16384
v_mfma_f32_16x16x32_bf16 a[152:155], v[148:151], a[212:215], a[152:155]
v_mfma_f32_16x16x32_bf16 a[156:159], v[148:151], v[164:167], a[156:159]
global_load_dwordx4 v[148:151], v3, s[80:81] offset:1024 sc1
v_mfma_f32_16x16x32_bf16 a[160:163], v[152:155], a[204:207], a[160:163]
v_mfma_f32_16x16x32_bf16 a[164:167], v[152:155], a[208:211], a[164:167]
v_mfma_f32_16x16x32_bf16 a[168:171], v[152:155], a[212:215], a[168:171]
v_mfma_f32_16x16x32_bf16 a[172:175], v[152:155], v[164:167], a[172:175]
global_load_dwordx4 v[152:155], v3, s[80:81] offset:2048 sc1
v_mfma_f32_16x16x32_bf16 a[176:179], v[156:159], a[204:207], a[176:179]
v_mfma_f32_16x16x32_bf16 a[180:183], v[156:159], a[208:211], a[180:183]
v_mfma_f32_16x16x32_bf16 a[184:187], v[156:159], a[212:215], a[184:187]
s_waitcnt vmcnt(14) lgkmcnt(0)
v_mfma_f32_16x16x32_bf16 a[188:191], v[156:159], v[164:167], a[188:191]
global_load_dwordx4 v[156:159], v3, s[80:81] offset:3072 sc1
s_add_u32 s80, s80, 8192
s_addc_u32 s81, s81, 0
v_mfma_f32_16x16x32_bf16 a[144:147], a[216:219], a[192:195], a[144:147]
ds_read_b128 v[164:167], v19 offset:17408
ds_read_b128 a[204:207], v16 offset:17408
v_mfma_f32_16x16x32_bf16 a[148:151], a[216:219], a[196:199], a[148:151]
ds_read_b128 a[208:211], v17 offset:17408
ds_read_b128 a[212:215], v18 offset:17408
v_mfma_f32_16x16x32_bf16 a[152:155], a[216:219], a[200:203], a[152:155]
v_mfma_f32_16x16x32_bf16 a[156:159], a[216:219], v[160:163], a[156:159]
global_load_dwordx4 a[216:219], v3, s[80:81] offset:-4096 sc1
v_mfma_f32_16x16x32_bf16 a[160:163], a[220:223], a[192:195], a[160:163]
v_mfma_f32_16x16x32_bf16 a[164:167], a[220:223], a[196:199], a[164:167]
v_mfma_f32_16x16x32_bf16 a[168:171], a[220:223], a[200:203], a[168:171]
v_mfma_f32_16x16x32_bf16 a[172:175], a[220:223], v[160:163], a[172:175]
global_load_dwordx4 a[220:223], v3, s[80:81] offset:-3072 sc1
v_mfma_f32_16x16x32_bf16 a[176:179], a[224:227], a[192:195], a[176:179]
v_mfma_f32_16x16x32_bf16 a[180:183], a[224:227], a[196:199], a[180:183]
v_mfma_f32_16x16x32_bf16 a[184:187], a[224:227], a[200:203], a[184:187]
s_waitcnt vmcnt(14) lgkmcnt(0)
v_mfma_f32_16x16x32_bf16 a[188:191], a[224:227], v[160:163], a[188:191]
global_load_dwordx4 a[224:227], v3, s[80:81] offset:-2048 sc1
v_mfma_f32_16x16x32_bf16 a[144:147], a[228:231], a[204:207], a[144:147]
ds_read_b128 v[160:163], v19 offset:12288
ds_read_b128 a[192:195], v16 offset:12288
v_mfma_f32_16x16x32_bf16 a[148:151], a[228:231], a[208:211], a[148:151]
ds_read_b128 a[196:199], v17 offset:12288
ds_read_b128 a[200:203], v18 offset:12288
v_mfma_f32_16x16x32_bf16 a[152:155], a[228:231], a[212:215], a[152:155]
v_mfma_f32_16x16x32_bf16 a[156:159], a[228:231], v[164:167], a[156:159]
global_load_dwordx4 a[228:231], v3, s[80:81] offset:-1024 sc1
v_mfma_f32_16x16x32_bf16 a[160:163], a[232:235], a[204:207], a[160:163]
v_mfma_f32_16x16x32_bf16 a[164:167], a[232:235], a[208:211], a[164:167]
v_mfma_f32_16x16x32_bf16 a[168:171], a[232:235], a[212:215], a[168:171]
v_mfma_f32_16x16x32_bf16 a[172:175], a[232:235], v[164:167], a[172:175]
global_load_dwordx4 a[232:235], v3, s[80:81] offset:0 sc1
v_mfma_f32_16x16x32_bf16 a[176:179], a[236:239], a[204:207], a[176:179]
v_mfma_f32_16x16x32_bf16 a[180:183], a[236:239], a[208:211], a[180:183]
v_mfma_f32_16x16x32_bf16 a[184:187], a[236:239], a[212:215], a[184:187]
s_waitcnt vmcnt(14) lgkmcnt(0)
v_mfma_f32_16x16x32_bf16 a[188:191], a[236:239], v[164:167], a[188:191]
global_load_dwordx4 a[236:239], v3, s[80:81] offset:1024 sc1
v_mfma_f32_16x16x32_bf16 v[80:83], a[240:243], a[192:195], v[80:83]
ds_read_b128 v[164:167], v19 offset:13312
ds_read_b128 a[204:207], v16 offset:13312
v_mfma_f32_16x16x32_bf16 v[84:87], a[240:243], a[196:199], v[84:87]
ds_read_b128 a[208:211], v17 offset:13312
ds_read_b128 a[212:215], v18 offset:13312
v_mfma_f32_16x16x32_bf16 v[88:91], a[240:243], a[200:203], v[88:91]
v_accvgpr_read_b32 v204, a144
v_accvgpr_read_b32 v205, a145
v_mfma_f32_16x16x32_bf16 v[92:95], a[240:243], v[160:163], v[92:95]
global_load_dwordx4 a[240:243], v3, s[80:81] offset:2048 sc1
v_accvgpr_read_b32 v206, a146
v_mfma_f32_16x16x32_bf16 v[96:99], a[244:247], a[192:195], v[96:99]
v_accvgpr_read_b32 v207, a147
v_mfma_f32_16x16x32_bf16 v[100:103], a[244:247], a[196:199], v[100:103]
v_cvt_pk_bf16_f32 v228, v204, v205
v_mfma_f32_16x16x32_bf16 v[104:107], a[244:247], a[200:203], v[104:107]
v_cvt_pk_bf16_f32 v229, v206, v207
v_mfma_f32_16x16x32_bf16 v[108:111], a[244:247], v[160:163], v[108:111]
global_load_dwordx4 a[244:247], v3, s[80:81] offset:3072 sc1
s_add_u32 s80, s80, 8192
s_addc_u32 s81, s81, 0
v_accvgpr_read_b32 v208, a148
v_mfma_f32_16x16x32_bf16 v[112:115], a[248:251], a[192:195], v[112:115]
v_accvgpr_read_b32 v209, a149
v_mfma_f32_16x16x32_bf16 v[116:119], a[248:251], a[196:199], v[116:119]
v_accvgpr_read_b32 v210, a150
v_mfma_f32_16x16x32_bf16 v[120:123], a[248:251], a[200:203], v[120:123]
s_waitcnt vmcnt(14) lgkmcnt(0)
v_accvgpr_read_b32 v211, a151
v_cvt_pk_bf16_f32 v232, v208, v209
v_mfma_f32_16x16x32_bf16 v[124:127], a[248:251], v[160:163], v[124:127]
global_load_dwordx4 a[248:251], v3, s[80:81] offset:-4096 sc1
v_cvt_pk_bf16_f32 v233, v210, v211
v_mfma_f32_16x16x32_bf16 v[80:83], a[252:255], a[204:207], v[80:83]
ds_read_b128 v[160:163], v19 offset:14336
ds_read_b128 a[192:195], v16 offset:14336
v_mfma_f32_16x16x32_bf16 v[84:87], a[252:255], a[208:211], v[84:87]
ds_read_b128 a[196:199], v17 offset:14336
ds_read_b128 a[200:203], v18 offset:14336
v_mfma_f32_16x16x32_bf16 v[88:91], a[252:255], a[212:215], v[88:91]
v_accvgpr_read_b32 v212, a152
v_accvgpr_read_b32 v213, a153
v_mfma_f32_16x16x32_bf16 v[92:95], a[252:255], v[164:167], v[92:95]
global_load_dwordx4 a[252:255], v3, s[80:81] offset:-3072 sc1
v_accvgpr_read_b32 v214, a154
v_mfma_f32_16x16x32_bf16 v[96:99], v[128:131], a[204:207], v[96:99]
v_accvgpr_read_b32 v215, a155
v_mfma_f32_16x16x32_bf16 v[100:103], v[128:131], a[208:211], v[100:103]
v_cvt_pk_bf16_f32 v236, v212, v213
v_mfma_f32_16x16x32_bf16 v[104:107], v[128:131], a[212:215], v[104:107]
v_cvt_pk_bf16_f32 v237, v214, v215
v_mfma_f32_16x16x32_bf16 v[108:111], v[128:131], v[164:167], v[108:111]
global_load_dwordx4 v[128:131], v3, s[80:81] offset:-2048 sc1
v_accvgpr_read_b32 v216, a156
v_mfma_f32_16x16x32_bf16 v[112:115], v[132:135], a[204:207], v[112:115]
v_accvgpr_read_b32 v217, a157
v_mfma_f32_16x16x32_bf16 v[116:119], v[132:135], a[208:211], v[116:119]
v_accvgpr_read_b32 v218, a158
v_mfma_f32_16x16x32_bf16 v[120:123], v[132:135], a[212:215], v[120:123]
s_waitcnt vmcnt(14) lgkmcnt(0)
v_accvgpr_read_b32 v219, a159
v_cvt_pk_bf16_f32 v240, v216, v217
v_mfma_f32_16x16x32_bf16 v[124:127], v[132:135], v[164:167], v[124:127]
global_load_dwordx4 v[132:135], v3, s[80:81] offset:-1024 sc1
v_cvt_pk_bf16_f32 v241, v218, v219
v_mfma_f32_16x16x32_bf16 v[80:83], v[136:139], a[192:195], v[80:83]
ds_read_b128 v[164:167], v19 offset:15360
ds_read_b128 a[204:207], v16 offset:15360
v_mfma_f32_16x16x32_bf16 v[84:87], v[136:139], a[196:199], v[84:87]
ds_read_b128 a[208:211], v17 offset:15360
ds_read_b128 a[212:215], v18 offset:15360
v_mfma_f32_16x16x32_bf16 v[88:91], v[136:139], a[200:203], v[88:91]
v_accvgpr_read_b32 v204, a160
v_accvgpr_read_b32 v205, a161
v_mfma_f32_16x16x32_bf16 v[92:95], v[136:139], v[160:163], v[92:95]
global_load_dwordx4 v[136:139], v3, s[80:81] offset:0 sc1
v_accvgpr_read_b32 v206, a162
v_mfma_f32_16x16x32_bf16 v[96:99], v[140:143], a[192:195], v[96:99]
v_accvgpr_read_b32 v207, a163
v_mfma_f32_16x16x32_bf16 v[100:103], v[140:143], a[196:199], v[100:103]
v_cvt_pk_bf16_f32 v230, v204, v205
v_mfma_f32_16x16x32_bf16 v[104:107], v[140:143], a[200:203], v[104:107]
v_cvt_pk_bf16_f32 v231, v206, v207
v_mfma_f32_16x16x32_bf16 v[108:111], v[140:143], v[160:163], v[108:111]
global_load_dwordx4 v[140:143], v3, s[80:81] offset:1024 sc1
v_mfma_f32_16x16x32_bf16 v[112:115], v[144:147], a[192:195], v[112:115]
buffer_store_dwordx4 v[228:231], v3, s[44:47], s48 offen sc1
v_mfma_f32_16x16x32_bf16 v[116:119], v[144:147], a[196:199], v[116:119]
s_cmp_eq_u32 s48, 0x40000000
s_cselect_b64 s[70:71], -1, 0
v_cndmask_b32 v168, v168, v228, s[70:71]
v_mfma_f32_16x16x32_bf16 v[120:123], v[144:147], a[200:203], v[120:123]
s_waitcnt vmcnt(15) lgkmcnt(0)
v_cndmask_b32 v169, v169, v229, s[70:71]
v_cndmask_b32 v170, v170, v230, s[70:71]
v_mfma_f32_16x16x32_bf16 v[124:127], v[144:147], v[160:163], v[124:127]
global_load_dwordx4 v[144:147], v3, s[80:81] offset:2048 sc1
v_cndmask_b32 v171, v171, v231, s[70:71]
v_mfma_f32_16x16x32_bf16 v[80:83], v[148:151], a[204:207], v[80:83]
ds_read_b128 v[160:163], v19 offset:16384
ds_read_b128 a[192:195], v16 offset:16384
v_mfma_f32_16x16x32_bf16 v[84:87], v[148:151], a[208:211], v[84:87]
ds_read_b128 a[196:199], v17 offset:16384
ds_read_b128 a[200:203], v18 offset:16384
v_mfma_f32_16x16x32_bf16 v[88:91], v[148:151], a[212:215], v[88:91]
v_accvgpr_read_b32 v208, a164
v_accvgpr_read_b32 v209, a165
v_mfma_f32_16x16x32_bf16 v[92:95], v[148:151], v[164:167], v[92:95]
global_load_dwordx4 v[148:151], v3, s[80:81] offset:3072 sc1
s_add_u32 s80, s80, 8192
s_addc_u32 s81, s81, 0
v_accvgpr_read_b32 v210, a166
v_mfma_f32_16x16x32_bf16 v[96:99], v[152:155], a[204:207], v[96:99]
v_accvgpr_read_b32 v211, a167
v_mfma_f32_16x16x32_bf16 v[100:103], v[152:155], a[208:211], v[100:103]
v_cvt_pk_bf16_f32 v234, v208, v209
v_mfma_f32_16x16x32_bf16 v[104:107], v[152:155], a[212:215], v[104:107]
v_cvt_pk_bf16_f32 v235, v210, v211
v_mfma_f32_16x16x32_bf16 v[108:111], v[152:155], v[164:167], v[108:111]
global_load_dwordx4 v[152:155], v3, s[80:81] offset:-4096 sc1
v_mfma_f32_16x16x32_bf16 v[112:115], v[156:159], a[204:207], v[112:115]
buffer_store_dwordx4 v[232:235], v3, s[44:47], s49 offen sc1
v_mfma_f32_16x16x32_bf16 v[116:119], v[156:159], a[208:211], v[116:119]
s_cmp_eq_u32 s49, 0x40000000
s_cselect_b64 s[68:69], -1, 0
v_cndmask_b32 v168, v168, v232, s[68:69]
v_mfma_f32_16x16x32_bf16 v[120:123], v[156:159], a[212:215], v[120:123]
s_waitcnt vmcnt(16) lgkmcnt(0)
v_cndmask_b32 v169, v169, v233, s[68:69]
v_cndmask_b32 v170, v170, v234, s[68:69]
v_mfma_f32_16x16x32_bf16 v[124:127], v[156:159], v[164:167], v[124:127]
global_load_dwordx4 v[156:159], v3, s[80:81] offset:-3072 sc1
v_cndmask_b32 v171, v171, v235, s[68:69]
v_mfma_f32_16x16x32_bf16 v[80:83], a[216:219], a[192:195], v[80:83]
ds_read_b128 v[164:167], v19 offset:17408
ds_read_b128 a[204:207], v16 offset:17408
v_mfma_f32_16x16x32_bf16 v[84:87], a[216:219], a[196:199], v[84:87]
ds_read_b128 a[208:211], v17 offset:17408
ds_read_b128 a[212:215], v18 offset:17408
v_mfma_f32_16x16x32_bf16 v[88:91], a[216:219], a[200:203], v[88:91]
v_accvgpr_read_b32 v212, a168
v_accvgpr_read_b32 v213, a169
v_mfma_f32_16x16x32_bf16 v[92:95], a[216:219], v[160:163], v[92:95]
global_load_dwordx4 a[216:219], v3, s[80:81] offset:-2048 sc1
v_accvgpr_read_b32 v214, a170
v_mfma_f32_16x16x32_bf16 v[96:99], a[220:223], a[192:195], v[96:99]
v_accvgpr_read_b32 v215, a171
v_cvt_pk_bf16_f32 v238, v212, v213
v_mfma_f32_16x16x32_bf16 v[100:103], a[220:223], a[196:199], v[100:103]
v_cvt_pk_bf16_f32 v239, v214, v215
v_mfma_f32_16x16x32_bf16 v[104:107], a[220:223], a[200:203], v[104:107]
buffer_store_dwordx4 v[236:239], v3, s[44:47], s50 offen sc1
v_mfma_f32_16x16x32_bf16 v[108:111], a[220:223], v[160:163], v[108:111]
global_load_dwordx4 a[220:223], v3, s[80:81] offset:-1024 sc1
v_mfma_f32_16x16x32_bf16 v[112:115], a[224:227], a[192:195], v[112:115]
s_cmp_eq_u32 s50, 0x40000000
s_cselect_b64 s[70:71], -1, 0
v_cndmask_b32 v168, v168, v236, s[70:71]
v_mfma_f32_16x16x32_bf16 v[116:119], a[224:227], a[196:199], v[116:119]
v_cndmask_b32 v169, v169, v237, s[70:71]
v_mfma_f32_16x16x32_bf16 v[120:123], a[224:227], a[200:203], v[120:123]
s_waitcnt vmcnt(17) lgkmcnt(0)
v_cndmask_b32 v170, v170, v238, s[70:71]
v_mfma_f32_16x16x32_bf16 v[124:127], a[224:227], v[160:163], v[124:127]
global_load_dwordx4 a[224:227], v3, s[80:81] offset:0 sc1
v_cndmask_b32 v171, v171, v239, s[70:71]
v_mfma_f32_16x16x32_bf16 v[80:83], a[228:231], a[204:207], v[80:83]
ds_read_b128 v[160:163], v19 offset:0
v_accvgpr_read_b32 v216, a172
v_mfma_f32_16x16x32_bf16 v[84:87], a[228:231], a[208:211], v[84:87]
v_accvgpr_read_b32 v217, a173
v_mfma_f32_16x16x32_bf16 v[88:91], a[228:231], a[212:215], v[88:91]
v_accvgpr_read_b32 v218, a174
v_mfma_f32_16x16x32_bf16 v[92:95], a[228:231], v[164:167], v[92:95]
global_load_dwordx4 a[228:231], v3, s[80:81] offset:1024 sc1
v_accvgpr_read_b32 v219, a175
v_mfma_f32_16x16x32_bf16 v[96:99], a[232:235], a[204:207], v[96:99]
v_cvt_pk_bf16_f32 v242, v216, v217
v_mfma_f32_16x16x32_bf16 v[100:103], a[232:235], a[208:211], v[100:103]
v_cvt_pk_bf16_f32 v243, v218, v219
v_mfma_f32_16x16x32_bf16 v[104:107], a[232:235], a[212:215], v[104:107]
buffer_store_dwordx4 v[240:243], v3, s[44:47], s51 offen sc1
v_mfma_f32_16x16x32_bf16 v[108:111], a[232:235], v[164:167], v[108:111]
global_load_dwordx4 a[232:235], v3, s[80:81] offset:2048 sc1
v_mfma_f32_16x16x32_bf16 v[112:115], a[236:239], a[204:207], v[112:115]
s_cmp_eq_u32 s51, 0x40000000
s_cselect_b64 s[68:69], -1, 0
v_cndmask_b32 v168, v168, v240, s[68:69]
v_mfma_f32_16x16x32_bf16 v[116:119], a[236:239], a[208:211], v[116:119]
v_cndmask_b32 v169, v169, v241, s[68:69]
v_mfma_f32_16x16x32_bf16 v[120:123], a[236:239], a[212:215], v[120:123]
s_waitcnt vmcnt(18) lgkmcnt(0)
v_cndmask_b32 v170, v170, v242, s[68:69]
v_mfma_f32_16x16x32_bf16 v[124:127], a[236:239], v[164:167], v[124:127]
global_load_dwordx4 a[236:239], v3, s[80:81] offset:3072 sc1
s_add_u32 s80, s80, 8192
s_addc_u32 s81, s81, 0
v_cndmask_b32 v171, v171, v243, s[68:69]
v_mfma_f32_16x16x32_bf16 v[32:35], a[240:243], a[0:3], 0
ds_read_b128 v[164:167], v19 offset:1024
v_accvgpr_read_b32 v204, a176
v_mfma_f32_16x16x32_bf16 v[36:39], a[240:243], a[4:7], 0
v_accvgpr_read_b32 v205, a177
v_mfma_f32_16x16x32_bf16 v[40:43], a[240:243], a[8:11], 0
v_accvgpr_read_b32 v206, a178
v_mfma_f32_16x16x32_bf16 v[44:47], a[240:243], v[160:163], 0
global_load_dwordx4 a[240:243], v3, s[80:81] offset:-4096 sc1
v_accvgpr_read_b32 v207, a179
v_mfma_f32_16x16x32_bf16 v[48:51], a[244:247], a[0:3], 0
v_cvt_pk_bf16_f32 v228, v204, v205
v_mfma_f32_16x16x32_bf16 v[52:55], a[244:247], a[4:7], 0
v_cvt_pk_bf16_f32 v229, v206, v207
v_mfma_f32_16x16x32_bf16 v[56:59], a[244:247], a[8:11], 0
v_accvgpr_read_b32 v208, a180
v_mfma_f32_16x16x32_bf16 v[60:63], a[244:247], v[160:163], 0
global_load_dwordx4 a[244:247], v3, s[80:81] offset:-3072 sc1
v_accvgpr_read_b32 v209, a181
v_mfma_f32_16x16x32_bf16 v[64:67], a[248:251], a[0:3], 0
v_accvgpr_read_b32 v210, a182
v_mfma_f32_16x16x32_bf16 v[68:71], a[248:251], a[4:7], 0
v_accvgpr_read_b32 v211, a183
v_mfma_f32_16x16x32_bf16 v[72:75], a[248:251], a[8:11], 0
s_waitcnt vmcnt(18) lgkmcnt(0)
v_cvt_pk_bf16_f32 v232, v208, v209
v_mfma_f32_16x16x32_bf16 v[76:79], a[248:251], v[160:163], 0
global_load_dwordx4 a[248:251], v3, s[80:81] offset:-2048 sc1
v_cvt_pk_bf16_f32 v233, v210, v211
v_mfma_f32_16x16x32_bf16 v[32:35], a[252:255], a[12:15], v[32:35]
ds_read_b128 v[160:163], v19 offset:2048
v_accvgpr_read_b32 v212, a184
v_mfma_f32_16x16x32_bf16 v[36:39], a[252:255], a[16:19], v[36:39]
v_accvgpr_read_b32 v213, a185
v_mfma_f32_16x16x32_bf16 v[40:43], a[252:255], a[20:23], v[40:43]
v_accvgpr_read_b32 v214, a186
v_mfma_f32_16x16x32_bf16 v[44:47], a[252:255], v[164:167], v[44:47]
global_load_dwordx4 a[252:255], v3, s[80:81] offset:-1024 sc1
v_accvgpr_read_b32 v215, a187
v_mfma_f32_16x16x32_bf16 v[48:51], v[128:131], a[12:15], v[48:51]
v_cvt_pk_bf16_f32 v236, v212, v213
v_mfma_f32_16x16x32_bf16 v[52:55], v[128:131], a[16:19], v[52:55]
v_cvt_pk_bf16_f32 v237, v214, v215
v_mfma_f32_16x16x32_bf16 v[56:59], v[128:131], a[20:23], v[56:59]
v_accvgpr_read_b32 v216, a188
v_mfma_f32_16x16x32_bf16 v[60:63], v[128:131], v[164:167], v[60:63]
global_load_dwordx4 v[128:131], v3, s[80:81] offset:0 sc1
v_accvgpr_read_b32 v217, a189
v_mfma_f32_16x16x32_bf16 v[64:67], v[132:135], a[12:15], v[64:67]
v_accvgpr_read_b32 v218, a190
v_mfma_f32_16x16x32_bf16 v[68:71], v[132:135], a[16:19], v[68:71]
v_accvgpr_read_b32 v219, a191
v_mfma_f32_16x16x32_bf16 v[72:75], v[132:135], a[20:23], v[72:75]
s_waitcnt vmcnt(17) lgkmcnt(0)
v_cvt_pk_bf16_f32 v240, v216, v217
v_mfma_f32_16x16x32_bf16 v[76:79], v[132:135], v[164:167], v[76:79]
global_load_dwordx4 v[132:135], v3, s[80:81] offset:1024 sc1
v_cvt_pk_bf16_f32 v241, v218, v219
v_mfma_f32_16x16x32_bf16 v[32:35], v[136:139], a[24:27], v[32:35]
ds_read_b128 v[164:167], v19 offset:3072
v_mfma_f32_16x16x32_bf16 v[36:39], v[136:139], a[28:31], v[36:39]
v_mfma_f32_16x16x32_bf16 v[40:43], v[136:139], a[32:35], v[40:43]
v_mfma_f32_16x16x32_bf16 v[44:47], v[136:139], v[160:163], v[44:47]
global_load_dwordx4 v[136:139], v3, s[80:81] offset:2048 sc1
v_mfma_f32_16x16x32_bf16 v[48:51], v[140:143], a[24:27], v[48:51]
v_mfma_f32_16x16x32_bf16 v[52:55], v[140:143], a[28:31], v[52:55]
v_mfma_f32_16x16x32_bf16 v[56:59], v[140:143], a[32:35], v[56:59]
v_mfma_f32_16x16x32_bf16 v[60:63], v[140:143], v[160:163], v[60:63]
global_load_dwordx4 v[140:143], v3, s[80:81] offset:3072 sc1
s_add_u32 s80, s80, 8192
s_addc_u32 s81, s81, 0
v_mfma_f32_16x16x32_bf16 v[64:67], v[144:147], a[24:27], v[64:67]
v_mfma_f32_16x16x32_bf16 v[68:71], v[144:147], a[28:31], v[68:71]
v_mfma_f32_16x16x32_bf16 v[72:75], v[144:147], a[32:35], v[72:75]
s_waitcnt vmcnt(16) lgkmcnt(0)
v_mfma_f32_16x16x32_bf16 v[76:79], v[144:147], v[160:163], v[76:79]
global_load_dwordx4 v[144:147], v3, s[80:81] offset:-4096 sc1
v_mfma_f32_16x16x32_bf16 v[32:35], v[148:151], a[36:39], v[32:35]
ds_read_b128 v[160:163], v19 offset:4096
v_mfma_f32_16x16x32_bf16 v[36:39], v[148:151], a[40:43], v[36:39]
v_mfma_f32_16x16x32_bf16 v[40:43], v[148:151], a[44:47], v[40:43]
v_mfma_f32_16x16x32_bf16 v[44:47], v[148:151], v[164:167], v[44:47]
global_load_dwordx4 v[148:151], v3, s[80:81] offset:-3072 sc1
v_mfma_f32_16x16x32_bf16 v[48:51], v[152:155], a[36:39], v[48:51]
v_mfma_f32_16x16x32_bf16 v[52:55], v[152:155], a[40:43], v[52:55]
v_mfma_f32_16x16x32_bf16 v[56:59], v[152:155], a[44:47], v[56:59]
v_mfma_f32_16x16x32_bf16 v[60:63], v[152:155], v[164:167], v[60:63]
global_load_dwordx4 v[152:155], v3, s[80:81] offset:-2048 sc1
v_mfma_f32_16x16x32_bf16 v[64:67], v[156:159], a[36:39], v[64:67]
v_mfma_f32_16x16x32_bf16 v[68:71], v[156:159], a[40:43], v[68:71]
v_mfma_f32_16x16x32_bf16 v[72:75], v[156:159], a[44:47], v[72:75]
s_waitcnt vmcnt(15) lgkmcnt(0)
v_mfma_f32_16x16x32_bf16 v[76:79], v[156:159], v[164:167], v[76:79]
global_load_dwordx4 v[156:159], v3, s[80:81] offset:-1024 sc1
v_mfma_f32_16x16x32_bf16 v[32:35], a[216:219], a[48:51], v[32:35]
ds_read_b128 v[164:167], v19 offset:5120
v_mfma_f32_16x16x32_bf16 v[36:39], a[216:219], a[52:55], v[36:39]
v_mfma_f32_16x16x32_bf16 v[40:43], a[216:219], a[56:59], v[40:43]
v_mfma_f32_16x16x32_bf16 v[44:47], a[216:219], v[160:163], v[44:47]
global_load_dwordx4 a[216:219], v3, s[80:81] offset:0 sc1
v_mfma_f32_16x16x32_bf16 v[48:51], a[220:223], a[48:51], v[48:51]
v_mfma_f32_16x16x32_bf16 v[52:55], a[220:223], a[52:55], v[52:55]
v_mfma_f32_16x16x32_bf16 v[56:59], a[220:223], a[56:59], v[56:59]
v_mfma_f32_16x16x32_bf16 v[60:63], a[220:223], v[160:163], v[60:63]
global_load_dwordx4 a[220:223], v3, s[80:81] offset:1024 sc1
v_mfma_f32_16x16x32_bf16 v[64:67], a[224:227], a[48:51], v[64:67]
v_mfma_f32_16x16x32_bf16 v[68:71], a[224:227], a[52:55], v[68:71]
v_mfma_f32_16x16x32_bf16 v[72:75], a[224:227], a[56:59], v[72:75]
s_waitcnt vmcnt(14) lgkmcnt(0)
v_mfma_f32_16x16x32_bf16 v[76:79], a[224:227], v[160:163], v[76:79]
global_load_dwordx4 a[224:227], v3, s[80:81] offset:2048 sc1
v_mfma_f32_16x16x32_bf16 v[32:35], a[228:231], a[60:63], v[32:35]
ds_read_b128 v[160:163], v19 offset:6144
v_mfma_f32_16x16x32_bf16 v[36:39], a[228:231], a[64:67], v[36:39]
v_mfma_f32_16x16x32_bf16 v[40:43], a[228:231], a[68:71], v[40:43]
v_mfma_f32_16x16x32_bf16 v[44:47], a[228:231], v[164:167], v[44:47]
global_load_dwordx4 a[228:231], v3, s[80:81] offset:3072 sc1
s_add_u32 s80, s80, 8192
s_addc_u32 s81, s81, 0
v_mfma_f32_16x16x32_bf16 v[48:51], a[232:235], a[60:63], v[48:51]
v_cvt_pk_bf16_f32 v230, v80, v81
v_mfma_f32_16x16x32_bf16 v[52:55], a[232:235], a[64:67], v[52:55]
v_mfma_f32_16x16x32_bf16 v[56:59], a[232:235], a[68:71], v[56:59]
v_cvt_pk_bf16_f32 v231, v82, v83
v_mfma_f32_16x16x32_bf16 v[60:63], a[232:235], v[164:167], v[60:63]
global_load_dwordx4 a[232:235], v3, s[80:81] offset:-4096 sc1
v_mfma_f32_16x16x32_bf16 v[64:67], a[236:239], a[60:63], v[64:67]
v_mfma_f32_16x16x32_bf16 v[68:71], a[236:239], a[64:67], v[68:71]
buffer_store_dwordx4 v[228:231], v3, s[44:47], s52 offen sc1
v_mfma_f32_16x16x32_bf16 v[72:75], a[236:239], a[68:71], v[72:75]
s_waitcnt vmcnt(15) lgkmcnt(0)
v_mfma_f32_16x16x32_bf16 v[76:79], a[236:239], v[164:167], v[76:79]
global_load_dwordx4 a[236:239], v3, s[80:81] offset:-3072 sc1
v_mfma_f32_16x16x32_bf16 v[32:35], a[240:243], a[72:75], v[32:35]
ds_read_b128 v[164:167], v19 offset:7168
s_cmp_eq_u32 s52, 0x40000000
s_cselect_b64 s[70:71], -1, 0
v_cndmask_b32 v168, v168, v228, s[70:71]
v_mfma_f32_16x16x32_bf16 v[36:39], a[240:243], a[76:79], v[36:39]
v_mfma_f32_16x16x32_bf16 v[40:43], a[240:243], a[80:83], v[40:43]
v_cndmask_b32 v169, v169, v229, s[70:71]
v_mfma_f32_16x16x32_bf16 v[44:47], a[240:243], v[160:163], v[44:47]
global_load_dwordx4 a[240:243], v3, s[80:81] offset:-2048 sc1
v_cndmask_b32 v170, v170, v230, s[70:71]
v_mfma_f32_16x16x32_bf16 v[48:51], a[244:247], a[72:75], v[48:51]
v_mfma_f32_16x16x32_bf16 v[52:55], a[244:247], a[76:79], v[52:55]
v_cndmask_b32 v171, v171, v231, s[70:71]
v_mfma_f32_16x16x32_bf16 v[56:59], a[244:247], a[80:83], v[56:59]
v_mfma_f32_16x16x32_bf16 v[60:63], a[244:247], v[160:163], v[60:63]
global_load_dwordx4 a[244:247], v3, s[80:81] offset:-1024 sc1
v_cvt_pk_bf16_f32 v234, v84, v85
v_mfma_f32_16x16x32_bf16 v[64:67], a[248:251], a[72:75], v[64:67]
v_mfma_f32_16x16x32_bf16 v[68:71], a[248:251], a[76:79], v[68:71]
v_cvt_pk_bf16_f32 v235, v86, v87
v_mfma_f32_16x16x32_bf16 v[72:75], a[248:251], a[80:83], v[72:75]
s_waitcnt vmcnt(15) lgkmcnt(0)
v_mfma_f32_16x16x32_bf16 v[76:79], a[248:251], v[160:163], v[76:79]
global_load_dwordx4 a[248:251], v3, s[80:81] offset:0 sc1
v_mfma_f32_16x16x32_bf16 v[32:35], a[252:255], a[84:87], v[32:35]
ds_read_b128 v[160:163], v19 offset:8192
v_mfma_f32_16x16x32_bf16 v[36:39], a[252:255], a[88:91], v[36:39]
buffer_store_dwordx4 v[232:235], v3, s[44:47], s53 offen sc1
v_mfma_f32_16x16x32_bf16 v[40:43], a[252:255], a[92:95], v[40:43]
s_cmp_eq_u32 s53, 0x40000000
s_cselect_b64 s[68:69], -1, 0
v_cndmask_b32 v168, v168, v232, s[68:69]
v_mfma_f32_16x16x32_bf16 v[44:47], a[252:255], v[164:167], v[44:47]
global_load_dwordx4 a[252:255], v3, s[80:81] offset:1024 sc1
v_mfma_f32_16x16x32_bf16 v[48:51], v[128:131], a[84:87], v[48:51]
v_cndmask_b32 v169, v169, v233, s[68:69]
v_mfma_f32_16x16x32_bf16 v[52:55], v[128:131], a[88:91], v[52:55]
v_mfma_f32_16x16x32_bf16 v[56:59], v[128:131], a[92:95], v[56:59]
v_cndmask_b32 v170, v170, v234, s[68:69]
v_mfma_f32_16x16x32_bf16 v[60:63], v[128:131], v[164:167], v[60:63]
global_load_dwordx4 v[128:131], v3, s[80:81] offset:2048 sc1
v_mfma_f32_16x16x32_bf16 v[64:67], v[132:135], a[84:87], v[64:67]
v_cndmask_b32 v171, v171, v235, s[68:69]
v_mfma_f32_16x16x32_bf16 v[68:71], v[132:135], a[88:91], v[68:71]
v_mfma_f32_16x16x32_bf16 v[72:75], v[132:135], a[92:95], v[72:75]
s_waitcnt vmcnt(16) lgkmcnt(0)
v_cvt_pk_bf16_f32 v238, v88, v89
v_mfma_f32_16x16x32_bf16 v[76:79], v[132:135], v[164:167], v[76:79]
global_load_dwordx4 v[132:135], v3, s[80:81] offset:3072 sc1
s_add_u32 s80, s80, 8192
s_addc_u32 s81, s81, 0
v_cvt_pk_bf16_f32 v239, v90, v91
v_mfma_f32_16x16x32_bf16 v[32:35], v[136:139], a[96:99], v[32:35]
ds_read_b128 v[164:167], v19 offset:9216
v_mfma_f32_16x16x32_bf16 v[36:39], v[136:139], a[100:103], v[36:39]
v_mfma_f32_16x16x32_bf16 v[40:43], v[136:139], a[104:107], v[40:43]
buffer_store_dwordx4 v[236:239], v3, s[44:47], s54 offen sc1
v_mfma_f32_16x16x32_bf16 v[44:47], v[136:139], v[160:163], v[44:47]
global_load_dwordx4 v[136:139], v3, s[80:81] offset:-4096 sc1
v_mfma_f32_16x16x32_bf16 v[48:51], v[140:143], a[96:99], v[48:51]
v_mfma_f32_16x16x32_bf16 v[52:55], v[140:143], a[100:103], v[52:55]
s_cmp_eq_u32 s54, 0x40000000
s_cselect_b64 s[70:71], -1, 0
v_cndmask_b32 v168, v168, v236, s[70:71]
v_mfma_f32_16x16x32_bf16 v[56:59], v[140:143], a[104:107], v[56:59]
v_mfma_f32_16x16x32_bf16 v[60:63], v[140:143], v[160:163], v[60:63]
global_load_dwordx4 v[140:143], v3, s[80:81] offset:-3072 sc1
v_cndmask_b32 v169, v169, v237, s[70:71]
v_mfma_f32_16x16x32_bf16 v[64:67], v[144:147], a[96:99], v[64:67]
v_cndmask_b32 v170, v170, v238, s[70:71]
v_mfma_f32_16x16x32_bf16 v[68:71], v[144:147], a[100:103], v[68:71]
v_mfma_f32_16x16x32_bf16 v[72:75], v[144:147], a[104:107], v[72:75]
s_waitcnt vmcnt(17) lgkmcnt(0)
v_cndmask_b32 v171, v171, v239, s[70:71]
v_mfma_f32_16x16x32_bf16 v[76:79], v[144:147], v[160:163], v[76:79]
global_load_dwordx4 v[144:147], v3, s[80:81] offset:-2048 sc1
v_mfma_f32_16x16x32_bf16 v[32:35], v[148:151], a[108:111], v[32:35]
ds_read_b128 v[160:163], v19 offset:10240
v_cvt_pk_bf16_f32 v242, v92, v93
v_mfma_f32_16x16x32_bf16 v[36:39], v[148:151], a[112:115], v[36:39]
v_mfma_f32_16x16x32_bf16 v[40:43], v[148:151], a[116:119], v[40:43]
v_cvt_pk_bf16_f32 v243, v94, v95
v_mfma_f32_16x16x32_bf16 v[44:47], v[148:151], v[164:167], v[44:47]
global_load_dwordx4 v[148:151], v3, s[80:81] offset:-1024 sc1
v_mfma_f32_16x16x32_bf16 v[48:51], v[152:155], a[108:111], v[48:51]
v_mfma_f32_16x16x32_bf16 v[52:55], v[152:155], a[112:115], v[52:55]
buffer_store_dwordx4 v[240:243], v3, s[44:47], s55 offen sc1
v_mfma_f32_16x16x32_bf16 v[56:59], v[152:155], a[116:119], v[56:59]
v_mfma_f32_16x16x32_bf16 v[60:63], v[152:155], v[164:167], v[60:63]
global_load_dwordx4 v[152:155], v3, s[80:81] offset:0 sc1
s_cmp_eq_u32 s55, 0x40000000
s_cselect_b64 s[68:69], -1, 0
v_cndmask_b32 v168, v168, v240, s[68:69]
v_mfma_f32_16x16x32_bf16 v[64:67], v[156:159], a[108:111], v[64:67]
v_mfma_f32_16x16x32_bf16 v[68:71], v[156:159], a[112:115], v[68:71]
v_cndmask_b32 v169, v169, v241, s[68:69]
v_mfma_f32_16x16x32_bf16 v[72:75], v[156:159], a[116:119], v[72:75]
s_waitcnt vmcnt(18) lgkmcnt(0)
v_mfma_f32_16x16x32_bf16 v[76:79], v[156:159], v[164:167], v[76:79]
global_load_dwordx4 v[156:159], v3, s[80:81] offset:1024 sc1
v_cndmask_b32 v170, v170, v242, s[68:69]
v_mfma_f32_16x16x32_bf16 v[32:35], a[216:219], a[120:123], v[32:35]
ds_read_b128 v[164:167], v19 offset:11264
v_mfma_f32_16x16x32_bf16 v[36:39], a[216:219], a[124:127], v[36:39]
v_cndmask_b32 v171, v171, v243, s[68:69]
v_mfma_f32_16x16x32_bf16 v[40:43], a[216:219], a[128:131], v[40:43]
v_mfma_f32_16x16x32_bf16 v[44:47], a[216:219], v[160:163], v[44:47]
global_load_dwordx4 a[216:219], v3, s[80:81] offset:2048 sc1
v_cvt_pk_bf16_f32 v228, v96, v97
v_mfma_f32_16x16x32_bf16 v[48:51], a[220:223], a[120:123], v[48:51]
v_cvt_pk_bf16_f32 v229, v98, v99
v_mfma_f32_16x16x32_bf16 v[52:55], a[220:223], a[124:127], v[52:55]
v_mfma_f32_16x16x32_bf16 v[56:59], a[220:223], a[128:131], v[56:59]
v_cvt_pk_bf16_f32 v232, v100, v101
v_mfma_f32_16x16x32_bf16 v[60:63], a[220:223], v[160:163], v[60:63]
global_load_dwordx4 a[220:223], v3, s[80:81] offset:3072 sc1
s_add_u32 s80, s80, 8192
s_addc_u32 s81, s81, 0
v_mfma_f32_16x16x32_bf16 v[64:67], a[224:227], a[120:123], v[64:67]
v_cvt_pk_bf16_f32 v233, v102, v103
v_mfma_f32_16x16x32_bf16 v[68:71], a[224:227], a[124:127], v[68:71]
v_mfma_f32_16x16x32_bf16 v[72:75], a[224:227], a[128:131], v[72:75]
s_waitcnt vmcnt(17) lgkmcnt(0)
v_cvt_pk_bf16_f32 v236, v104, v105
v_mfma_f32_16x16x32_bf16 v[76:79], a[224:227], v[160:163], v[76:79]
global_load_dwordx4 a[224:227], v3, s[80:81] offset:-4096 sc1
v_cvt_pk_bf16_f32 v237, v106, v107
v_mfma_f32_16x16x32_bf16 v[32:35], a[228:231], a[132:135], v[32:35]
ds_read_b128 v[160:163], v19 offset:12288
ds_read_b128 a[144:147], v16 offset:12288
v_mfma_f32_16x16x32_bf16 v[36:39], a[228:231], a[136:139], v[36:39]
ds_read_b128 a[148:151], v17 offset:12288
ds_read_b128 a[152:155], v18 offset:12288
v_mfma_f32_16x16x32_bf16 v[40:43], a[228:231], a[140:143], v[40:43]
v_cvt_pk_bf16_f32 v240, v108, v109
v_mfma_f32_16x16x32_bf16 v[44:47], a[228:231], v[164:167], v[44:47]
global_load_dwordx4 a[228:231], v3, s[80:81] offset:-3072 sc1
v_cvt_pk_bf16_f32 v241, v110, v111
v_mfma_f32_16x16x32_bf16 v[48:51], a[232:235], a[132:135], v[48:51]
v_mfma_f32_16x16x32_bf16 v[52:55], a[232:235], a[136:139], v[52:55]
v_cvt_pk_bf16_f32 v230, v112, v113
v_mfma_f32_16x16x32_bf16 v[56:59], a[232:235], a[140:143], v[56:59]
v_mfma_f32_16x16x32_bf16 v[60:63], a[232:235], v[164:167], v[60:63]
global_load_dwordx4 a[232:235], v3, s[80:81] offset:-2048 sc1
v_cvt_pk_bf16_f32 v231, v114, v115
v_mfma_f32_16x16x32_bf16 v[64:67], a[236:239], a[132:135], v[64:67]
v_mfma_f32_16x16x32_bf16 v[68:71], a[236:239], a[136:139], v[68:71]
v_mfma_f32_16x16x32_bf16 v[72:75], a[236:239], a[140:143], v[72:75]
s_waitcnt vmcnt(17) lgkmcnt(0)
buffer_store_dwordx4 v[228:231], v3, s[44:47], s56 offen sc1
v_mfma_f32_16x16x32_bf16 v[76:79], a[236:239], v[164:167], v[76:79]
global_load_dwordx4 a[236:239], v3, s[80:81] offset:-1024 sc1
s_cmp_eq_u32 s56, 0x40000000
s_cselect_b64 s[70:71], -1, 0
v_cndmask_b32 v172, v172, v228, s[70:71]
v_mfma_f32_16x16x32_bf16 v[32:35], a[240:243], a[144:147], v[32:35]
ds_read_b128 v[164:167], v19 offset:13312
ds_read_b128 a[156:159], v16 offset:13312
v_mfma_f32_16x16x32_bf16 v[36:39], a[240:243], a[148:151], v[36:39]
ds_read_b128 a[160:163], v17 offset:13312
ds_read_b128 a[164:167], v18 offset:13312
v_mfma_f32_16x16x32_bf16 v[40:43], a[240:243], a[152:155], v[40:43]
v_cndmask_b32 v173, v173, v229, s[70:71]
v_mfma_f32_16x16x32_bf16 v[44:47], a[240:243], v[160:163], v[44:47]
v_mfma_f32_16x16x32_bf16 v[48:51], a[244:247], a[144:147], v[48:51]
v_cndmask_b32 v174, v174, v230, s[70:71]
v_mfma_f32_16x16x32_bf16 v[52:55], a[244:247], a[148:151], v[52:55]
v_mfma_f32_16x16x32_bf16 v[56:59], a[244:247], a[152:155], v[56:59]
v_cndmask_b32 v175, v175, v231, s[70:71]
v_mfma_f32_16x16x32_bf16 v[60:63], a[244:247], v[160:163], v[60:63]
v_mfma_f32_16x16x32_bf16 v[64:67], a[248:251], a[144:147], v[64:67]
v_cvt_pk_bf16_f32 v234, v116, v117
v_mfma_f32_16x16x32_bf16 v[68:71], a[248:251], a[148:151], v[68:71]
v_mfma_f32_16x16x32_bf16 v[72:75], a[248:251], a[152:155], v[72:75]
s_waitcnt vmcnt(15) lgkmcnt(0)
v_cvt_pk_bf16_f32 v235, v118, v119
v_mfma_f32_16x16x32_bf16 v[76:79], a[248:251], v[160:163], v[76:79]
buffer_store_dwordx4 v[232:235], v3, s[44:47], s57 offen sc1
v_mfma_f32_16x16x32_bf16 v[32:35], a[252:255], a[156:159], v[32:35]
ds_read_b128 v[160:163], v19 offset:14336
ds_read_b128 a[168:171], v16 offset:14336
v_mfma_f32_16x16x32_bf16 v[36:39], a[252:255], a[160:163], v[36:39]
ds_read_b128 a[172:175], v17 offset:14336
ds_read_b128 a[176:179], v18 offset:14336
v_mfma_f32_16x16x32_bf16 v[40:43], a[252:255], a[164:167], v[40:43]
v_mfma_f32_16x16x32_bf16 v[44:47], a[252:255], v[164:167], v[44:47]
s_cmp_eq_u32 s57, 0x40000000
s_cselect_b64 s[68:69], -1, 0
v_cndmask_b32 v172, v172, v232, s[68:69]
v_mfma_f32_16x16x32_bf16 v[48:51], v[128:131], a[156:159], v[48:51]
v_mfma_f32_16x16x32_bf16 v[52:55], v[128:131], a[160:163], v[52:55]
v_cndmask_b32 v173, v173, v233, s[68:69]
v_mfma_f32_16x16x32_bf16 v[56:59], v[128:131], a[164:167], v[56:59]
v_mfma_f32_16x16x32_bf16 v[60:63], v[128:131], v[164:167], v[60:63]
v_cndmask_b32 v174, v174, v234, s[68:69]
v_mfma_f32_16x16x32_bf16 v[64:67], v[132:135], a[156:159], v[64:67]
v_cndmask_b32 v175, v175, v235, s[68:69]
v_mfma_f32_16x16x32_bf16 v[68:71], v[132:135], a[160:163], v[68:71]
v_mfma_f32_16x16x32_bf16 v[72:75], v[132:135], a[164:167], v[72:75]
s_waitcnt vmcnt(12) lgkmcnt(0)
v_cvt_pk_bf16_f32 v238, v120, v121
v_mfma_f32_16x16x32_bf16 v[76:79], v[132:135], v[164:167], v[76:79]
v_cvt_pk_bf16_f32 v239, v122, v123
v_mfma_f32_16x16x32_bf16 v[32:35], v[136:139], a[168:171], v[32:35]
ds_read_b128 v[164:167], v19 offset:15360
ds_read_b128 a[180:183], v16 offset:15360
v_mfma_f32_16x16x32_bf16 v[36:39], v[136:139], a[172:175], v[36:39]
ds_read_b128 a[184:187], v17 offset:15360
ds_read_b128 a[188:191], v18 offset:15360
v_mfma_f32_16x16x32_bf16 v[40:43], v[136:139], a[176:179], v[40:43]
v_mfma_f32_16x16x32_bf16 v[44:47], v[136:139], v[160:163], v[44:47]
buffer_store_dwordx4 v[236:239], v3, s[44:47], s58 offen sc1
v_mfma_f32_16x16x32_bf16 v[48:51], v[140:143], a[168:171], v[48:51]
v_mfma_f32_16x16x32_bf16 v[52:55], v[140:143], a[172:175], v[52:55]
v_mfma_f32_16x16x32_bf16 v[56:59], v[140:143], a[176:179], v[56:59]
s_cmp_eq_u32 s58, 0x40000000
s_cselect_b64 s[70:71], -1, 0
v_cndmask_b32 v172, v172, v236, s[70:71]
v_mfma_f32_16x16x32_bf16 v[60:63], v[140:143], v[160:163], v[60:63]
v_cndmask_b32 v173, v173, v237, s[70:71]
v_mfma_f32_16x16x32_bf16 v[64:67], v[144:147], a[168:171], v[64:67]
v_mfma_f32_16x16x32_bf16 v[68:71], v[144:147], a[172:175], v[68:71]
v_cndmask_b32 v174, v174, v238, s[70:71]
v_mfma_f32_16x16x32_bf16 v[72:75], v[144:147], a[176:179], v[72:75]
s_waitcnt vmcnt(9) lgkmcnt(0)
v_mfma_f32_16x16x32_bf16 v[76:79], v[144:147], v[160:163], v[76:79]
v_cndmask_b32 v175, v175, v239, s[70:71]
v_mfma_f32_16x16x32_bf16 v[32:35], v[148:151], a[180:183], v[32:35]
ds_read_b128 v[160:163], v19 offset:16384
ds_read_b128 a[192:195], v16 offset:16384
v_mfma_f32_16x16x32_bf16 v[36:39], v[148:151], a[184:187], v[36:39]
ds_read_b128 a[196:199], v17 offset:16384
ds_read_b128 a[200:203], v18 offset:16384
v_mfma_f32_16x16x32_bf16 v[40:43], v[148:151], a[188:191], v[40:43]
v_cvt_pk_bf16_f32 v242, v124, v125
v_mfma_f32_16x16x32_bf16 v[44:47], v[148:151], v[164:167], v[44:47]
v_cvt_pk_bf16_f32 v243, v126, v127
v_mfma_f32_16x16x32_bf16 v[48:51], v[152:155], a[180:183], v[48:51]
v_mfma_f32_16x16x32_bf16 v[52:55], v[152:155], a[184:187], v[52:55]
buffer_store_dwordx4 v[240:243], v3, s[44:47], s59 offen sc1
v_mfma_f32_16x16x32_bf16 v[56:59], v[152:155], a[188:191], v[56:59]
v_mfma_f32_16x16x32_bf16 v[60:63], v[152:155], v[164:167], v[60:63]
v_mfma_f32_16x16x32_bf16 v[64:67], v[156:159], a[180:183], v[64:67]
s_cmp_eq_u32 s59, 0x40000000
s_cselect_b64 s[68:69], -1, 0
v_cndmask_b32 v172, v172, v240, s[68:69]
v_mfma_f32_16x16x32_bf16 v[68:71], v[156:159], a[184:187], v[68:71]
v_mfma_f32_16x16x32_bf16 v[72:75], v[156:159], a[188:191], v[72:75]
s_waitcnt vmcnt(7) lgkmcnt(0)
v_cndmask_b32 v173, v173, v241, s[68:69]
v_mfma_f32_16x16x32_bf16 v[76:79], v[156:159], v[164:167], v[76:79]
v_cndmask_b32 v174, v174, v242, s[68:69]
v_mfma_f32_16x16x32_bf16 v[32:35], a[216:219], a[192:195], v[32:35]
ds_read_b128 v[164:167], v19 offset:17408
ds_read_b128 a[204:207], v16 offset:17408
v_mfma_f32_16x16x32_bf16 v[36:39], a[216:219], a[196:199], v[36:39]
ds_read_b128 a[208:211], v17 offset:17408
ds_read_b128 a[212:215], v18 offset:17408
v_mfma_f32_16x16x32_bf16 v[40:43], a[216:219], a[200:203], v[40:43]
v_cndmask_b32 v175, v175, v243, s[68:69]
v_mfma_f32_16x16x32_bf16 v[44:47], a[216:219], v[160:163], v[44:47]
v_mfma_f32_16x16x32_bf16 v[48:51], a[220:223], a[192:195], v[48:51]
v_mfma_f32_16x16x32_bf16 v[52:55], a[220:223], a[196:199], v[52:55]
v_mfma_f32_16x16x32_bf16 v[56:59], a[220:223], a[200:203], v[56:59]
v_mfma_f32_16x16x32_bf16 v[60:63], a[220:223], v[160:163], v[60:63]
v_mfma_f32_16x16x32_bf16 v[64:67], a[224:227], a[192:195], v[64:67]
v_mfma_f32_16x16x32_bf16 v[68:71], a[224:227], a[196:199], v[68:71]
v_mfma_f32_16x16x32_bf16 v[72:75], a[224:227], a[200:203], v[72:75]
s_waitcnt vmcnt(3) lgkmcnt(0)
v_mfma_f32_16x16x32_bf16 v[76:79], a[224:227], v[160:163], v[76:79]
v_mfma_f32_16x16x32_bf16 v[32:35], a[228:231], a[204:207], v[32:35]
v_mfma_f32_16x16x32_bf16 v[36:39], a[228:231], a[208:211], v[36:39]
v_mfma_f32_16x16x32_bf16 v[40:43], a[228:231], a[212:215], v[40:43]
v_mfma_f32_16x16x32_bf16 v[44:47], a[228:231], v[164:167], v[44:47]
v_mfma_f32_16x16x32_bf16 v[48:51], a[232:235], a[204:207], v[48:51]
v_mfma_f32_16x16x32_bf16 v[52:55], a[232:235], a[208:211], v[52:55]
v_mfma_f32_16x16x32_bf16 v[56:59], a[232:235], a[212:215], v[56:59]
v_mfma_f32_16x16x32_bf16 v[60:63], a[232:235], v[164:167], v[60:63]
v_mfma_f32_16x16x32_bf16 v[64:67], a[236:239], a[204:207], v[64:67]
v_mfma_f32_16x16x32_bf16 v[68:71], a[236:239], a[208:211], v[68:71]
v_mfma_f32_16x16x32_bf16 v[72:75], a[236:239], a[212:215], v[72:75]
v_mfma_f32_16x16x32_bf16 v[76:79], a[236:239], v[164:167], v[76:79]
s_lshl_b32 s36, s23, 3
s_add_u32 s37, s36, s22
s_nop 3
v_cvt_pk_bf16_f32 v228, v32, v33
v_cvt_pk_bf16_f32 v229, v34, v35
v_cvt_pk_bf16_f32 v232, v36, v37
v_cvt_pk_bf16_f32 v233, v38, v39
v_cvt_pk_bf16_f32 v236, v40, v41
v_cvt_pk_bf16_f32 v237, v42, v43
v_cvt_pk_bf16_f32 v240, v44, v45
v_cvt_pk_bf16_f32 v241, v46, v47
v_cvt_pk_bf16_f32 v230, v48, v49
v_cvt_pk_bf16_f32 v231, v50, v51
buffer_store_dwordx4 v[228:231], v3, s[44:47], s60 offen sc1
s_cmp_eq_u32 s60, 0x40000000
s_cselect_b64 s[70:71], -1, 0
v_cndmask_b32 v172, v172, v228, s[70:71]
v_cndmask_b32 v173, v173, v229, s[70:71]
v_cndmask_b32 v174, v174, v230, s[70:71]
v_cndmask_b32 v175, v175, v231, s[70:71]
v_cvt_pk_bf16_f32 v234, v52, v53
v_cvt_pk_bf16_f32 v235, v54, v55
buffer_store_dwordx4 v[232:235], v3, s[44:47], s61 offen sc1
s_cmp_eq_u32 s61, 0x40000000
s_cselect_b64 s[68:69], -1, 0
v_cndmask_b32 v172, v172, v232, s[68:69]
v_cndmask_b32 v173, v173, v233, s[68:69]
v_cndmask_b32 v174, v174, v234, s[68:69]
v_cndmask_b32 v175, v175, v235, s[68:69]
v_cvt_pk_bf16_f32 v238, v56, v57
v_cvt_pk_bf16_f32 v239, v58, v59
buffer_store_dwordx4 v[236:239], v3, s[44:47], s62 offen sc1
s_cmp_eq_u32 s62, 0x40000000
s_cselect_b64 s[70:71], -1, 0
v_cndmask_b32 v172, v172, v236, s[70:71]
v_cndmask_b32 v173, v173, v237, s[70:71]
v_cndmask_b32 v174, v174, v238, s[70:71]
v_cndmask_b32 v175, v175, v239, s[70:71]
v_cvt_pk_bf16_f32 v242, v60, v61
v_cvt_pk_bf16_f32 v243, v62, v63
buffer_store_dwordx4 v[240:243], v3, s[44:47], s63 offen sc1
s_cmp_eq_u32 s63, 0x40000000
s_cselect_b64 s[68:69], -1, 0
v_cndmask_b32 v172, v172, v240, s[68:69]
v_cndmask_b32 v173, v173, v241, s[68:69]
v_cndmask_b32 v174, v174, v242, s[68:69]
v_cndmask_b32 v175, v175, v243, s[68:69]
v_cvt_pk_bf16_f32 v228, v64, v65
v_cvt_pk_bf16_f32 v229, v66, v67
v_cvt_pk_bf16_f32 v230, v68, v69
v_cvt_pk_bf16_f32 v231, v70, v71
buffer_store_dwordx4 v[228:231], v3, s[44:47], s64 offen sc1
s_cmp_eq_u32 s64, 0x40000000
s_cselect_b64 s[70:71], -1, 0
v_cndmask_b32 v176, v176, v228, s[70:71]
v_cndmask_b32 v177, v177, v229, s[70:71]
v_cndmask_b32 v178, v178, v230, s[70:71]
v_cndmask_b32 v179, v179, v231, s[70:71]
v_cvt_pk_bf16_f32 v236, v72, v73
v_cvt_pk_bf16_f32 v237, v74, v75
v_cvt_pk_bf16_f32 v238, v76, v77
v_cvt_pk_bf16_f32 v239, v78, v79
buffer_store_dwordx4 v[236:239], v3, s[44:47], s65 offen sc1
s_cmp_eq_u32 s65, 0x40000000
s_cselect_b64 s[70:71], -1, 0
v_cndmask_b32 v176, v176, v236, s[70:71]
v_cndmask_b32 v177, v177, v237, s[70:71]
v_cndmask_b32 v178, v178, v238, s[70:71]
v_cndmask_b32 v179, v179, v239, s[70:71]
s_lshl_b32 s36, s23, 3
v_min_u32 v6, 7, v2
v_add_u32 v6, s36, v6
v_lshlrev_b32 v6, 6, v6
v_add_u32 v6, 39059456, v6
v_and_b32 v128, 15, v2
v_lshrrev_b32 v135, 4, v2
v_bfe_u32 v136, v2, 2, 2
v_and_b32 v137, 3, v2
v_lshlrev_b32 v137, 3, v137
v_lshl_add_u32 v129, v135, 3, v136
v_lshl_add_u32 v129, v129, 7, v137
v_lshl_add_u32 v130, v135, 2, v136
v_lshl_add_u32 v130, v130, 7, v137
v_lshrrev_b32 v136, 1, v136
v_and_b32 v137, 1, v135
v_lshl_or_b32 v131, v137, 1, v136
v_lshrrev_b32 v137, 1, v135
v_lshl_or_b32 v132, v137, 1, v136
s_lshl_b32 s36, s23, 6
v_add_u32 v128, s36, v128
v_mul_u32_u24 v128, 1152, v128
v_lshlrev_b32 v133, 4, v135
v_lshlrev_b32 v134, 3, v135
s_mul_i32 s43, s23, 73728
s_mov_b32 s36, s20
s_add_u32 s39, s22, 0
s_mul_i32 s42, s36, 18
s_add_u32 s42, s42, s39
s_lshl_b32 s42, s42, 10
s_add_u32 s48, s42, s43
s_lshr_b32 s38, s39, 2
s_lshl_b32 s38, s38, 5
s_mul_i32 s42, s36, 144
s_add_u32 s38, s38, s42
s_sub_u32 s42, s39, 16
s_lshl_b32 s42, s42, 1
s_and_b32 s73, s36, 1
s_xor_b32 s42, s42, s73
s_and_b32 s73, s39, 3
s_cmp_ge_u32 s39, 16
s_cselect_b32 s42, s42, s73
s_cselect_b64 s[70:71], -1, 0
v_cndmask_b32 v139, v131, v132, s[70:71]
v_cndmask_b32 v140, v129, v130, s[70:71]
v_xor_b32 v139, s42, v139
v_lshl_add_u32 v139, v139, 5, v140
s_lshl_b32 s73, s38, 7
v_add_u32 v8, s73, v139
v_add_u32 v139, 512, v8
v_xor_b32 v140, 32, v8
v_cndmask_b32 v9, v139, v140, s[70:71]
v_cndmask_b32 v139, v133, v134, s[70:71]
s_mul_i32 s73, s42, 18432
s_lshl_b32 s38, s38, 1
s_add_u32 s73, s73, s38
v_add3_u32 v10, v128, v139, s73
s_and_b32 s42, s42, 1
s_mul_i32 s42, s42, 4294930432
s_add_u32 s42, s42, 18432
s_cmp_ge_u32 s39, 16
s_cselect_b32 s42, s42, 8
v_add_u32 v11, s42, v10
ds_read_b64_tr_b16 v[216:217], v8
ds_read_b64_tr_b16 v[218:219], v9
s_mov_b32 s36, s20
s_add_u32 s39, s22, 8
s_mul_i32 s42, s36, 18
s_add_u32 s42, s42, s39
s_lshl_b32 s42, s42, 10
s_add_u32 s49, s42, s43
s_lshr_b32 s38, s39, 2
s_lshl_b32 s38, s38, 5
s_mul_i32 s42, s36, 144
s_add_u32 s38, s38, s42
s_sub_u32 s42, s39, 16
s_lshl_b32 s42, s42, 1
s_and_b32 s73, s36, 1
s_xor_b32 s42, s42, s73
s_and_b32 s73, s39, 3
s_cmp_ge_u32 s39, 16
s_cselect_b32 s42, s42, s73
s_cselect_b64 s[70:71], -1, 0
v_cndmask_b32 v139, v131, v132, s[70:71]
v_cndmask_b32 v140, v129, v130, s[70:71]
v_xor_b32 v139, s42, v139
v_lshl_add_u32 v139, v139, 5, v140
s_lshl_b32 s73, s38, 7
v_add_u32 v12, s73, v139
v_add_u32 v139, 512, v12
v_xor_b32 v140, 32, v12
v_cndmask_b32 v13, v139, v140, s[70:71]
v_cndmask_b32 v139, v133, v134, s[70:71]
s_mul_i32 s73, s42, 18432
s_lshl_b32 s38, s38, 1
s_add_u32 s73, s73, s38
v_add3_u32 v14, v128, v139, s73
s_and_b32 s42, s42, 1
s_mul_i32 s42, s42, 4294930432
s_add_u32 s42, s42, 18432
s_cmp_ge_u32 s39, 16
s_cselect_b32 s42, s42, 8
v_add_u32 v15, s42, v14
ds_read_b64_tr_b16 v[220:221], v12
ds_read_b64_tr_b16 v[222:223], v13
s_mov_b32 s36, s20
s_and_b32 s39, s22, 1
s_add_u32 s39, s39, 16
s_mul_i32 s42, s36, 18
s_add_u32 s42, s42, s39
s_lshl_b32 s42, s42, 10
s_add_u32 s50, s42, s43
s_lshr_b32 s38, s39, 2
s_lshl_b32 s38, s38, 5
s_mul_i32 s42, s36, 144
s_add_u32 s38, s38, s42
s_sub_u32 s42, s39, 16
s_lshl_b32 s42, s42, 1
s_and_b32 s73, s36, 1
s_xor_b32 s42, s42, s73
s_and_b32 s73, s39, 3
s_cmp_ge_u32 s39, 16
s_cselect_b32 s42, s42, s73
s_cselect_b64 s[70:71], -1, 0
v_cndmask_b32 v139, v131, v132, s[70:71]
v_cndmask_b32 v140, v129, v130, s[70:71]
v_xor_b32 v139, s42, v139
v_lshl_add_u32 v139, v139, 5, v140
s_lshl_b32 s73, s38, 7
v_add_u32 v20, s73, v139
v_add_u32 v139, 512, v20
v_xor_b32 v140, 32, v20
v_cndmask_b32 v21, v139, v140, s[70:71]
v_cndmask_b32 v139, v133, v134, s[70:71]
s_mul_i32 s73, s42, 18432
s_lshl_b32 s38, s38, 1
s_add_u32 s73, s73, s38
v_add3_u32 v22, v128, v139, s73
s_and_b32 s42, s42, 1
s_mul_i32 s42, s42, 4294930432
s_add_u32 s42, s42, 18432
s_cmp_ge_u32 s39, 16
s_cselect_b32 s42, s42, 8
v_add_u32 v23, s42, v22
ds_read_b64_tr_b16 v[224:225], v20
ds_read_b64_tr_b16 v[226:227], v21
s_mov_b32 s32, s18
s_and_b32 s33, s19, 0xffff
s_mov_b32 s34, 2359296
s_mov_b32 s35, 0x20000
s_mov_b32 s38, 0x00003f80
s_mov_b32 s39, 0x3f800000
s_mov_b32 s42, 0x3f317218
s_waitcnt vmcnt(0) lgkmcnt(0)
s_barrier
s_cmp_lg_u32 s20, 0
s_cbranch_scc1 fused_kernel_nf4
s_lshl_b32 s78, s37, 6
s_add_u32 s78, s78, 39059456
v_mov_b32 v30, s78
v_mov_b32 v31, s76
s_mov_b64 exec, 1
global_store_dword v30, v31, s[16:17] sc1
s_mov_b64 exec, -1
fused_kernel_nf4:
s_mov_b32 s77, 400000
fused_kernel_pm7:
global_load_dword v4, v6, s[16:17] sc1
s_waitcnt vmcnt(0)
v_cmp_ne_u32 vcc, s76, v4
s_sub_u32 s77, s77, 1
s_cselect_b64 vcc, 0, vcc
s_cmp_eq_u64 vcc, 0
s_cbranch_scc1 fused_kernel_pmd7
s_mov_b64 exec, vcc
s_branch fused_kernel_pm7
fused_kernel_pmd7:
s_mov_b64 exec, -1
s_or_b32 s36, s2, s20
s_cmp_lg_u32 s36, 0
s_cbranch_scc1 fused_kernel_noep
v_mov_b32 v24, 7241728
v_mov_b32 v25, s76
s_mov_b64 exec, 1
global_store_dword v24, v25, s[16:17] sc1
s_mov_b64 exec, -1
fused_kernel_noep:
s_lshr_b32 s36, s22, 1
s_cmp_eq_u32 s36, s20
s_cbranch_scc1 fused_kernel_three7
s_add_u32 s36, s22, 1
s_and_b32 s36, s36, 7
s_mul_i32 s36, s36, 2359296
s_add_u32 s36, s36, s48
buffer_load_dwordx4 v[36:39], v3, s[44:47], s36 offen sc1
s_add_u32 s36, s22, 2
s_and_b32 s36, s36, 7
s_mul_i32 s36, s36, 2359296
s_add_u32 s36, s36, s48
buffer_load_dwordx4 v[40:43], v3, s[44:47], s36 offen sc1
s_add_u32 s36, s22, 3
s_and_b32 s36, s36, 7
s_mul_i32 s36, s36, 2359296
s_add_u32 s36, s36, s48
buffer_load_dwordx4 v[44:47], v3, s[44:47], s36 offen sc1
s_add_u32 s36, s22, 4
s_and_b32 s36, s36, 7
s_mul_i32 s36, s36, 2359296
s_add_u32 s36, s36, s48
buffer_load_dwordx4 v[48:51], v3, s[44:47], s36 offen sc1
s_add_u32 s36, s22, 5
s_and_b32 s36, s36, 7
s_mul_i32 s36, s36, 2359296
s_add_u32 s36, s36, s48
buffer_load_dwordx4 v[52:55], v3, s[44:47], s36 offen sc1
s_add_u32 s36, s22, 6
s_and_b32 s36, s36, 7
s_mul_i32 s36, s36, 2359296
s_add_u32 s36, s36, s48
buffer_load_dwordx4 v[56:59], v3, s[44:47], s36 offen sc1
s_add_u32 s36, s22, 7
s_and_b32 s36, s36, 7
s_mul_i32 s36, s36, 2359296
s_add_u32 s36, s36, s48
buffer_load_dwordx4 v[60:63], v3, s[44:47], s36 offen sc1
s_add_u32 s36, s22, 1
s_and_b32 s36, s36, 7
s_mul_i32 s36, s36, 2359296
s_add_u32 s36, s36, s49
buffer_load_dwordx4 v[68:71], v3, s[44:47], s36 offen sc1
s_add_u32 s36, s22, 2
s_and_b32 s36, s36, 7
s_mul_i32 s36, s36, 2359296
s_add_u32 s36, s36, s49
buffer_load_dwordx4 v[72:75], v3, s[44:47], s36 offen sc1
s_add_u32 s36, s22, 3
s_and_b32 s36, s36, 7
s_mul_i32 s36, s36, 2359296
s_add_u32 s36, s36, s49
buffer_load_dwordx4 v[76:79], v3, s[44:47], s36 offen sc1
s_add_u32 s36, s22, 4
s_and_b32 s36, s36, 7
s_mul_i32 s36, s36, 2359296
s_add_u32 s36, s36, s49
buffer_load_dwordx4 v[80:83], v3, s[44:47], s36 offen sc1
s_add_u32 s36, s22, 5
s_and_b32 s36, s36, 7
s_mul_i32 s36, s36, 2359296
s_add_u32 s36, s36, s49
buffer_load_dwordx4 v[84:87], v3, s[44:47], s36 offen sc1
s_add_u32 s36, s22, 6
s_and_b32 s36, s36, 7
s_mul_i32 s36, s36, 2359296
s_add_u32 s36, s36, s49
buffer_load_dwordx4 v[88:91], v3, s[44:47], s36 offen sc1
s_add_u32 s36, s22, 7
s_and_b32 s36, s36, 7
s_mul_i32 s36, s36, 2359296
s_add_u32 s36, s36, s49
buffer_load_dwordx4 v[92:95], v3, s[44:47], s36 offen sc1
v_dot2_f32_bf16 v144, v168, s38, 0
v_dot2_f32_bf16 v145, v168, s39, 0
v_dot2_f32_bf16 v146, v169, s38, 0
v_dot2_f32_bf16 v147, v169, s39, 0
v_dot2_f32_bf16 v148, v170, s38, 0
v_dot2_f32_bf16 v149, v170, s39, 0
v_dot2_f32_bf16 v150, v171, s38, 0
v_dot2_f32_bf16 v151, v171, s39, 0
s_waitcnt vmcnt(13)
v_dot2_f32_bf16 v144, v36, s38, v144
v_dot2_f32_bf16 v145, v36, s39, v145
v_dot2_f32_bf16 v146, v37, s38, v146
v_dot2_f32_bf16 v147, v37, s39, v147
v_dot2_f32_bf16 v148, v38, s38, v148
v_dot2_f32_bf16 v149, v38, s39, v149
v_dot2_f32_bf16 v150, v39, s38, v150
v_dot2_f32_bf16 v151, v39, s39, v151
s_waitcnt vmcnt(12)
v_dot2_f32_bf16 v144, v40, s38, v144
v_dot2_f32_bf16 v145, v40, s39, v145
v_dot2_f32_bf16 v146, v41, s38, v146
v_dot2_f32_bf16 v147, v41, s39, v147
v_dot2_f32_bf16 v148, v42, s38, v148
v_dot2_f32_bf16 v149, v42, s39, v149
v_dot2_f32_bf16 v150, v43, s38, v150
v_dot2_f32_bf16 v151, v43, s39, v151
s_waitcnt vmcnt(11)
v_dot2_f32_bf16 v144, v44, s38, v144
v_dot2_f32_bf16 v145, v44, s39, v145
v_dot2_f32_bf16 v146, v45, s38, v146
v_dot2_f32_bf16 v147, v45, s39, v147
v_dot2_f32_bf16 v148, v46, s38, v148
v_dot2_f32_bf16 v149, v46, s39, v149
v_dot2_f32_bf16 v150, v47, s38, v150
v_dot2_f32_bf16 v151, v47, s39, v151
s_waitcnt vmcnt(10)
v_dot2_f32_bf16 v144, v48, s38, v144
v_dot2_f32_bf16 v145, v48, s39, v145
v_dot2_f32_bf16 v146, v49, s38, v146
v_dot2_f32_bf16 v147, v49, s39, v147
v_dot2_f32_bf16 v148, v50, s38, v148
v_dot2_f32_bf16 v149, v50, s39, v149
v_dot2_f32_bf16 v150, v51, s38, v150
v_dot2_f32_bf16 v151, v51, s39, v151
s_waitcnt vmcnt(9)
v_dot2_f32_bf16 v144, v52, s38, v144
v_dot2_f32_bf16 v145, v52, s39, v145
v_dot2_f32_bf16 v146, v53, s38, v146
v_dot2_f32_bf16 v147, v53, s39, v147
v_dot2_f32_bf16 v148, v54, s38, v148
v_dot2_f32_bf16 v149, v54, s39, v149
v_dot2_f32_bf16 v150, v55, s38, v150
v_dot2_f32_bf16 v151, v55, s39, v151
s_waitcnt vmcnt(8)
v_dot2_f32_bf16 v144, v56, s38, v144
v_dot2_f32_bf16 v145, v56, s39, v145
v_dot2_f32_bf16 v146, v57, s38, v146
v_dot2_f32_bf16 v147, v57, s39, v147
v_dot2_f32_bf16 v148, v58, s38, v148
v_dot2_f32_bf16 v149, v58, s39, v149
v_dot2_f32_bf16 v150, v59, s38, v150
v_dot2_f32_bf16 v151, v59, s39, v151
s_waitcnt vmcnt(7)
v_dot2_f32_bf16 v144, v60, s38, v144
v_dot2_f32_bf16 v145, v60, s39, v145
v_dot2_f32_bf16 v146, v61, s38, v146
v_dot2_f32_bf16 v147, v61, s39, v147
v_dot2_f32_bf16 v148, v62, s38, v148
v_dot2_f32_bf16 v149, v62, s39, v149
v_dot2_f32_bf16 v150, v63, s38, v150
v_dot2_f32_bf16 v151, v63, s39, v151
v_lshlrev_b32 v152, 16, v216
v_and_b32 v153, 0xffff0000, v216
v_lshlrev_b32 v154, 16, v217
v_and_b32 v155, 0xffff0000, v217
v_lshlrev_b32 v156, 16, v218
v_and_b32 v157, 0xffff0000, v218
v_lshlrev_b32 v158, 16, v219
v_and_b32 v159, 0xffff0000, v219
v_fma_f32 v144, v144, s42, v152
v_fma_f32 v145, v145, s42, v153
v_fma_f32 v146, v146, s42, v154
v_fma_f32 v147, v147, s42, v155
v_fma_f32 v148, v148, s42, v156
v_fma_f32 v149, v149, s42, v157
v_fma_f32 v150, v150, s42, v158
v_fma_f32 v151, v151, s42, v159
v_cvt_pk_bf16_f32 v216, v144, v145
v_cvt_pk_bf16_f32 v217, v146, v147
v_cvt_pk_bf16_f32 v218, v148, v149
v_cvt_pk_bf16_f32 v219, v150, v151
buffer_store_dwordx4 v[216:219], v10, s[32:35], 0 offen sc1
v_dot2_f32_bf16 v144, v172, s38, 0
v_dot2_f32_bf16 v145, v172, s39, 0
v_dot2_f32_bf16 v146, v173, s38, 0
v_dot2_f32_bf16 v147, v173, s39, 0
v_dot2_f32_bf16 v148, v174, s38, 0
v_dot2_f32_bf16 v149, v174, s39, 0
v_dot2_f32_bf16 v150, v175, s38, 0
v_dot2_f32_bf16 v151, v175, s39, 0
s_waitcnt vmcnt(7)
v_dot2_f32_bf16 v144, v68, s38, v144
v_dot2_f32_bf16 v145, v68, s39, v145
v_dot2_f32_bf16 v146, v69, s38, v146
v_dot2_f32_bf16 v147, v69, s39, v147
v_dot2_f32_bf16 v148, v70, s38, v148
v_dot2_f32_bf16 v149, v70, s39, v149
v_dot2_f32_bf16 v150, v71, s38, v150
v_dot2_f32_bf16 v151, v71, s39, v151
s_waitcnt vmcnt(6)
v_dot2_f32_bf16 v144, v72, s38, v144
v_dot2_f32_bf16 v145, v72, s39, v145
v_dot2_f32_bf16 v146, v73, s38, v146
v_dot2_f32_bf16 v147, v73, s39, v147
v_dot2_f32_bf16 v148, v74, s38, v148
v_dot2_f32_bf16 v149, v74, s39, v149
v_dot2_f32_bf16 v150, v75, s38, v150
v_dot2_f32_bf16 v151, v75, s39, v151
s_waitcnt vmcnt(5)
v_dot2_f32_bf16 v144, v76, s38, v144
v_dot2_f32_bf16 v145, v76, s39, v145
v_dot2_f32_bf16 v146, v77, s38, v146
v_dot2_f32_bf16 v147, v77, s39, v147
v_dot2_f32_bf16 v148, v78, s38, v148
v_dot2_f32_bf16 v149, v78, s39, v149
v_dot2_f32_bf16 v150, v79, s38, v150
v_dot2_f32_bf16 v151, v79, s39, v151
s_waitcnt vmcnt(4)
v_dot2_f32_bf16 v144, v80, s38, v144
v_dot2_f32_bf16 v145, v80, s39, v145
v_dot2_f32_bf16 v146, v81, s38, v146
v_dot2_f32_bf16 v147, v81, s39, v147
v_dot2_f32_bf16 v148, v82, s38, v148
v_dot2_f32_bf16 v149, v82, s39, v149
v_dot2_f32_bf16 v150, v83, s38, v150
v_dot2_f32_bf16 v151, v83, s39, v151
s_waitcnt vmcnt(3)
v_dot2_f32_bf16 v144, v84, s38, v144
v_dot2_f32_bf16 v145, v84, s39, v145
v_dot2_f32_bf16 v146, v85, s38, v146
v_dot2_f32_bf16 v147, v85, s39, v147
v_dot2_f32_bf16 v148, v86, s38, v148
v_dot2_f32_bf16 v149, v86, s39, v149
v_dot2_f32_bf16 v150, v87, s38, v150
v_dot2_f32_bf16 v151, v87, s39, v151
s_waitcnt vmcnt(2)
v_dot2_f32_bf16 v144, v88, s38, v144
v_dot2_f32_bf16 v145, v88, s39, v145
v_dot2_f32_bf16 v146, v89, s38, v146
v_dot2_f32_bf16 v147, v89, s39, v147
v_dot2_f32_bf16 v148, v90, s38, v148
v_dot2_f32_bf16 v149, v90, s39, v149
v_dot2_f32_bf16 v150, v91, s38, v150
v_dot2_f32_bf16 v151, v91, s39, v151
s_waitcnt vmcnt(1)
v_dot2_f32_bf16 v144, v92, s38, v144
v_dot2_f32_bf16 v145, v92, s39, v145
v_dot2_f32_bf16 v146, v93, s38, v146
v_dot2_f32_bf16 v147, v93, s39, v147
v_dot2_f32_bf16 v148, v94, s38, v148
v_dot2_f32_bf16 v149, v94, s39, v149
v_dot2_f32_bf16 v150, v95, s38, v150
v_dot2_f32_bf16 v151, v95, s39, v151
v_lshlrev_b32 v152, 16, v220
v_and_b32 v153, 0xffff0000, v220
v_lshlrev_b32 v154, 16, v221
v_and_b32 v155, 0xffff0000, v221
v_lshlrev_b32 v156, 16, v222
v_and_b32 v157, 0xffff0000, v222
v_lshlrev_b32 v158, 16, v223
v_and_b32 v159, 0xffff0000, v223
v_fma_f32 v144, v144, s42, v152
v_fma_f32 v145, v145, s42, v153
v_fma_f32 v146, v146, s42, v154
v_fma_f32 v147, v147, s42, v155
v_fma_f32 v148, v148, s42, v156
v_fma_f32 v149, v149, s42, v157
v_fma_f32 v150, v150, s42, v158
v_fma_f32 v151, v151, s42, v159
v_cvt_pk_bf16_f32 v220, v144, v145
v_cvt_pk_bf16_f32 v221, v146, v147
v_cvt_pk_bf16_f32 v222, v148, v149
v_cvt_pk_bf16_f32 v223, v150, v151
buffer_store_dwordx4 v[220:223], v14, s[32:35], 0 offen sc1
s_branch fused_kernel_fin
fused_kernel_three7:
s_add_u32 s36, s22, 1
s_and_b32 s36, s36, 7
s_mul_i32 s36, s36, 2359296
s_add_u32 s36, s36, s48
buffer_load_dwordx4 v[36:39], v3, s[44:47], s36 offen sc1
s_add_u32 s36, s22, 2
s_and_b32 s36, s36, 7
s_mul_i32 s36, s36, 2359296
s_add_u32 s36, s36, s48
buffer_load_dwordx4 v[40:43], v3, s[44:47], s36 offen sc1
s_add_u32 s36, s22, 3
s_and_b32 s36, s36, 7
s_mul_i32 s36, s36, 2359296
s_add_u32 s36, s36, s48
buffer_load_dwordx4 v[44:47], v3, s[44:47], s36 offen sc1
s_add_u32 s36, s22, 4
s_and_b32 s36, s36, 7
s_mul_i32 s36, s36, 2359296
s_add_u32 s36, s36, s48
buffer_load_dwordx4 v[48:51], v3, s[44:47], s36 offen sc1
s_add_u32 s36, s22, 5
s_and_b32 s36, s36, 7
s_mul_i32 s36, s36, 2359296
s_add_u32 s36, s36, s48
buffer_load_dwordx4 v[52:55], v3, s[44:47], s36 offen sc1
s_add_u32 s36, s22, 6
s_and_b32 s36, s36, 7
s_mul_i32 s36, s36, 2359296
s_add_u32 s36, s36, s48
buffer_load_dwordx4 v[56:59], v3, s[44:47], s36 offen sc1
s_add_u32 s36, s22, 7
s_and_b32 s36, s36, 7
s_mul_i32 s36, s36, 2359296
s_add_u32 s36, s36, s48
buffer_load_dwordx4 v[60:63], v3, s[44:47], s36 offen sc1
s_add_u32 s36, s22, 1
s_and_b32 s36, s36, 7
s_mul_i32 s36, s36, 2359296
s_add_u32 s36, s36, s49
buffer_load_dwordx4 v[68:71], v3, s[44:47], s36 offen sc1
s_add_u32 s36, s22, 2
s_and_b32 s36, s36, 7
s_mul_i32 s36, s36, 2359296
s_add_u32 s36, s36, s49
buffer_load_dwordx4 v[72:75], v3, s[44:47], s36 offen sc1
s_add_u32 s36, s22, 3
s_and_b32 s36, s36, 7
s_mul_i32 s36, s36, 2359296
s_add_u32 s36, s36, s49
buffer_load_dwordx4 v[76:79], v3, s[44:47], s36 offen sc1
s_add_u32 s36, s22, 4
s_and_b32 s36, s36, 7
s_mul_i32 s36, s36, 2359296
s_add_u32 s36, s36, s49
buffer_load_dwordx4 v[80:83], v3, s[44:47], s36 offen sc1
s_add_u32 s36, s22, 5
s_and_b32 s36, s36, 7
s_mul_i32 s36, s36, 2359296
s_add_u32 s36, s36, s49
buffer_load_dwordx4 v[84:87], v3, s[44:47], s36 offen sc1
s_add_u32 s36, s22, 6
s_and_b32 s36, s36, 7
s_mul_i32 s36, s36, 2359296
s_add_u32 s36, s36, s49
buffer_load_dwordx4 v[88:91], v3, s[44:47], s36 offen sc1
s_add_u32 s36, s22, 7
s_and_b32 s36, s36, 7
s_mul_i32 s36, s36, 2359296
s_add_u32 s36, s36, s49
buffer_load_dwordx4 v[92:95], v3, s[44:47], s36 offen sc1
s_add_u32 s36, s22, 1
s_and_b32 s36, s36, 7
s_mul_i32 s36, s36, 2359296
s_add_u32 s36, s36, s50
buffer_load_dwordx4 v[100:103], v3, s[44:47], s36 offen sc1
s_add_u32 s36, s22, 2
s_and_b32 s36, s36, 7
s_mul_i32 s36, s36, 2359296
s_add_u32 s36, s36, s50
buffer_load_dwordx4 v[104:107], v3, s[44:47], s36 offen sc1
s_add_u32 s36, s22, 3
s_and_b32 s36, s36, 7
s_mul_i32 s36, s36, 2359296
s_add_u32 s36, s36, s50
buffer_load_dwordx4 v[108:111], v3, s[44:47], s36 offen sc1
s_add_u32 s36, s22, 4
s_and_b32 s36, s36, 7
s_mul_i32 s36, s36, 2359296
s_add_u32 s36, s36, s50
buffer_load_dwordx4 v[112:115], v3, s[44:47], s36 offen sc1
s_add_u32 s36, s22, 5
s_and_b32 s36, s36, 7
s_mul_i32 s36, s36, 2359296
s_add_u32 s36, s36, s50
buffer_load_dwordx4 v[116:119], v3, s[44:47], s36 offen sc1
s_add_u32 s36, s22, 6
s_and_b32 s36, s36, 7
s_mul_i32 s36, s36, 2359296
s_add_u32 s36, s36, s50
buffer_load_dwordx4 v[120:123], v3, s[44:47], s36 offen sc1
s_add_u32 s36, s22, 7
s_and_b32 s36, s36, 7
s_mul_i32 s36, s36, 2359296
s_add_u32 s36, s36, s50
buffer_load_dwordx4 v[124:127], v3, s[44:47], s36 offen sc1
v_dot2_f32_bf16 v144, v168, s38, 0
v_dot2_f32_bf16 v145, v168, s39, 0
v_dot2_f32_bf16 v146, v169, s38, 0
v_dot2_f32_bf16 v147, v169, s39, 0
v_dot2_f32_bf16 v148, v170, s38, 0
v_dot2_f32_bf16 v149, v170, s39, 0
v_dot2_f32_bf16 v150, v171, s38, 0
v_dot2_f32_bf16 v151, v171, s39, 0
s_waitcnt vmcnt(20)
v_dot2_f32_bf16 v144, v36, s38, v144
v_dot2_f32_bf16 v145, v36, s39, v145
v_dot2_f32_bf16 v146, v37, s38, v146
v_dot2_f32_bf16 v147, v37, s39, v147
v_dot2_f32_bf16 v148, v38, s38, v148
v_dot2_f32_bf16 v149, v38, s39, v149
v_dot2_f32_bf16 v150, v39, s38, v150
v_dot2_f32_bf16 v151, v39, s39, v151
s_waitcnt vmcnt(19)
v_dot2_f32_bf16 v144, v40, s38, v144
v_dot2_f32_bf16 v145, v40, s39, v145
v_dot2_f32_bf16 v146, v41, s38, v146
v_dot2_f32_bf16 v147, v41, s39, v147
v_dot2_f32_bf16 v148, v42, s38, v148
v_dot2_f32_bf16 v149, v42, s39, v149
v_dot2_f32_bf16 v150, v43, s38, v150
v_dot2_f32_bf16 v151, v43, s39, v151
s_waitcnt vmcnt(18)
v_dot2_f32_bf16 v144, v44, s38, v144
v_dot2_f32_bf16 v145, v44, s39, v145
v_dot2_f32_bf16 v146, v45, s38, v146
v_dot2_f32_bf16 v147, v45, s39, v147
v_dot2_f32_bf16 v148, v46, s38, v148
v_dot2_f32_bf16 v149, v46, s39, v149
v_dot2_f32_bf16 v150, v47, s38, v150
v_dot2_f32_bf16 v151, v47, s39, v151
s_waitcnt vmcnt(17)
v_dot2_f32_bf16 v144, v48, s38, v144
v_dot2_f32_bf16 v145, v48, s39, v145
v_dot2_f32_bf16 v146, v49, s38, v146
v_dot2_f32_bf16 v147, v49, s39, v147
v_dot2_f32_bf16 v148, v50, s38, v148
v_dot2_f32_bf16 v149, v50, s39, v149
v_dot2_f32_bf16 v150, v51, s38, v150
v_dot2_f32_bf16 v151, v51, s39, v151
s_waitcnt vmcnt(16)
v_dot2_f32_bf16 v144, v52, s38, v144
v_dot2_f32_bf16 v145, v52, s39, v145
v_dot2_f32_bf16 v146, v53, s38, v146
v_dot2_f32_bf16 v147, v53, s39, v147
v_dot2_f32_bf16 v148, v54, s38, v148
v_dot2_f32_bf16 v149, v54, s39, v149
v_dot2_f32_bf16 v150, v55, s38, v150
v_dot2_f32_bf16 v151, v55, s39, v151
s_waitcnt vmcnt(15)
v_dot2_f32_bf16 v144, v56, s38, v144
v_dot2_f32_bf16 v145, v56, s39, v145
v_dot2_f32_bf16 v146, v57, s38, v146
v_dot2_f32_bf16 v147, v57, s39, v147
v_dot2_f32_bf16 v148, v58, s38, v148
v_dot2_f32_bf16 v149, v58, s39, v149
v_dot2_f32_bf16 v150, v59, s38, v150
v_dot2_f32_bf16 v151, v59, s39, v151
s_waitcnt vmcnt(14)
v_dot2_f32_bf16 v144, v60, s38, v144
v_dot2_f32_bf16 v145, v60, s39, v145
v_dot2_f32_bf16 v146, v61, s38, v146
v_dot2_f32_bf16 v147, v61, s39, v147
v_dot2_f32_bf16 v148, v62, s38, v148
v_dot2_f32_bf16 v149, v62, s39, v149
v_dot2_f32_bf16 v150, v63, s38, v150
v_dot2_f32_bf16 v151, v63, s39, v151
v_lshlrev_b32 v152, 16, v216
v_and_b32 v153, 0xffff0000, v216
v_lshlrev_b32 v154, 16, v217
v_and_b32 v155, 0xffff0000, v217
v_lshlrev_b32 v156, 16, v218
v_and_b32 v157, 0xffff0000, v218
v_lshlrev_b32 v158, 16, v219
v_and_b32 v159, 0xffff0000, v219
v_fma_f32 v144, v144, s42, v152
v_fma_f32 v145, v145, s42, v153
v_fma_f32 v146, v146, s42, v154
v_fma_f32 v147, v147, s42, v155
v_fma_f32 v148, v148, s42, v156
v_fma_f32 v149, v149, s42, v157
v_fma_f32 v150, v150, s42, v158
v_fma_f32 v151, v151, s42, v159
v_cvt_pk_bf16_f32 v216, v144, v145
v_cvt_pk_bf16_f32 v217, v146, v147
v_cvt_pk_bf16_f32 v218, v148, v149
v_cvt_pk_bf16_f32 v219, v150, v151
buffer_store_dwordx4 v[216:219], v10, s[32:35], 0 offen sc1
v_dot2_f32_bf16 v144, v172, s38, 0
v_dot2_f32_bf16 v145, v172, s39, 0
v_dot2_f32_bf16 v146, v173, s38, 0
v_dot2_f32_bf16 v147, v173, s39, 0
v_dot2_f32_bf16 v148, v174, s38, 0
v_dot2_f32_bf16 v149, v174, s39, 0
v_dot2_f32_bf16 v150, v175, s38, 0
v_dot2_f32_bf16 v151, v175, s39, 0
s_waitcnt vmcnt(14)
v_dot2_f32_bf16 v144, v68, s38, v144
v_dot2_f32_bf16 v145, v68, s39, v145
v_dot2_f32_bf16 v146, v69, s38, v146
v_dot2_f32_bf16 v147, v69, s39, v147
v_dot2_f32_bf16 v148, v70, s38, v148
v_dot2_f32_bf16 v149, v70, s39, v149
v_dot2_f32_bf16 v150, v71, s38, v150
v_dot2_f32_bf16 v151, v71, s39, v151
s_waitcnt vmcnt(13)
v_dot2_f32_bf16 v144, v72, s38, v144
v_dot2_f32_bf16 v145, v72, s39, v145
v_dot2_f32_bf16 v146, v73, s38, v146
v_dot2_f32_bf16 v147, v73, s39, v147
v_dot2_f32_bf16 v148, v74, s38, v148
v_dot2_f32_bf16 v149, v74, s39, v149
v_dot2_f32_bf16 v150, v75, s38, v150
v_dot2_f32_bf16 v151, v75, s39, v151
s_waitcnt vmcnt(12)
v_dot2_f32_bf16 v144, v76, s38, v144
v_dot2_f32_bf16 v145, v76, s39, v145
v_dot2_f32_bf16 v146, v77, s38, v146
v_dot2_f32_bf16 v147, v77, s39, v147
v_dot2_f32_bf16 v148, v78, s38, v148
v_dot2_f32_bf16 v149, v78, s39, v149
v_dot2_f32_bf16 v150, v79, s38, v150
v_dot2_f32_bf16 v151, v79, s39, v151
s_waitcnt vmcnt(11)
v_dot2_f32_bf16 v144, v80, s38, v144
v_dot2_f32_bf16 v145, v80, s39, v145
v_dot2_f32_bf16 v146, v81, s38, v146
v_dot2_f32_bf16 v147, v81, s39, v147
v_dot2_f32_bf16 v148, v82, s38, v148
v_dot2_f32_bf16 v149, v82, s39, v149
v_dot2_f32_bf16 v150, v83, s38, v150
v_dot2_f32_bf16 v151, v83, s39, v151
s_waitcnt vmcnt(10)
v_dot2_f32_bf16 v144, v84, s38, v144
v_dot2_f32_bf16 v145, v84, s39, v145
v_dot2_f32_bf16 v146, v85, s38, v146
v_dot2_f32_bf16 v147, v85, s39, v147
v_dot2_f32_bf16 v148, v86, s38, v148
v_dot2_f32_bf16 v149, v86, s39, v149
v_dot2_f32_bf16 v150, v87, s38, v150
v_dot2_f32_bf16 v151, v87, s39, v151
s_waitcnt vmcnt(9)
v_dot2_f32_bf16 v144, v88, s38, v144
v_dot2_f32_bf16 v145, v88, s39, v145
v_dot2_f32_bf16 v146, v89, s38, v146
v_dot2_f32_bf16 v147, v89, s39, v147
v_dot2_f32_bf16 v148, v90, s38, v148
v_dot2_f32_bf16 v149, v90, s39, v149
v_dot2_f32_bf16 v150, v91, s38, v150
v_dot2_f32_bf16 v151, v91, s39, v151
s_waitcnt vmcnt(8)
v_dot2_f32_bf16 v144, v92, s38, v144
v_dot2_f32_bf16 v145, v92, s39, v145
v_dot2_f32_bf16 v146, v93, s38, v146
v_dot2_f32_bf16 v147, v93, s39, v147
v_dot2_f32_bf16 v148, v94, s38, v148
v_dot2_f32_bf16 v149, v94, s39, v149
v_dot2_f32_bf16 v150, v95, s38, v150
v_dot2_f32_bf16 v151, v95, s39, v151
v_lshlrev_b32 v152, 16, v220
v_and_b32 v153, 0xffff0000, v220
v_lshlrev_b32 v154, 16, v221
v_and_b32 v155, 0xffff0000, v221
v_lshlrev_b32 v156, 16, v222
v_and_b32 v157, 0xffff0000, v222
v_lshlrev_b32 v158, 16, v223
v_and_b32 v159, 0xffff0000, v223
v_fma_f32 v144, v144, s42, v152
v_fma_f32 v145, v145, s42, v153
v_fma_f32 v146, v146, s42, v154
v_fma_f32 v147, v147, s42, v155
v_fma_f32 v148, v148, s42, v156
v_fma_f32 v149, v149, s42, v157
v_fma_f32 v150, v150, s42, v158
v_fma_f32 v151, v151, s42, v159
v_cvt_pk_bf16_f32 v220, v144, v145
v_cvt_pk_bf16_f32 v221, v146, v147
v_cvt_pk_bf16_f32 v222, v148, v149
v_cvt_pk_bf16_f32 v223, v150, v151
buffer_store_dwordx4 v[220:223], v14, s[32:35], 0 offen sc1
v_dot2_f32_bf16 v144, v176, s38, 0
v_dot2_f32_bf16 v145, v176, s39, 0
v_dot2_f32_bf16 v146, v177, s38, 0
v_dot2_f32_bf16 v147, v177, s39, 0
v_dot2_f32_bf16 v148, v178, s38, 0
v_dot2_f32_bf16 v149, v178, s39, 0
v_dot2_f32_bf16 v150, v179, s38, 0
v_dot2_f32_bf16 v151, v179, s39, 0
s_waitcnt vmcnt(8)
v_dot2_f32_bf16 v144, v100, s38, v144
v_dot2_f32_bf16 v145, v100, s39, v145
v_dot2_f32_bf16 v146, v101, s38, v146
v_dot2_f32_bf16 v147, v101, s39, v147
v_dot2_f32_bf16 v148, v102, s38, v148
v_dot2_f32_bf16 v149, v102, s39, v149
v_dot2_f32_bf16 v150, v103, s38, v150
v_dot2_f32_bf16 v151, v103, s39, v151
s_waitcnt vmcnt(7)
v_dot2_f32_bf16 v144, v104, s38, v144
v_dot2_f32_bf16 v145, v104, s39, v145
v_dot2_f32_bf16 v146, v105, s38, v146
v_dot2_f32_bf16 v147, v105, s39, v147
v_dot2_f32_bf16 v148, v106, s38, v148
v_dot2_f32_bf16 v149, v106, s39, v149
v_dot2_f32_bf16 v150, v107, s38, v150
v_dot2_f32_bf16 v151, v107, s39, v151
s_waitcnt vmcnt(6)
v_dot2_f32_bf16 v144, v108, s38, v144
v_dot2_f32_bf16 v145, v108, s39, v145
v_dot2_f32_bf16 v146, v109, s38, v146
v_dot2_f32_bf16 v147, v109, s39, v147
v_dot2_f32_bf16 v148, v110, s38, v148
v_dot2_f32_bf16 v149, v110, s39, v149
v_dot2_f32_bf16 v150, v111, s38, v150
v_dot2_f32_bf16 v151, v111, s39, v151
s_waitcnt vmcnt(5)
v_dot2_f32_bf16 v144, v112, s38, v144
v_dot2_f32_bf16 v145, v112, s39, v145
v_dot2_f32_bf16 v146, v113, s38, v146
v_dot2_f32_bf16 v147, v113, s39, v147
v_dot2_f32_bf16 v148, v114, s38, v148
v_dot2_f32_bf16 v149, v114, s39, v149
v_dot2_f32_bf16 v150, v115, s38, v150
v_dot2_f32_bf16 v151, v115, s39, v151
s_waitcnt vmcnt(4)
v_dot2_f32_bf16 v144, v116, s38, v144
v_dot2_f32_bf16 v145, v116, s39, v145
v_dot2_f32_bf16 v146, v117, s38, v146
v_dot2_f32_bf16 v147, v117, s39, v147
v_dot2_f32_bf16 v148, v118, s38, v148
v_dot2_f32_bf16 v149, v118, s39, v149
v_dot2_f32_bf16 v150, v119, s38, v150
v_dot2_f32_bf16 v151, v119, s39, v151
s_waitcnt vmcnt(3)
v_dot2_f32_bf16 v144, v120, s38, v144
v_dot2_f32_bf16 v145, v120, s39, v145
v_dot2_f32_bf16 v146, v121, s38, v146
v_dot2_f32_bf16 v147, v121, s39, v147
v_dot2_f32_bf16 v148, v122, s38, v148
v_dot2_f32_bf16 v149, v122, s39, v149
v_dot2_f32_bf16 v150, v123, s38, v150
v_dot2_f32_bf16 v151, v123, s39, v151
s_waitcnt vmcnt(2)
v_dot2_f32_bf16 v144, v124, s38, v144
v_dot2_f32_bf16 v145, v124, s39, v145
v_dot2_f32_bf16 v146, v125, s38, v146
v_dot2_f32_bf16 v147, v125, s39, v147
v_dot2_f32_bf16 v148, v126, s38, v148
v_dot2_f32_bf16 v149, v126, s39, v149
v_dot2_f32_bf16 v150, v127, s38, v150
v_dot2_f32_bf16 v151, v127, s39, v151
v_lshlrev_b32 v152, 16, v224
v_and_b32 v153, 0xffff0000, v224
v_lshlrev_b32 v154, 16, v225
v_and_b32 v155, 0xffff0000, v225
v_lshlrev_b32 v156, 16, v226
v_and_b32 v157, 0xffff0000, v226
v_lshlrev_b32 v158, 16, v227
v_and_b32 v159, 0xffff0000, v227
v_fma_f32 v144, v144, s42, v152
v_fma_f32 v145, v145, s42, v153
v_fma_f32 v146, v146, s42, v154
v_fma_f32 v147, v147, s42, v155
v_fma_f32 v148, v148, s42, v156
v_fma_f32 v149, v149, s42, v157
v_fma_f32 v150, v150, s42, v158
v_fma_f32 v151, v151, s42, v159
v_cvt_pk_bf16_f32 v224, v144, v145
v_cvt_pk_bf16_f32 v225, v146, v147
v_cvt_pk_bf16_f32 v226, v148, v149
v_cvt_pk_bf16_f32 v227, v150, v151
v_subrev_u32 v23, 8, v23
v_and_b32 v152, 16, v2
v_cmp_eq_u32 vcc, 0, v152
v_permlane16_swap_b32 v224, v226
v_permlane16_swap_b32 v225, v227
v_cndmask_b32 v22, v23, v22, vcc
buffer_store_dwordx4 v[224:227], v22, s[32:35], 0 offen sc1
s_branch fused_kernel_fin
fused_kernel_fin:
fused_kernel_end:
fused_kernel_done:
s_endpgm
.section .rodata,"a"
.p2align 6
.amdhsa_kernel fused_kernel
  .amdhsa_next_free_vgpr 512
  .amdhsa_next_free_sgpr 102
  .amdhsa_accum_offset 256
  .amdhsa_group_segment_fixed_size 0
  .amdhsa_kernarg_size 104
  .amdhsa_user_sgpr_count 2
  .amdhsa_user_sgpr_kernarg_segment_ptr 1
  .amdhsa_system_sgpr_workgroup_id_x 1
  .amdhsa_float_denorm_mode_32 3
.end_amdhsa_kernel
```
